```python
import torch

def _softmax(x, axis=-1):
    return torch.softmax(x, dim=axis)
def _gelu(x):
    return torch.nn.functional.gelu(x, approximate="tanh")
def _silu(x):
    return torch.nn.functional.silu(x)
def _sigmoid(x):
    return torch.sigmoid(x)
def _layernorm(x, axis=-1, eps=1e-5):
    m = x.mean(dim=axis, keepdim=True)
    v = x.var(dim=axis, keepdim=True, unbiased=False)
    return (x - m) / torch.sqrt(v + eps)
def _scatter_add(tgt, idx, src, axis=0):
    return tgt.clone().index_add_(axis, idx, src)
def _segment_sum(src, seg, n):
    out = torch.zeros((n,) + src.shape[1:], dtype=src.dtype)
    return out.index_add_(0, seg, src)
def _pad(x, pw):
    flat = tuple(v for pair in reversed(pw) for v in pair)
    return torch.nn.functional.pad(x, flat)

kernel_name = 'gated_mix__grouped_kv_mqa__glu_gated_geglu__prompt'

def setup_inputs():

    _w = (lambda a: (lambda t: t.to(torch.bfloat16) if t.is_floating_point() else t)(torch.as_tensor(a)))
    def _A_setup():
        B, S, D, H = 1, 2048, 512, 32
        Dh = D // H
        return {
            "x": _w((lambda *s: torch.randn(*s, dtype=torch.bfloat16) * 0.05)(B, S, D)),
            "wq": _w((lambda *s: torch.randn(*s, dtype=torch.bfloat16) * 0.8)(D, H * Dh)),
            "wk": _w((lambda *s: torch.randn(*s, dtype=torch.bfloat16) * 0.8)(D, Dh)),
            "wv": _w((lambda *s: torch.randn(*s, dtype=torch.bfloat16) * 0.05)(D, Dh)),
            "wo": _w((lambda *s: torch.randn(*s, dtype=torch.bfloat16) * 0.05)(H * Dh, D)),
        }
    _A_in = _A_setup()

    def _B_setup():
        B, S, Dm, Df = 1, 2048, 512, 1792
        return {
            "x": _w((lambda *s: torch.randn(*s, dtype=torch.bfloat16) * 0.05)(B, S, Dm)),
            "w_gate": _w((lambda *s: torch.randn(*s, dtype=torch.bfloat16) * 0.8)(Dm, Df) * (Dm ** -0.5)),
            "w_up": _w((lambda *s: torch.randn(*s, dtype=torch.bfloat16) * 0.8)(Dm, Df) * (Dm ** -0.5)),
            "w_down": _w((lambda *s: torch.randn(*s, dtype=torch.bfloat16) * 0.8)(Df, Dm) * (Df ** -0.5)),
        }
    _B_in = _B_setup()

    return {
        "A_x": _A_in["x"],
        "A_wq": _A_in["wq"],
        "A_wk": _A_in["wk"],
        "A_wv": _A_in["wv"],
        "A_wo": _A_in["wo"],
        "B_x": _B_in["x"],
        "B_w_gate": _B_in["w_gate"],
        "B_w_up": _B_in["w_up"],
        "B_w_down": _B_in["w_down"],
        "gate_w": _w((lambda *s: torch.randn(*s, dtype=torch.bfloat16) * 0.05)(512) * 16.0),
    }

def reference(A_x, A_wq, A_wk, A_wv, A_wo, B_x, B_w_gate, B_w_up, B_w_down, gate_w):
    def _A_ref(x, wq, wk, wv, wo):
        B, S, D = x.shape
        H = 32
        Dh = D // H
        q = (lambda x, *d: x.permute(*d))((x @ wq).reshape(B, S, H, Dh), 0, 2, 1, 3)
        k = x @ wk
        v = x @ wv
        scores = torch.einsum("bhqd,bkd->bhqk", q, k) * (Dh ** -0.5)
        p = _softmax(scores, axis=-1)
        o = torch.einsum("bhqk,bkd->bhqd", p, v)
        return (lambda x, *d: x.permute(*d))(o, 0, 2, 1, 3).reshape(B, S, H * Dh) @ wo

    def _B_ref(x, w_gate, w_up, w_down):
        g = torch.einsum("bsd,df->bsf", x, w_gate)
        u = torch.einsum("bsd,df->bsf", x, w_up)
        h = _gelu(g) * u
        return torch.einsum("bsf,fd->bsd", h, w_down)

    x = A_x
    g = _sigmoid((x * gate_w).sum(-1, keepdims=True))
    a = _A_ref(x, A_wq, A_wk, A_wv, A_wo)
    b = _B_ref(x, B_w_gate, B_w_up, B_w_down)
    return g * a + (1 - g) * b
```

```asm
; @launch grid=(256,1,1) block=(512,1,1) lds=163840
.amdgcn_target "amdgcn-amd-amdhsa--gfx950"
.text
.globl gated_mix__grouped_kv_mqa__glu_gated_geglu__prompt_kernel
.p2align 8
.type gated_mix__grouped_kv_mqa__glu_gated_geglu__prompt_kernel,@function
gated_mix__grouped_kv_mqa__glu_gated_geglu__prompt_kernel:
    s_cmp_ge_u32 s2, 256
    s_cbranch_scc1 L_exit
    s_load_dwordx16 s[16:31], s[0:1], 0
    s_load_dwordx8 s[32:39], s[0:1], 64
    s_load_dwordx2 s[40:41], s[0:1], 96
    v_lshrrev_b32 v1, 6, v0
    v_and_b32 v0, 63, v0
    v_readfirstlane_b32 s3, v1
    s_mov_b32 s80, s2
    s_lshr_b32 s67, s80, 3
    s_bfe_u32 s66, s80, 0x20001
    s_and_b32 s68, s80, 1
    s_lshl_b32 s68, s68, 3
    s_mul_i32 s69, s66, 28
    s_add_u32 s69, s69, s67
    s_lshr_b32 s83, s69, 3
    s_and_b32 s82, s69, 7
    s_lshl_b32 s66, s66, 1
    s_bfe_u32 s69, s67, 0x10001
    s_add_u32 s66, s66, s69
    s_and_b32 s69, s67, 1
    s_add_u32 s69, s69, 14
    s_cmp_ge_u32 s80, 224
    s_cselect_b32 s82, s66, s82
    s_cselect_b32 s83, s69, s83
    s_add_u32 s82, s82, s68
    s_lshl_b32 s87, s83, 1
    s_add_u32 s87, s87, s82
    s_and_b32 s87, s87, 7
    s_and_b32 s64, s3, 3
    s_lshl_b32 s81, s64, 10
    s_cmp_ge_u32 s3, 4
    s_cbranch_scc1 L_roleF
    s_setprio 3
    v_lshrrev_b32 v16, 3, v0
    v_and_b32 v17, 7, v0
    v_lshrrev_b32 v18, 1, v16
    s_and_b32 s66, s64, 1
    s_lshl_b32 s66, s66, 2
    v_or_b32 v6, s66, v18
    v_xor_b32 v6, v6, v17
    v_lshlrev_b32 v6, 4, v6
    v_lshl_add_u32 v6, v16, 10, v6
    v_lshrrev_b32 v16, 2, v0
    v_and_b32 v17, 3, v0
    v_lshlrev_b32 v17, 4, v17
    v_lshl_add_u32 v7, v16, 10, v17
    v_lshrrev_b32 v16, 4, v0
    v_and_b32 v17, 15, v0
    v_lshlrev_b32 v18, 1, v16
    v_xor_b32 v17, v17, v18
    s_and_b32 s66, s64, 2
    s_lshl_b32 s66, s66, 2
    v_xor_b32 v17, s66, v17
    v_lshlrev_b32 v17, 4, v17
    v_mul_u32_u24 v16, 3584, v16
    v_add_u32 v14, v16, v17
    v_mov_b32 v15, v14
    s_lshl_b32 s84, s82, 17
    s_lshl_b32 s66, s64, 13
    s_add_u32 s84, s84, s66
    s_lshl_b32 s89, s64, 14
    s_lshl_b32 s66, s83, 6
    s_add_u32 s89, s89, s66
    s_mul_i32 s66, s64, 14336
    s_lshl_b32 s92, s83, 8
    s_add_u32 s92, s92, s66
    s_add_u32 s93, s92, 1835008
    s_mul_i32 s66, s87, 229376
    s_add_u32 s85, s92, s66
    s_waitcnt lgkmcnt(0)
    s_load_dword s65, s[40:41], 0
    s_mov_b32 s44, s16
    s_mov_b32 s45, s17
    s_mov_b32 s46, 0x200000
    s_mov_b32 s47, 0x20000
    s_mov_b32 s60, s18
    s_mov_b32 s61, s19
    s_mov_b32 s62, 0x80000
    s_mov_b32 s63, 0x20000
    s_cmp_ge_u32 s80, 224
    s_cbranch_scc1 L_Aidle_1
    s_add_u32 s77, s87, 0
    s_and_b32 s77, s77, 7
    s_lshl_b32 s78, s77, 16
    s_lshl_b32 s77, s77, 7
    s_add_u32 s77, s77, s84
    s_add_u32 s78, s78, s89
    s_add_u32 m0, s81, 0
    s_add_u32 s66, s77, 0
    buffer_load_dwordx4 v6, s[44:47], s66 offen lds
    s_add_u32 m0, s81, 4096
    s_add_u32 s66, s77, 32768
    buffer_load_dwordx4 v6, s[44:47], s66 offen lds
    s_add_u32 m0, s81, 8192
    s_add_u32 s66, s77, 65536
    buffer_load_dwordx4 v6, s[44:47], s66 offen lds
    s_add_u32 m0, s81, 12288
    s_add_u32 s66, s77, 98304
    buffer_load_dwordx4 v6, s[44:47], s66 offen lds
    s_add_u32 m0, s81, 49152
    s_nop 0
    buffer_load_dwordx4 v7, s[60:63], s78 offen lds
    s_mov_b32 s52, s28
    s_mov_b32 s53, s29
    s_mov_b32 s54, 0x1c0000
    s_mov_b32 s55, 0x20000
    s_mov_b32 s56, s30
    s_mov_b32 s57, s31
    s_mov_b32 s58, 0x1c0000
    s_mov_b32 s59, 0x20000
    s_add_u32 m0, s81, 61440
    s_nop 0
    buffer_load_dwordx4 v14, s[52:55], s85 offen lds
    s_add_u32 m0, s81, 65536
    s_nop 0
    buffer_load_dwordx4 v15, s[56:59], s85 offen lds
    s_add_u32 s85, s85, 57344
    s_add_u32 m0, s81, 69632
    s_nop 0
    buffer_load_dwordx4 v14, s[52:55], s85 offen lds
    s_add_u32 m0, s81, 73728
    s_nop 0
    buffer_load_dwordx4 v15, s[56:59], s85 offen lds
    s_add_u32 s85, s85, 57344
    s_add_u32 m0, s81, 77824
    s_nop 0
    buffer_load_dwordx4 v14, s[52:55], s85 offen lds
    s_add_u32 m0, s81, 81920
    s_nop 0
    buffer_load_dwordx4 v15, s[56:59], s85 offen lds
    s_add_u32 s85, s85, 57344
    s_add_u32 s77, s87, 1
    s_and_b32 s77, s77, 7
    s_lshl_b32 s78, s77, 16
    s_lshl_b32 s77, s77, 7
    s_add_u32 s77, s77, s84
    s_add_u32 s78, s78, s89
    s_add_u32 m0, s81, 16384
    s_add_u32 s66, s77, 0
    buffer_load_dwordx4 v6, s[44:47], s66 offen lds
    s_add_u32 m0, s81, 20480
    s_add_u32 s66, s77, 32768
    buffer_load_dwordx4 v6, s[44:47], s66 offen lds
    s_add_u32 m0, s81, 24576
    s_add_u32 s66, s77, 65536
    buffer_load_dwordx4 v6, s[44:47], s66 offen lds
    s_add_u32 m0, s81, 28672
    s_add_u32 s66, s77, 98304
    buffer_load_dwordx4 v6, s[44:47], s66 offen lds
    s_add_u32 m0, s81, 53248
    s_nop 0
    buffer_load_dwordx4 v7, s[60:63], s78 offen lds
    s_add_u32 m0, s81, 86016
    s_nop 0
    buffer_load_dwordx4 v14, s[52:55], s85 offen lds
    s_add_u32 m0, s81, 90112
    s_nop 0
    buffer_load_dwordx4 v15, s[56:59], s85 offen lds
    s_add_u32 s85, s85, 57344
    s_cmp_eq_u32 s85, s93
    s_cselect_b32 s85, s92, s85
    s_add_u32 m0, s81, 94208
    s_nop 0
    buffer_load_dwordx4 v14, s[52:55], s85 offen lds
    s_add_u32 m0, s81, 98304
    s_nop 0
    buffer_load_dwordx4 v15, s[56:59], s85 offen lds
    s_add_u32 s85, s85, 57344
    s_add_u32 m0, s81, 102400
    s_nop 0
    buffer_load_dwordx4 v14, s[52:55], s85 offen lds
    s_add_u32 m0, s81, 106496
    s_nop 0
    buffer_load_dwordx4 v15, s[56:59], s85 offen lds
    s_add_u32 s85, s85, 57344
    s_mov_b32 s48, s40
    s_mov_b32 s49, s41
    s_mov_b32 s50, 0x10000000
    s_mov_b32 s51, 0x20000
    s_lshl_b32 s68, s2, 5
    s_lshl_b32 s69, s64, 2
    s_add_u32 s68, s68, s69
    s_add_u32 s68, s68, 24576
    v_mov_b32 v21, 0
    s_waitcnt lgkmcnt(0)
    s_mul_i32 s65, s65, 0x9E3779B1
    s_add_u32 s65, s65, 0x7F4A7C15
    v_mov_b32 v20, s65
    s_mov_b64 exec, 1
    buffer_store_dword v20, v21, s[48:51], s68 offen sc1
    s_mov_b64 exec, -1
    s_lshl_b32 s66, s64, 12
    v_and_b32 v16, 31, v0
    v_lshrrev_b32 v17, 5, v0
    v_bfe_u32 v18, v0, 1, 3
    v_xor_b32 v18, v18, v17
    v_lshlrev_b32 v16, 7, v16
    v_add_u32 v16, s66, v16
    v_xor_b32 v8, 0, v18
    v_lshl_add_u32 v8, v8, 4, v16
    v_xor_b32 v9, 2, v18
    v_lshl_add_u32 v9, v9, 4, v16
    v_xor_b32 v10, 4, v18
    v_lshl_add_u32 v10, v10, 4, v16
    v_xor_b32 v11, 6, v18
    v_lshl_add_u32 v11, v11, 4, v16
    v_bfe_u32 v16, v0, 2, 2
    v_lshl_add_u32 v16, v17, 3, v16
    v_and_b32 v18, 3, v0
    v_lshlrev_b32 v18, 3, v18
    v_lshl_add_u32 v13, v16, 6, v18
    v_bfe_u32 v16, v0, 4, 1
    v_lshl_add_u32 v13, v16, 5, v13
    v_add_u32 v13, 49152, v13
    v_lshlrev_b32 v16, 2, v0
    v_add_u32 v16, 160832, v16
    v_mov_b32 v17, 0
    ds_write_b32 v16, v17
    v_lshlrev_b32 v1, 4, v0
    v_and_b32 v3, 31, v0
    v_lshlrev_b32 v3, 2, v3
    v_mov_b32 v2, 0xdddddddd
    v_add_u32 v12, 151552, v1
    v_lshlrev_b32 v62, 3, v0
    s_mov_b32 s90, 262144
    v_bfe_u32 v16, v0, 4, 1
    v_lshlrev_b32 v4, 10, v16
    v_and_b32 v16, 32, v0
    v_lshl_add_u32 v4, v16, 4, v4
    v_and_b32 v16, 15, v0
    v_lshl_add_u32 v4, v16, 4, v4
    v_lshlrev_b32 v5, 2, v16
    s_lshl_b32 s66, s64, 11
    s_add_u32 s66, s66, 151552
    v_add_u32 v57, s66, v4
    v_and_b32 v16, 11, v0
    v_cmp_eq_u32 vcc, 0, v16
    v_mov_b32 v16, 0x3f803f80
    s_nop 0
    v_cndmask_b32 v16, 0, v16, vcc
    v_mov_b32 v17, v16
    v_mov_b64 v[132:133], v[16:17]
    v_mov_b64 v[134:135], v[16:17]
    v_mov_b64 v[140:141], v[16:17]
    v_mov_b64 v[142:143], v[16:17]
    v_mov_b64 v[148:149], v[16:17]
    v_mov_b64 v[150:151], v[16:17]
    v_mov_b64 v[156:157], v[16:17]
    v_mov_b64 v[158:159], v[16:17]
    v_mov_b64 v[164:165], v[16:17]
    v_mov_b64 v[166:167], v[16:17]
    v_mov_b64 v[172:173], v[16:17]
    v_mov_b64 v[174:175], v[16:17]
    v_mov_b64 v[180:181], v[16:17]
    v_mov_b64 v[182:183], v[16:17]
    v_mov_b64 v[188:189], v[16:17]
    v_mov_b64 v[190:191], v[16:17]
    v_mov_b64 v[196:197], v[16:17]
    v_mov_b64 v[198:199], v[16:17]
    v_mov_b64 v[204:205], v[16:17]
    v_mov_b64 v[206:207], v[16:17]
    v_mov_b64 v[212:213], v[16:17]
    v_mov_b64 v[214:215], v[16:17]
    v_mov_b64 v[220:221], v[16:17]
    v_mov_b64 v[222:223], v[16:17]
    v_mov_b64 v[228:229], v[16:17]
    v_mov_b64 v[230:231], v[16:17]
    v_mov_b64 v[236:237], v[16:17]
    v_mov_b64 v[238:239], v[16:17]
    v_mov_b64 v[244:245], v[16:17]
    v_mov_b64 v[246:247], v[16:17]
    v_mov_b64 v[252:253], v[16:17]
    v_mov_b64 v[254:255], v[16:17]
    v_mov_b64 v[48:49], 0
    v_mov_b64 v[50:51], 0
    v_mov_b64 v[52:53], 0
    v_mov_b64 v[54:55], 0
    v_mov_b32 v56, 0
    s_lshl_b32 s66, s82, 2
    s_add_u32 s66, s66, s64
    s_lshl_b32 s88, s66, 15
    s_lshl_b32 s66, s83, 11
    s_add_u32 s88, s88, s66
    s_add_u32 s88, s88, 3145728
    s_lshl_b32 s86, s64, 3
    s_lshr_b32 s66, s80, 3
    s_add_u32 s86, s86, s66
    s_waitcnt vmcnt(14)
    s_waitcnt lgkmcnt(0)
    s_barrier
    ds_read_b128 v[16:19], v8 offset:0
    ds_read_b64_tr_b16 v[24:25], v13 offset:0
    ds_read_b64_tr_b16 v[26:27], v13 offset:256
    s_waitcnt vmcnt(5)
    s_waitcnt lgkmcnt(0)
    s_barrier
    v_mfma_f32_32x32x16_bf16 v[32:47], v[24:27], v[16:19], 0
    ds_read_b128 v[20:23], v9 offset:0
    ds_read_b64_tr_b16 v[28:29], v13 offset:1024
    ds_read_b64_tr_b16 v[30:31], v13 offset:1280
    s_add_u32 s77, s87, 2
    s_and_b32 s77, s77, 7
    s_lshl_b32 s78, s77, 16
    s_lshl_b32 s77, s77, 7
    s_add_u32 s77, s77, s84
    s_add_u32 s78, s78, s89
    s_add_u32 m0, s81, 32768
    s_add_u32 s66, s77, 0
    buffer_load_dwordx4 v6, s[44:47], s66 offen lds
    s_add_u32 m0, s81, 36864
    s_add_u32 s66, s77, 32768
    buffer_load_dwordx4 v6, s[44:47], s66 offen lds
    s_add_u32 m0, s81, 40960
    s_add_u32 s66, s77, 65536
    buffer_load_dwordx4 v6, s[44:47], s66 offen lds
    s_waitcnt lgkmcnt(0)
    v_mfma_f32_32x32x16_bf16 v[32:47], v[28:31], v[20:23], v[32:47]
    ds_read_b128 v[16:19], v10 offset:0
    ds_read_b64_tr_b16 v[24:25], v13 offset:2048
    ds_read_b64_tr_b16 v[26:27], v13 offset:2304
    s_add_u32 m0, s81, 110592
    s_nop 0
    buffer_load_dwordx4 v14, s[52:55], s85 offen lds
    s_add_u32 m0, s81, 114688
    s_nop 0
    buffer_load_dwordx4 v15, s[56:59], s85 offen lds
    s_add_u32 s85, s85, 57344
    s_add_u32 m0, s81, 118784
    s_nop 0
    buffer_load_dwordx4 v14, s[52:55], s85 offen lds
    s_add_u32 m0, s81, 122880
    s_nop 0
    buffer_load_dwordx4 v15, s[56:59], s85 offen lds
    s_add_u32 s85, s85, 57344
    s_cmp_eq_u32 s85, s93
    s_cselect_b32 s85, s92, s85
    s_add_u32 m0, s81, 126976
    s_nop 0
    buffer_load_dwordx4 v14, s[52:55], s85 offen lds
    s_add_u32 m0, s81, 131072
    s_nop 0
    buffer_load_dwordx4 v15, s[56:59], s85 offen lds
    s_add_u32 s85, s85, 57344
    s_add_u32 m0, s81, 135168
    s_nop 0
    buffer_load_dwordx4 v14, s[52:55], s85 offen lds
    s_add_u32 m0, s81, 139264
    s_nop 0
    buffer_load_dwordx4 v15, s[56:59], s85 offen lds
    s_add_u32 s85, s85, 57344
    s_waitcnt vmcnt(12)
    s_waitcnt lgkmcnt(0)
    s_barrier
    v_mfma_f32_32x32x16_bf16 v[32:47], v[24:27], v[16:19], v[32:47]
    ds_read_b128 v[20:23], v11 offset:0
    ds_read_b64_tr_b16 v[28:29], v13 offset:3072
    ds_read_b64_tr_b16 v[30:31], v13 offset:3328
    s_add_u32 m0, s81, 45056
    s_add_u32 s66, s77, 98304
    buffer_load_dwordx4 v6, s[44:47], s66 offen lds
    s_add_u32 m0, s81, 57344
    s_nop 0
    buffer_load_dwordx4 v7, s[60:63], s78 offen lds
    s_waitcnt lgkmcnt(0)
    v_mfma_f32_32x32x16_bf16 v[32:47], v[28:31], v[20:23], v[32:47]
    ds_read_b128 v[16:19], v8 offset:16384
    ds_read_b64_tr_b16 v[24:25], v13 offset:4096
    ds_read_b64_tr_b16 v[26:27], v13 offset:4352
    s_add_u32 m0, s81, 61440
    s_nop 0
    buffer_load_dwordx4 v14, s[52:55], s85 offen lds
    s_add_u32 m0, s81, 65536
    s_nop 0
    buffer_load_dwordx4 v15, s[56:59], s85 offen lds
    s_add_u32 s85, s85, 57344
    s_add_u32 m0, s81, 69632
    s_nop 0
    buffer_load_dwordx4 v14, s[52:55], s85 offen lds
    s_add_u32 m0, s81, 73728
    s_nop 0
    buffer_load_dwordx4 v15, s[56:59], s85 offen lds
    s_add_u32 s85, s85, 57344
    s_cmp_eq_u32 s85, s93
    s_cselect_b32 s85, s92, s85
    s_waitcnt vmcnt(10)
    s_waitcnt lgkmcnt(0)
    s_barrier
    v_mfma_f32_32x32x16_bf16 v[32:47], v[24:27], v[16:19], v[32:47]
    ds_read_b128 v[20:23], v9 offset:16384
    ds_read_b64_tr_b16 v[28:29], v13 offset:5120
    ds_read_b64_tr_b16 v[30:31], v13 offset:5376
    s_add_u32 s77, s87, 3
    s_and_b32 s77, s77, 7
    s_lshl_b32 s78, s77, 16
    s_lshl_b32 s77, s77, 7
    s_add_u32 s77, s77, s84
    s_add_u32 s78, s78, s89
    s_add_u32 m0, s81, 0
    s_add_u32 s66, s77, 0
    buffer_load_dwordx4 v6, s[44:47], s66 offen lds
    s_add_u32 m0, s81, 4096
    s_add_u32 s66, s77, 32768
    buffer_load_dwordx4 v6, s[44:47], s66 offen lds
    s_add_u32 m0, s81, 8192
    s_add_u32 s66, s77, 65536
    buffer_load_dwordx4 v6, s[44:47], s66 offen lds
    s_waitcnt lgkmcnt(0)
    v_mfma_f32_32x32x16_bf16 v[32:47], v[28:31], v[20:23], v[32:47]
    ds_read_b128 v[16:19], v10 offset:16384
    ds_read_b64_tr_b16 v[24:25], v13 offset:6144
    ds_read_b64_tr_b16 v[26:27], v13 offset:6400
    s_add_u32 m0, s81, 77824
    s_nop 0
    buffer_load_dwordx4 v14, s[52:55], s85 offen lds
    s_add_u32 m0, s81, 81920
    s_nop 0
    buffer_load_dwordx4 v15, s[56:59], s85 offen lds
    s_add_u32 s85, s85, 57344
    s_add_u32 m0, s81, 86016
    s_nop 0
    buffer_load_dwordx4 v14, s[52:55], s85 offen lds
    s_add_u32 m0, s81, 90112
    s_nop 0
    buffer_load_dwordx4 v15, s[56:59], s85 offen lds
    s_add_u32 s85, s85, 57344
    s_waitcnt vmcnt(11)
    s_waitcnt lgkmcnt(0)
    s_barrier
    v_mfma_f32_32x32x16_bf16 v[32:47], v[24:27], v[16:19], v[32:47]
    ds_read_b128 v[20:23], v11 offset:16384
    ds_read_b64_tr_b16 v[28:29], v13 offset:7168
    ds_read_b64_tr_b16 v[30:31], v13 offset:7424
    s_add_u32 m0, s81, 12288
    s_add_u32 s66, s77, 98304
    buffer_load_dwordx4 v6, s[44:47], s66 offen lds
    s_add_u32 m0, s81, 49152
    s_nop 0
    buffer_load_dwordx4 v7, s[60:63], s78 offen lds
    s_waitcnt lgkmcnt(0)
    v_mfma_f32_32x32x16_bf16 v[32:47], v[28:31], v[20:23], v[32:47]
    ds_read_b128 v[16:19], v8 offset:32768
    ds_read_b64_tr_b16 v[24:25], v13 offset:8192
    ds_read_b64_tr_b16 v[26:27], v13 offset:8448
    s_add_u32 m0, s81, 94208
    s_nop 0
    buffer_load_dwordx4 v14, s[52:55], s85 offen lds
    s_add_u32 m0, s81, 98304
    s_nop 0
    buffer_load_dwordx4 v15, s[56:59], s85 offen lds
    s_add_u32 s85, s85, 57344
    s_add_u32 m0, s81, 102400
    s_nop 0
    buffer_load_dwordx4 v14, s[52:55], s85 offen lds
    s_add_u32 m0, s81, 106496
    s_nop 0
    buffer_load_dwordx4 v15, s[56:59], s85 offen lds
    s_add_u32 s85, s85, 57344
    s_cmp_eq_u32 s85, s93
    s_cselect_b32 s85, s92, s85
    s_waitcnt vmcnt(13)
    s_waitcnt lgkmcnt(0)
    s_barrier
    v_mfma_f32_32x32x16_bf16 v[32:47], v[24:27], v[16:19], v[32:47]
    ds_read_b128 v[20:23], v9 offset:32768
    ds_read_b64_tr_b16 v[28:29], v13 offset:9216
    ds_read_b64_tr_b16 v[30:31], v13 offset:9472
    s_add_u32 s77, s87, 4
    s_and_b32 s77, s77, 7
    s_lshl_b32 s78, s77, 16
    s_lshl_b32 s77, s77, 7
    s_add_u32 s77, s77, s84
    s_add_u32 s78, s78, s89
    s_add_u32 m0, s81, 16384
    s_add_u32 s66, s77, 0
    buffer_load_dwordx4 v6, s[44:47], s66 offen lds
    s_add_u32 m0, s81, 20480
    s_add_u32 s66, s77, 32768
    buffer_load_dwordx4 v6, s[44:47], s66 offen lds
    s_add_u32 m0, s81, 24576
    s_add_u32 s66, s77, 65536
    buffer_load_dwordx4 v6, s[44:47], s66 offen lds
    s_waitcnt lgkmcnt(0)
    v_mfma_f32_32x32x16_bf16 v[32:47], v[28:31], v[20:23], v[32:47]
    ds_read_b128 v[16:19], v10 offset:32768
    ds_read_b64_tr_b16 v[24:25], v13 offset:10240
    ds_read_b64_tr_b16 v[26:27], v13 offset:10496
    s_add_u32 m0, s81, 110592
    s_nop 0
    buffer_load_dwordx4 v14, s[52:55], s85 offen lds
    s_add_u32 m0, s81, 114688
    s_nop 0
    buffer_load_dwordx4 v15, s[56:59], s85 offen lds
    s_add_u32 s85, s85, 57344
    s_add_u32 m0, s81, 118784
    s_nop 0
    buffer_load_dwordx4 v14, s[52:55], s85 offen lds
    s_add_u32 m0, s81, 122880
    s_nop 0
    buffer_load_dwordx4 v15, s[56:59], s85 offen lds
    s_add_u32 s85, s85, 57344
    s_waitcnt vmcnt(11)
    s_waitcnt lgkmcnt(0)
    s_barrier
    v_mfma_f32_32x32x16_bf16 v[32:47], v[24:27], v[16:19], v[32:47]
    ds_read_b128 v[20:23], v11 offset:32768
    ds_read_b64_tr_b16 v[28:29], v13 offset:11264
    ds_read_b64_tr_b16 v[30:31], v13 offset:11520
    s_add_u32 m0, s81, 28672
    s_add_u32 s66, s77, 98304
    buffer_load_dwordx4 v6, s[44:47], s66 offen lds
    s_add_u32 m0, s81, 53248
    s_nop 0
    buffer_load_dwordx4 v7, s[60:63], s78 offen lds
    s_waitcnt lgkmcnt(0)
    v_mfma_f32_32x32x16_bf16 v[32:47], v[28:31], v[20:23], v[32:47]
    ds_read_b128 v[16:19], v8 offset:0
    ds_read_b64_tr_b16 v[24:25], v13 offset:0
    ds_read_b64_tr_b16 v[26:27], v13 offset:256
    s_add_u32 m0, s81, 126976
    s_nop 0
    buffer_load_dwordx4 v14, s[52:55], s85 offen lds
    s_add_u32 m0, s81, 131072
    s_nop 0
    buffer_load_dwordx4 v15, s[56:59], s85 offen lds
    s_add_u32 s85, s85, 57344
    s_add_u32 m0, s81, 135168
    s_nop 0
    buffer_load_dwordx4 v14, s[52:55], s85 offen lds
    s_add_u32 m0, s81, 139264
    s_nop 0
    buffer_load_dwordx4 v15, s[56:59], s85 offen lds
    s_add_u32 s85, s85, 57344
    s_cmp_eq_u32 s85, s93
    s_cselect_b32 s85, s92, s85
    s_waitcnt vmcnt(13)
    s_waitcnt lgkmcnt(0)
    s_barrier
    v_mfma_f32_32x32x16_bf16 v[32:47], v[24:27], v[16:19], v[32:47]
    ds_read_b128 v[20:23], v9 offset:0
    ds_read_b64_tr_b16 v[28:29], v13 offset:1024
    ds_read_b64_tr_b16 v[30:31], v13 offset:1280
    s_add_u32 s77, s87, 5
    s_and_b32 s77, s77, 7
    s_lshl_b32 s78, s77, 16
    s_lshl_b32 s77, s77, 7
    s_add_u32 s77, s77, s84
    s_add_u32 s78, s78, s89
    s_add_u32 m0, s81, 32768
    s_add_u32 s66, s77, 0
    buffer_load_dwordx4 v6, s[44:47], s66 offen lds
    s_add_u32 m0, s81, 36864
    s_add_u32 s66, s77, 32768
    buffer_load_dwordx4 v6, s[44:47], s66 offen lds
    s_add_u32 m0, s81, 40960
    s_add_u32 s66, s77, 65536
    buffer_load_dwordx4 v6, s[44:47], s66 offen lds
    s_waitcnt lgkmcnt(0)
    v_mfma_f32_32x32x16_bf16 v[32:47], v[28:31], v[20:23], v[32:47]
    ds_read_b128 v[16:19], v10 offset:0
    ds_read_b64_tr_b16 v[24:25], v13 offset:2048
    ds_read_b64_tr_b16 v[26:27], v13 offset:2304
    s_add_u32 m0, s81, 61440
    s_nop 0
    buffer_load_dwordx4 v14, s[52:55], s85 offen lds
    s_add_u32 m0, s81, 65536
    s_nop 0
    buffer_load_dwordx4 v15, s[56:59], s85 offen lds
    s_add_u32 s85, s85, 57344
    s_add_u32 m0, s81, 69632
    s_nop 0
    buffer_load_dwordx4 v14, s[52:55], s85 offen lds
    s_add_u32 m0, s81, 73728
    s_nop 0
    buffer_load_dwordx4 v15, s[56:59], s85 offen lds
    s_add_u32 s85, s85, 57344
    s_waitcnt vmcnt(11)
    s_waitcnt lgkmcnt(0)
    s_barrier
    v_mfma_f32_32x32x16_bf16 v[32:47], v[24:27], v[16:19], v[32:47]
    ds_read_b128 v[20:23], v11 offset:0
    ds_read_b64_tr_b16 v[28:29], v13 offset:3072
    ds_read_b64_tr_b16 v[30:31], v13 offset:3328
    s_add_u32 m0, s81, 45056
    s_add_u32 s66, s77, 98304
    buffer_load_dwordx4 v6, s[44:47], s66 offen lds
    s_add_u32 m0, s81, 57344
    s_nop 0
    buffer_load_dwordx4 v7, s[60:63], s78 offen lds
    s_waitcnt lgkmcnt(0)
    v_mfma_f32_32x32x16_bf16 v[32:47], v[28:31], v[20:23], v[32:47]
    ds_read_b128 v[16:19], v8 offset:16384
    ds_read_b64_tr_b16 v[24:25], v13 offset:4096
    ds_read_b64_tr_b16 v[26:27], v13 offset:4352
    s_add_u32 m0, s81, 77824
    s_nop 0
    buffer_load_dwordx4 v14, s[52:55], s85 offen lds
    s_add_u32 m0, s81, 81920
    s_nop 0
    buffer_load_dwordx4 v15, s[56:59], s85 offen lds
    s_add_u32 s85, s85, 57344
    s_add_u32 m0, s81, 86016
    s_nop 0
    buffer_load_dwordx4 v14, s[52:55], s85 offen lds
    s_add_u32 m0, s81, 90112
    s_nop 0
    buffer_load_dwordx4 v15, s[56:59], s85 offen lds
    s_add_u32 s85, s85, 57344
    s_cmp_eq_u32 s85, s93
    s_cselect_b32 s85, s92, s85
    s_waitcnt vmcnt(13)
    s_waitcnt lgkmcnt(0)
    s_barrier
    v_mfma_f32_32x32x16_bf16 v[32:47], v[24:27], v[16:19], v[32:47]
    ds_read_b128 v[20:23], v9 offset:16384
    ds_read_b64_tr_b16 v[28:29], v13 offset:5120
    ds_read_b64_tr_b16 v[30:31], v13 offset:5376
    s_add_u32 s77, s87, 6
    s_and_b32 s77, s77, 7
    s_lshl_b32 s78, s77, 16
    s_lshl_b32 s77, s77, 7
    s_add_u32 s77, s77, s84
    s_add_u32 s78, s78, s89
    s_add_u32 m0, s81, 0
    s_add_u32 s66, s77, 0
    buffer_load_dwordx4 v6, s[44:47], s66 offen lds
    s_add_u32 m0, s81, 4096
    s_add_u32 s66, s77, 32768
    buffer_load_dwordx4 v6, s[44:47], s66 offen lds
    s_add_u32 m0, s81, 8192
    s_add_u32 s66, s77, 65536
    buffer_load_dwordx4 v6, s[44:47], s66 offen lds
    s_waitcnt lgkmcnt(0)
    v_mfma_f32_32x32x16_bf16 v[32:47], v[28:31], v[20:23], v[32:47]
    ds_read_b128 v[16:19], v10 offset:16384
    ds_read_b64_tr_b16 v[24:25], v13 offset:6144
    ds_read_b64_tr_b16 v[26:27], v13 offset:6400
    s_add_u32 m0, s81, 94208
    s_nop 0
    buffer_load_dwordx4 v14, s[52:55], s85 offen lds
    s_add_u32 m0, s81, 98304
    s_nop 0
    buffer_load_dwordx4 v15, s[56:59], s85 offen lds
    s_add_u32 s85, s85, 57344
    s_add_u32 m0, s81, 102400
    s_nop 0
    buffer_load_dwordx4 v14, s[52:55], s85 offen lds
    s_add_u32 m0, s81, 106496
    s_nop 0
    buffer_load_dwordx4 v15, s[56:59], s85 offen lds
    s_add_u32 s85, s85, 57344
    s_waitcnt vmcnt(11)
    s_waitcnt lgkmcnt(0)
    s_barrier
    v_mfma_f32_32x32x16_bf16 v[32:47], v[24:27], v[16:19], v[32:47]
    ds_read_b128 v[20:23], v11 offset:16384
    ds_read_b64_tr_b16 v[28:29], v13 offset:7168
    ds_read_b64_tr_b16 v[30:31], v13 offset:7424
    s_add_u32 m0, s81, 12288
    s_add_u32 s66, s77, 98304
    buffer_load_dwordx4 v6, s[44:47], s66 offen lds
    s_add_u32 m0, s81, 49152
    s_nop 0
    buffer_load_dwordx4 v7, s[60:63], s78 offen lds
    s_waitcnt lgkmcnt(0)
    v_mfma_f32_32x32x16_bf16 v[32:47], v[28:31], v[20:23], v[32:47]
    ds_read_b128 v[16:19], v8 offset:32768
    ds_read_b64_tr_b16 v[24:25], v13 offset:8192
    ds_read_b64_tr_b16 v[26:27], v13 offset:8448
    s_add_u32 m0, s81, 110592
    s_nop 0
    buffer_load_dwordx4 v14, s[52:55], s85 offen lds
    s_add_u32 m0, s81, 114688
    s_nop 0
    buffer_load_dwordx4 v15, s[56:59], s85 offen lds
    s_add_u32 s85, s85, 57344
    s_add_u32 m0, s81, 118784
    s_nop 0
    buffer_load_dwordx4 v14, s[52:55], s85 offen lds
    s_add_u32 m0, s81, 122880
    s_nop 0
    buffer_load_dwordx4 v15, s[56:59], s85 offen lds
    s_add_u32 s85, s85, 57344
    s_cmp_eq_u32 s85, s93
    s_cselect_b32 s85, s92, s85
    s_waitcnt vmcnt(13)
    s_waitcnt lgkmcnt(0)
    s_barrier
    v_mfma_f32_32x32x16_bf16 v[32:47], v[24:27], v[16:19], v[32:47]
    ds_read_b128 v[20:23], v9 offset:32768
    ds_read_b64_tr_b16 v[28:29], v13 offset:9216
    ds_read_b64_tr_b16 v[30:31], v13 offset:9472
    s_add_u32 s77, s87, 7
    s_and_b32 s77, s77, 7
    s_lshl_b32 s78, s77, 16
    s_lshl_b32 s77, s77, 7
    s_add_u32 s77, s77, s84
    s_add_u32 s78, s78, s89
    s_add_u32 m0, s81, 16384
    s_add_u32 s66, s77, 0
    buffer_load_dwordx4 v6, s[44:47], s66 offen lds
    s_add_u32 m0, s81, 20480
    s_add_u32 s66, s77, 32768
    buffer_load_dwordx4 v6, s[44:47], s66 offen lds
    s_add_u32 m0, s81, 24576
    s_add_u32 s66, s77, 65536
    buffer_load_dwordx4 v6, s[44:47], s66 offen lds
    s_add_u32 m0, s81, 28672
    s_add_u32 s66, s77, 98304
    buffer_load_dwordx4 v6, s[44:47], s66 offen lds
    s_add_u32 m0, s81, 53248
    s_nop 0
    buffer_load_dwordx4 v7, s[60:63], s78 offen lds
    s_waitcnt lgkmcnt(0)
    v_mfma_f32_32x32x16_bf16 v[32:47], v[28:31], v[20:23], v[32:47]
    ds_read_b128 v[16:19], v10 offset:32768
    ds_read_b64_tr_b16 v[24:25], v13 offset:10240
    ds_read_b64_tr_b16 v[26:27], v13 offset:10496
    s_add_u32 m0, s81, 126976
    s_nop 0
    buffer_load_dwordx4 v14, s[52:55], s85 offen lds
    s_add_u32 m0, s81, 131072
    s_nop 0
    buffer_load_dwordx4 v15, s[56:59], s85 offen lds
    s_add_u32 s85, s85, 57344
    s_add_u32 m0, s81, 135168
    s_nop 0
    buffer_load_dwordx4 v14, s[52:55], s85 offen lds
    s_add_u32 m0, s81, 139264
    s_nop 0
    buffer_load_dwordx4 v15, s[56:59], s85 offen lds
    s_add_u32 s85, s85, 57344
    s_waitcnt vmcnt(13)
    s_waitcnt lgkmcnt(0)
    s_barrier
    v_mfma_f32_32x32x16_bf16 v[32:47], v[24:27], v[16:19], v[32:47]
    ds_read_b128 v[20:23], v11 offset:32768
    ds_read_b64_tr_b16 v[28:29], v13 offset:11264
    ds_read_b64_tr_b16 v[30:31], v13 offset:11520
    s_waitcnt lgkmcnt(0)
    v_mfma_f32_32x32x16_bf16 v[32:47], v[28:31], v[20:23], v[32:47]
    ds_read_b128 v[16:19], v8 offset:0
    ds_read_b64_tr_b16 v[24:25], v13 offset:0
    ds_read_b64_tr_b16 v[26:27], v13 offset:256
    s_add_u32 m0, s81, 61440
    s_nop 0
    buffer_load_dwordx4 v14, s[52:55], s85 offen lds
    s_add_u32 m0, s81, 65536
    s_nop 0
    buffer_load_dwordx4 v15, s[56:59], s85 offen lds
    s_add_u32 s85, s85, 57344
    s_add_u32 m0, s81, 69632
    s_nop 0
    buffer_load_dwordx4 v14, s[52:55], s85 offen lds
    s_add_u32 m0, s81, 73728
    s_nop 0
    buffer_load_dwordx4 v15, s[56:59], s85 offen lds
    s_add_u32 s85, s85, 57344
    s_cmp_eq_u32 s85, s93
    s_cselect_b32 s85, s92, s85
    s_waitcnt vmcnt(13)
    s_waitcnt lgkmcnt(0)
    s_barrier
    v_mfma_f32_32x32x16_bf16 v[32:47], v[24:27], v[16:19], v[32:47]
    ds_read_b128 v[20:23], v9 offset:0
    ds_read_b64_tr_b16 v[28:29], v13 offset:1024
    ds_read_b64_tr_b16 v[30:31], v13 offset:1280
    s_waitcnt lgkmcnt(0)
    v_mfma_f32_32x32x16_bf16 v[32:47], v[28:31], v[20:23], v[32:47]
    ds_read_b128 v[16:19], v10 offset:0
    ds_read_b64_tr_b16 v[24:25], v13 offset:2048
    ds_read_b64_tr_b16 v[26:27], v13 offset:2304
    s_waitcnt vmcnt(0)
    s_waitcnt lgkmcnt(0)
    s_barrier
    v_mfma_f32_32x32x16_bf16 v[32:47], v[24:27], v[16:19], v[32:47]
    ds_read_b128 v[20:23], v11 offset:0
    ds_read_b64_tr_b16 v[28:29], v13 offset:3072
    ds_read_b64_tr_b16 v[30:31], v13 offset:3328
    s_waitcnt lgkmcnt(0)
    v_mfma_f32_32x32x16_bf16 v[32:47], v[28:31], v[20:23], v[32:47]
    ds_read_b128 v[16:19], v8 offset:16384
    ds_read_b64_tr_b16 v[24:25], v13 offset:4096
    ds_read_b64_tr_b16 v[26:27], v13 offset:4352
    v_mov_b32 v58, 160772
    ds_read_b32 v59, v58
    s_waitcnt lgkmcnt(0)
    v_readfirstlane_b32 s66, v59
    s_cmp_eq_u32 s66, 1
    s_cbranch_scc1 L_kvok_3
    s_cmp_lg_u32 s64, 0
    s_cbranch_scc1 L_norec_4
    s_mov_b32 s76, 0x40000
L_poll_6:
    buffer_load_dwordx2 v[58:59], v62, s[48:51], s90 offen sc1
    buffer_load_dwordx2 v[60:61], v62, s[48:51], s90 offen offset:512 sc1
    s_waitcnt vmcnt(0)
    v_cmp_ne_u32 vcc, s65, v58
    v_cmp_ne_u32 s[78:79], s65, v60
    s_or_b64 vcc, vcc, s[78:79]
    s_cbranch_vccz L_polled_7
    s_sleep 8
    s_sub_u32 s76, s76, 1
    s_cmp_lg_u32 s76, 0
    s_cbranch_scc1 L_poll_6
L_polled_7:
L_seen_5:
    v_cmp_lt_u32 vcc, 0x58800000, v61
    v_mov_b32 v58, 0x7f800000
    s_nop 0
    v_cndmask_b32 v59, v59, v58, vcc
    s_nop 1
    v_max_u32_dpp v59, v59, v59 row_shr:1
    s_nop 1
    v_max_u32_dpp v59, v59, v59 row_shr:2
    s_nop 1
    v_max_u32_dpp v59, v59, v59 row_shr:4
    s_nop 1
    v_max_u32_dpp v59, v59, v59 row_shr:8
    s_nop 1
    v_max_u32_dpp v59, v59, v59 row_bcast:15 row_mask:0xa
    s_nop 1
    v_max_u32_dpp v59, v59, v59 row_bcast:31 row_mask:0xc
    v_mov_b32 v58, 160768
    s_mov_b32 exec_lo, 0
    s_mov_b32 exec_hi, 0x80000000
    ds_write_b32 v58, v59
    s_mov_b64 exec, -1
L_norec_4:
    v_mov_b32 v58, 160868
    v_mov_b32 v59, 1
    s_mov_b64 exec, 1
    ds_add_u32 v58, v59
    s_mov_b64 exec, -1
L_ls_8:
    ds_read_b32 v59, v58
    s_waitcnt lgkmcnt(0)
    v_readfirstlane_b32 s76, v59
    s_cmp_lt_u32 s76, 4
    s_cbranch_scc1 L_ls_8
L_kvok_3:
    s_add_u32 s66, s86, 0
    s_and_b32 s66, s66, 31
    s_lshl_b32 s66, s66, 11
    s_add_u32 s67, s66, 131072
    s_add_u32 s66, s66, 65536
    buffer_load_dwordx4 v[64:67], v1, s[48:51], s66 offen offset:0 sc1
    buffer_load_dwordx4 v[128:131], v1, s[48:51], s67 offen offset:0 sc1
    buffer_load_dwordx4 v[68:71], v1, s[48:51], s66 offen offset:1024 sc1
    buffer_load_dwordx4 v[136:139], v1, s[48:51], s67 offen offset:1024 sc1
    s_add_u32 s66, s86, 1
    s_and_b32 s66, s66, 31
    s_lshl_b32 s66, s66, 11
    s_add_u32 s67, s66, 131072
    s_add_u32 s66, s66, 65536
    buffer_load_dwordx4 v[72:75], v1, s[48:51], s66 offen offset:0 sc1
    buffer_load_dwordx4 v[144:147], v1, s[48:51], s67 offen offset:0 sc1
    buffer_load_dwordx4 v[76:79], v1, s[48:51], s66 offen offset:1024 sc1
    buffer_load_dwordx4 v[152:155], v1, s[48:51], s67 offen offset:1024 sc1
    s_add_u32 s66, s86, 2
    s_and_b32 s66, s66, 31
    s_lshl_b32 s66, s66, 11
    s_add_u32 s67, s66, 131072
    s_add_u32 s66, s66, 65536
    buffer_load_dwordx4 v[80:83], v1, s[48:51], s66 offen offset:0 sc1
    buffer_load_dwordx4 v[160:163], v1, s[48:51], s67 offen offset:0 sc1
    buffer_load_dwordx4 v[84:87], v1, s[48:51], s66 offen offset:1024 sc1
    buffer_load_dwordx4 v[168:171], v1, s[48:51], s67 offen offset:1024 sc1
    s_add_u32 s66, s86, 3
    s_and_b32 s66, s66, 31
    s_lshl_b32 s66, s66, 11
    s_add_u32 s67, s66, 131072
    s_add_u32 s66, s66, 65536
    buffer_load_dwordx4 v[88:91], v1, s[48:51], s66 offen offset:0 sc1
    buffer_load_dwordx4 v[176:179], v1, s[48:51], s67 offen offset:0 sc1
    buffer_load_dwordx4 v[92:95], v1, s[48:51], s66 offen offset:1024 sc1
    buffer_load_dwordx4 v[184:187], v1, s[48:51], s67 offen offset:1024 sc1
    s_waitcnt lgkmcnt(0)
    v_mfma_f32_32x32x16_bf16 v[32:47], v[24:27], v[16:19], v[32:47]
    ds_read_b128 v[20:23], v9 offset:16384
    ds_read_b64_tr_b16 v[28:29], v13 offset:5120
    ds_read_b64_tr_b16 v[30:31], v13 offset:5376
    s_waitcnt lgkmcnt(0)
    v_mfma_f32_32x32x16_bf16 v[32:47], v[28:31], v[20:23], v[32:47]
    ds_read_b128 v[16:19], v10 offset:16384
    ds_read_b64_tr_b16 v[24:25], v13 offset:6144
    ds_read_b64_tr_b16 v[26:27], v13 offset:6400
    s_add_u32 s66, s86, 4
    s_and_b32 s66, s66, 31
    s_lshl_b32 s66, s66, 11
    s_add_u32 s67, s66, 131072
    s_add_u32 s66, s66, 65536
    buffer_load_dwordx4 v[96:99], v1, s[48:51], s66 offen offset:0 sc1
    buffer_load_dwordx4 v[192:195], v1, s[48:51], s67 offen offset:0 sc1
    s_waitcnt vmcnt(16)
    v_permlane16_swap_b32 v128, v132
    v_permlane16_swap_b32 v129, v133
    v_permlane16_swap_b32 v130, v134
    v_permlane16_swap_b32 v131, v135
    buffer_load_dwordx4 v[100:103], v1, s[48:51], s66 offen offset:1024 sc1
    buffer_load_dwordx4 v[200:203], v1, s[48:51], s67 offen offset:1024 sc1
    s_waitcnt vmcnt(16)
    v_permlane16_swap_b32 v136, v140
    v_permlane16_swap_b32 v137, v141
    v_permlane16_swap_b32 v138, v142
    v_permlane16_swap_b32 v139, v143
    s_add_u32 s66, s86, 5
    s_and_b32 s66, s66, 31
    s_lshl_b32 s66, s66, 11
    s_add_u32 s67, s66, 131072
    s_add_u32 s66, s66, 65536
    buffer_load_dwordx4 v[104:107], v1, s[48:51], s66 offen offset:0 sc1
    buffer_load_dwordx4 v[208:211], v1, s[48:51], s67 offen offset:0 sc1
    s_waitcnt vmcnt(16)
    v_permlane16_swap_b32 v144, v148
    v_permlane16_swap_b32 v145, v149
    v_permlane16_swap_b32 v146, v150
    v_permlane16_swap_b32 v147, v151
    buffer_load_dwordx4 v[108:111], v1, s[48:51], s66 offen offset:1024 sc1
    buffer_load_dwordx4 v[216:219], v1, s[48:51], s67 offen offset:1024 sc1
    s_waitcnt vmcnt(16)
    v_permlane16_swap_b32 v152, v156
    v_permlane16_swap_b32 v153, v157
    v_permlane16_swap_b32 v154, v158
    v_permlane16_swap_b32 v155, v159
    s_add_u32 s66, s86, 6
    s_and_b32 s66, s66, 31
    s_lshl_b32 s66, s66, 11
    s_add_u32 s67, s66, 131072
    s_add_u32 s66, s66, 65536
    buffer_load_dwordx4 v[112:115], v1, s[48:51], s66 offen offset:0 sc1
    buffer_load_dwordx4 v[224:227], v1, s[48:51], s67 offen offset:0 sc1
    s_waitcnt vmcnt(16)
    v_permlane16_swap_b32 v160, v164
    v_permlane16_swap_b32 v161, v165
    v_permlane16_swap_b32 v162, v166
    v_permlane16_swap_b32 v163, v167
    buffer_load_dwordx4 v[116:119], v1, s[48:51], s66 offen offset:1024 sc1
    buffer_load_dwordx4 v[232:235], v1, s[48:51], s67 offen offset:1024 sc1
    s_waitcnt vmcnt(16)
    v_permlane16_swap_b32 v168, v172
    v_permlane16_swap_b32 v169, v173
    v_permlane16_swap_b32 v170, v174
    v_permlane16_swap_b32 v171, v175
    s_add_u32 s66, s86, 7
    s_and_b32 s66, s66, 31
    s_lshl_b32 s66, s66, 11
    s_add_u32 s67, s66, 131072
    s_add_u32 s66, s66, 65536
    buffer_load_dwordx4 v[120:123], v1, s[48:51], s66 offen offset:0 sc1
    buffer_load_dwordx4 v[240:243], v1, s[48:51], s67 offen offset:0 sc1
    s_waitcnt vmcnt(16)
    v_permlane16_swap_b32 v176, v180
    v_permlane16_swap_b32 v177, v181
    v_permlane16_swap_b32 v178, v182
    v_permlane16_swap_b32 v179, v183
    buffer_load_dwordx4 v[124:127], v1, s[48:51], s66 offen offset:1024 sc1
    buffer_load_dwordx4 v[248:251], v1, s[48:51], s67 offen offset:1024 sc1
    s_waitcnt vmcnt(16)
    v_permlane16_swap_b32 v184, v188
    v_permlane16_swap_b32 v185, v189
    v_permlane16_swap_b32 v186, v190
    v_permlane16_swap_b32 v187, v191
    s_waitcnt lgkmcnt(0)
    v_mfma_f32_32x32x16_bf16 v[32:47], v[24:27], v[16:19], v[32:47]
    ds_read_b128 v[20:23], v11 offset:16384
    ds_read_b64_tr_b16 v[28:29], v13 offset:7168
    ds_read_b64_tr_b16 v[30:31], v13 offset:7424
    s_waitcnt lgkmcnt(0)
    v_mfma_f32_32x32x16_bf16 v[32:47], v[28:31], v[20:23], v[32:47]
    v_mov_b32 v58, 160872
    v_mov_b32 v59, 1
    s_mov_b64 exec, 1
    ds_add_u32 v58, v59
    s_mov_b64 exec, -1
    s_branch L_Ajoin_2
L_Aidle_1:
    s_cmp_eq_u32 s83, 14
    s_cselect_b32 s52, s20, s22
    s_cselect_b32 s53, s21, s23
    s_movk_i32 s54, 16384
    s_mov_b32 s55, 0x20000
    s_mov_b32 s87, 0
    s_mov_b32 s56, s34
    s_mov_b32 s57, s35
    s_mov_b32 s58, 0x400
    s_mov_b32 s59, 0x20000
    v_lshlrev_b32 v14, 4, v0
    s_add_u32 m0, s81, 98304
    s_add_u32 s66, s81, 0
    buffer_load_dwordx4 v14, s[56:59], s66 offen lds
    s_add_u32 m0, s81, 81920
    s_add_u32 s66, s81, 0
    buffer_load_dwordx4 v14, s[52:55], s66 offen lds
    s_add_u32 m0, s81, 86016
    s_add_u32 s66, s81, 4096
    buffer_load_dwordx4 v14, s[52:55], s66 offen lds
    s_add_u32 m0, s81, 90112
    s_add_u32 s66, s81, 8192
    buffer_load_dwordx4 v14, s[52:55], s66 offen lds
    s_add_u32 m0, s81, 94208
    s_add_u32 s66, s81, 12288
    buffer_load_dwordx4 v14, s[52:55], s66 offen lds
    s_add_u32 s77, s87, 0
    s_and_b32 s77, s77, 7
    s_lshl_b32 s78, s77, 16
    s_lshl_b32 s77, s77, 7
    s_add_u32 s77, s77, s84
    s_add_u32 s78, s78, s89
    s_add_u32 m0, s81, 0
    s_add_u32 s66, s77, 0
    buffer_load_dwordx4 v6, s[44:47], s66 offen lds
    s_add_u32 m0, s81, 4096
    s_add_u32 s66, s77, 32768
    buffer_load_dwordx4 v6, s[44:47], s66 offen lds
    s_add_u32 m0, s81, 8192
    s_add_u32 s66, s77, 65536
    buffer_load_dwordx4 v6, s[44:47], s66 offen lds
    s_add_u32 m0, s81, 12288
    s_add_u32 s66, s77, 98304
    buffer_load_dwordx4 v6, s[44:47], s66 offen lds
    s_add_u32 m0, s81, 65536
    s_nop 0
    buffer_load_dwordx4 v7, s[60:63], s78 offen lds
    s_add_u32 s77, s87, 1
    s_and_b32 s77, s77, 7
    s_lshl_b32 s78, s77, 16
    s_lshl_b32 s77, s77, 7
    s_add_u32 s77, s77, s84
    s_add_u32 s78, s78, s89
    s_add_u32 m0, s81, 16384
    s_add_u32 s66, s77, 0
    buffer_load_dwordx4 v6, s[44:47], s66 offen lds
    s_add_u32 m0, s81, 20480
    s_add_u32 s66, s77, 32768
    buffer_load_dwordx4 v6, s[44:47], s66 offen lds
    s_add_u32 m0, s81, 24576
    s_add_u32 s66, s77, 65536
    buffer_load_dwordx4 v6, s[44:47], s66 offen lds
    s_add_u32 m0, s81, 28672
    s_add_u32 s66, s77, 98304
    buffer_load_dwordx4 v6, s[44:47], s66 offen lds
    s_add_u32 m0, s81, 69632
    s_nop 0
    buffer_load_dwordx4 v7, s[60:63], s78 offen lds
    s_add_u32 s77, s87, 2
    s_and_b32 s77, s77, 7
    s_lshl_b32 s78, s77, 16
    s_lshl_b32 s77, s77, 7
    s_add_u32 s77, s77, s84
    s_add_u32 s78, s78, s89
    s_add_u32 m0, s81, 32768
    s_add_u32 s66, s77, 0
    buffer_load_dwordx4 v6, s[44:47], s66 offen lds
    s_add_u32 m0, s81, 36864
    s_add_u32 s66, s77, 32768
    buffer_load_dwordx4 v6, s[44:47], s66 offen lds
    s_add_u32 m0, s81, 40960
    s_add_u32 s66, s77, 65536
    buffer_load_dwordx4 v6, s[44:47], s66 offen lds
    s_add_u32 m0, s81, 45056
    s_add_u32 s66, s77, 98304
    buffer_load_dwordx4 v6, s[44:47], s66 offen lds
    s_add_u32 m0, s81, 73728
    s_nop 0
    buffer_load_dwordx4 v7, s[60:63], s78 offen lds
    s_add_u32 s77, s87, 3
    s_and_b32 s77, s77, 7
    s_lshl_b32 s78, s77, 16
    s_lshl_b32 s77, s77, 7
    s_add_u32 s77, s77, s84
    s_add_u32 s78, s78, s89
    s_add_u32 m0, s81, 49152
    s_add_u32 s66, s77, 0
    buffer_load_dwordx4 v6, s[44:47], s66 offen lds
    s_add_u32 m0, s81, 53248
    s_add_u32 s66, s77, 32768
    buffer_load_dwordx4 v6, s[44:47], s66 offen lds
    s_add_u32 m0, s81, 57344
    s_add_u32 s66, s77, 65536
    buffer_load_dwordx4 v6, s[44:47], s66 offen lds
    s_add_u32 m0, s81, 61440
    s_add_u32 s66, s77, 98304
    buffer_load_dwordx4 v6, s[44:47], s66 offen lds
    s_add_u32 m0, s81, 77824
    s_nop 0
    buffer_load_dwordx4 v7, s[60:63], s78 offen lds
    s_mov_b32 s48, s40
    s_mov_b32 s49, s41
    s_mov_b32 s50, 0x10000000
    s_mov_b32 s51, 0x20000
    s_lshl_b32 s68, s2, 5
    s_lshl_b32 s69, s64, 2
    s_add_u32 s68, s68, s69
    s_add_u32 s68, s68, 24576
    v_mov_b32 v21, 0
    s_waitcnt lgkmcnt(0)
    s_mul_i32 s65, s65, 0x9E3779B1
    s_add_u32 s65, s65, 0x7F4A7C15
    v_mov_b32 v20, s65
    s_mov_b64 exec, 1
    buffer_store_dword v20, v21, s[48:51], s68 offen sc1
    s_mov_b64 exec, -1
    s_lshl_b32 s66, s64, 12
    v_and_b32 v16, 31, v0
    v_lshrrev_b32 v17, 5, v0
    v_bfe_u32 v18, v0, 1, 3
    v_xor_b32 v18, v18, v17
    v_lshlrev_b32 v16, 7, v16
    v_add_u32 v16, s66, v16
    v_xor_b32 v8, 0, v18
    v_lshl_add_u32 v8, v8, 4, v16
    v_xor_b32 v9, 2, v18
    v_lshl_add_u32 v9, v9, 4, v16
    v_xor_b32 v10, 4, v18
    v_lshl_add_u32 v10, v10, 4, v16
    v_xor_b32 v11, 6, v18
    v_lshl_add_u32 v11, v11, 4, v16
    v_bfe_u32 v16, v0, 2, 2
    v_lshl_add_u32 v16, v17, 3, v16
    v_and_b32 v18, 3, v0
    v_lshlrev_b32 v18, 3, v18
    v_lshl_add_u32 v13, v16, 6, v18
    v_bfe_u32 v16, v0, 4, 1
    v_lshl_add_u32 v13, v16, 5, v13
    v_add_u32 v13, 65536, v13
    v_lshlrev_b32 v16, 2, v0
    v_add_u32 v16, 160832, v16
    v_mov_b32 v17, 0
    ds_write_b32 v16, v17
    v_lshlrev_b32 v1, 4, v0
    v_and_b32 v3, 31, v0
    v_lshlrev_b32 v3, 2, v3
    v_mov_b32 v2, 0xdddddddd
    v_add_u32 v12, 151552, v1
    v_lshlrev_b32 v62, 3, v0
    s_mov_b32 s90, 262144
    v_bfe_u32 v16, v0, 4, 1
    v_lshlrev_b32 v4, 10, v16
    v_and_b32 v16, 32, v0
    v_lshl_add_u32 v4, v16, 4, v4
    v_and_b32 v16, 15, v0
    v_lshl_add_u32 v4, v16, 4, v4
    v_lshlrev_b32 v5, 2, v16
    s_lshl_b32 s66, s64, 11
    s_add_u32 s66, s66, 151552
    v_add_u32 v57, s66, v4
    v_and_b32 v16, 11, v0
    v_cmp_eq_u32 vcc, 0, v16
    v_mov_b32 v16, 0x3f803f80
    s_nop 0
    v_cndmask_b32 v16, 0, v16, vcc
    v_mov_b32 v17, v16
    v_mov_b64 v[132:133], v[16:17]
    v_mov_b64 v[134:135], v[16:17]
    v_mov_b64 v[140:141], v[16:17]
    v_mov_b64 v[142:143], v[16:17]
    v_mov_b64 v[148:149], v[16:17]
    v_mov_b64 v[150:151], v[16:17]
    v_mov_b64 v[156:157], v[16:17]
    v_mov_b64 v[158:159], v[16:17]
    v_mov_b64 v[164:165], v[16:17]
    v_mov_b64 v[166:167], v[16:17]
    v_mov_b64 v[172:173], v[16:17]
    v_mov_b64 v[174:175], v[16:17]
    v_mov_b64 v[180:181], v[16:17]
    v_mov_b64 v[182:183], v[16:17]
    v_mov_b64 v[188:189], v[16:17]
    v_mov_b64 v[190:191], v[16:17]
    v_mov_b64 v[196:197], v[16:17]
    v_mov_b64 v[198:199], v[16:17]
    v_mov_b64 v[204:205], v[16:17]
    v_mov_b64 v[206:207], v[16:17]
    v_mov_b64 v[212:213], v[16:17]
    v_mov_b64 v[214:215], v[16:17]
    v_mov_b64 v[220:221], v[16:17]
    v_mov_b64 v[222:223], v[16:17]
    v_mov_b64 v[228:229], v[16:17]
    v_mov_b64 v[230:231], v[16:17]
    v_mov_b64 v[236:237], v[16:17]
    v_mov_b64 v[238:239], v[16:17]
    v_mov_b64 v[244:245], v[16:17]
    v_mov_b64 v[246:247], v[16:17]
    v_mov_b64 v[252:253], v[16:17]
    v_mov_b64 v[254:255], v[16:17]
    v_mov_b64 v[48:49], 0
    v_mov_b64 v[50:51], 0
    v_mov_b64 v[52:53], 0
    v_mov_b64 v[54:55], 0
    v_mov_b32 v56, 0
    s_lshl_b32 s66, s82, 2
    s_add_u32 s66, s66, s64
    s_lshl_b32 s88, s66, 15
    s_lshl_b32 s66, s83, 11
    s_add_u32 s88, s88, s66
    s_add_u32 s88, s88, 3145728
    s_lshl_b32 s86, s64, 3
    s_lshr_b32 s66, s80, 3
    s_add_u32 s86, s86, s66
    s_waitcnt vmcnt(16)
    s_waitcnt lgkmcnt(0)
    s_barrier
    ds_read_b128 v[16:19], v8 offset:0
    ds_read_b64_tr_b16 v[24:25], v13 offset:0
    ds_read_b64_tr_b16 v[26:27], v13 offset:256
    ds_read_b128 v[20:23], v9 offset:0
    ds_read_b64_tr_b16 v[28:29], v13 offset:1024
    ds_read_b64_tr_b16 v[30:31], v13 offset:1280
    s_waitcnt lgkmcnt(3)
    v_mfma_f32_32x32x16_bf16 v[32:47], v[24:27], v[16:19], 0
    ds_read_b128 v[16:19], v10 offset:0
    ds_read_b64_tr_b16 v[24:25], v13 offset:2048
    ds_read_b64_tr_b16 v[26:27], v13 offset:2304
    s_waitcnt lgkmcnt(3)
    v_mfma_f32_32x32x16_bf16 v[32:47], v[28:31], v[20:23], v[32:47]
    ds_read_b128 v[20:23], v11 offset:0
    ds_read_b64_tr_b16 v[28:29], v13 offset:3072
    ds_read_b64_tr_b16 v[30:31], v13 offset:3328
    s_waitcnt lgkmcnt(3)
    v_mfma_f32_32x32x16_bf16 v[32:47], v[24:27], v[16:19], v[32:47]
    s_waitcnt lgkmcnt(0)
    v_mfma_f32_32x32x16_bf16 v[32:47], v[28:31], v[20:23], v[32:47]
    s_waitcnt vmcnt(11)
    s_waitcnt lgkmcnt(0)
    s_barrier
    s_add_u32 s77, s87, 4
    s_and_b32 s77, s77, 7
    s_lshl_b32 s78, s77, 16
    s_lshl_b32 s77, s77, 7
    s_add_u32 s77, s77, s84
    s_add_u32 s78, s78, s89
    s_add_u32 m0, s81, 0
    s_add_u32 s66, s77, 0
    buffer_load_dwordx4 v6, s[44:47], s66 offen lds
    s_add_u32 m0, s81, 4096
    s_add_u32 s66, s77, 32768
    buffer_load_dwordx4 v6, s[44:47], s66 offen lds
    s_add_u32 m0, s81, 8192
    s_add_u32 s66, s77, 65536
    buffer_load_dwordx4 v6, s[44:47], s66 offen lds
    s_add_u32 m0, s81, 12288
    s_add_u32 s66, s77, 98304
    buffer_load_dwordx4 v6, s[44:47], s66 offen lds
    s_add_u32 m0, s81, 65536
    s_nop 0
    buffer_load_dwordx4 v7, s[60:63], s78 offen lds
    ds_read_b128 v[16:19], v8 offset:16384
    ds_read_b64_tr_b16 v[24:25], v13 offset:4096
    ds_read_b64_tr_b16 v[26:27], v13 offset:4352
    ds_read_b128 v[20:23], v9 offset:16384
    ds_read_b64_tr_b16 v[28:29], v13 offset:5120
    ds_read_b64_tr_b16 v[30:31], v13 offset:5376
    s_waitcnt lgkmcnt(3)
    v_mfma_f32_32x32x16_bf16 v[32:47], v[24:27], v[16:19], v[32:47]
    ds_read_b128 v[16:19], v10 offset:16384
    ds_read_b64_tr_b16 v[24:25], v13 offset:6144
    ds_read_b64_tr_b16 v[26:27], v13 offset:6400
    s_waitcnt lgkmcnt(3)
    v_mfma_f32_32x32x16_bf16 v[32:47], v[28:31], v[20:23], v[32:47]
    ds_read_b128 v[20:23], v11 offset:16384
    ds_read_b64_tr_b16 v[28:29], v13 offset:7168
    ds_read_b64_tr_b16 v[30:31], v13 offset:7424
    s_waitcnt lgkmcnt(3)
    v_mfma_f32_32x32x16_bf16 v[32:47], v[24:27], v[16:19], v[32:47]
    s_waitcnt lgkmcnt(0)
    v_mfma_f32_32x32x16_bf16 v[32:47], v[28:31], v[20:23], v[32:47]
    s_waitcnt vmcnt(11)
    s_waitcnt lgkmcnt(0)
    s_barrier
    s_add_u32 s77, s87, 5
    s_and_b32 s77, s77, 7
    s_lshl_b32 s78, s77, 16
    s_lshl_b32 s77, s77, 7
    s_add_u32 s77, s77, s84
    s_add_u32 s78, s78, s89
    s_add_u32 m0, s81, 16384
    s_add_u32 s66, s77, 0
    buffer_load_dwordx4 v6, s[44:47], s66 offen lds
    s_add_u32 m0, s81, 20480
    s_add_u32 s66, s77, 32768
    buffer_load_dwordx4 v6, s[44:47], s66 offen lds
    s_add_u32 m0, s81, 24576
    s_add_u32 s66, s77, 65536
    buffer_load_dwordx4 v6, s[44:47], s66 offen lds
    s_add_u32 m0, s81, 28672
    s_add_u32 s66, s77, 98304
    buffer_load_dwordx4 v6, s[44:47], s66 offen lds
    s_add_u32 m0, s81, 69632
    s_nop 0
    buffer_load_dwordx4 v7, s[60:63], s78 offen lds
    ds_read_b128 v[16:19], v8 offset:32768
    ds_read_b64_tr_b16 v[24:25], v13 offset:8192
    ds_read_b64_tr_b16 v[26:27], v13 offset:8448
    ds_read_b128 v[20:23], v9 offset:32768
    ds_read_b64_tr_b16 v[28:29], v13 offset:9216
    ds_read_b64_tr_b16 v[30:31], v13 offset:9472
    s_waitcnt lgkmcnt(3)
    v_mfma_f32_32x32x16_bf16 v[32:47], v[24:27], v[16:19], v[32:47]
    ds_read_b128 v[16:19], v10 offset:32768
    ds_read_b64_tr_b16 v[24:25], v13 offset:10240
    ds_read_b64_tr_b16 v[26:27], v13 offset:10496
    s_waitcnt lgkmcnt(3)
    v_mfma_f32_32x32x16_bf16 v[32:47], v[28:31], v[20:23], v[32:47]
    ds_read_b128 v[20:23], v11 offset:32768
    ds_read_b64_tr_b16 v[28:29], v13 offset:11264
    ds_read_b64_tr_b16 v[30:31], v13 offset:11520
    s_waitcnt lgkmcnt(3)
    v_mfma_f32_32x32x16_bf16 v[32:47], v[24:27], v[16:19], v[32:47]
    s_waitcnt lgkmcnt(0)
    v_mfma_f32_32x32x16_bf16 v[32:47], v[28:31], v[20:23], v[32:47]
    s_waitcnt vmcnt(11)
    s_waitcnt lgkmcnt(0)
    s_barrier
    s_add_u32 s77, s87, 6
    s_and_b32 s77, s77, 7
    s_lshl_b32 s78, s77, 16
    s_lshl_b32 s77, s77, 7
    s_add_u32 s77, s77, s84
    s_add_u32 s78, s78, s89
    s_add_u32 m0, s81, 32768
    s_add_u32 s66, s77, 0
    buffer_load_dwordx4 v6, s[44:47], s66 offen lds
    s_add_u32 m0, s81, 36864
    s_add_u32 s66, s77, 32768
    buffer_load_dwordx4 v6, s[44:47], s66 offen lds
    s_add_u32 m0, s81, 40960
    s_add_u32 s66, s77, 65536
    buffer_load_dwordx4 v6, s[44:47], s66 offen lds
    s_add_u32 m0, s81, 45056
    s_add_u32 s66, s77, 98304
    buffer_load_dwordx4 v6, s[44:47], s66 offen lds
    s_add_u32 m0, s81, 73728
    s_nop 0
    buffer_load_dwordx4 v7, s[60:63], s78 offen lds
    ds_read_b128 v[16:19], v8 offset:49152
    ds_read_b64_tr_b16 v[24:25], v13 offset:12288
    ds_read_b64_tr_b16 v[26:27], v13 offset:12544
    ds_read_b128 v[20:23], v9 offset:49152
    ds_read_b64_tr_b16 v[28:29], v13 offset:13312
    ds_read_b64_tr_b16 v[30:31], v13 offset:13568
    s_waitcnt lgkmcnt(3)
    v_mfma_f32_32x32x16_bf16 v[32:47], v[24:27], v[16:19], v[32:47]
    ds_read_b128 v[16:19], v10 offset:49152
    ds_read_b64_tr_b16 v[24:25], v13 offset:14336
    ds_read_b64_tr_b16 v[26:27], v13 offset:14592
    s_waitcnt lgkmcnt(3)
    v_mfma_f32_32x32x16_bf16 v[32:47], v[28:31], v[20:23], v[32:47]
    ds_read_b128 v[20:23], v11 offset:49152
    ds_read_b64_tr_b16 v[28:29], v13 offset:15360
    ds_read_b64_tr_b16 v[30:31], v13 offset:15616
    s_waitcnt lgkmcnt(3)
    v_mfma_f32_32x32x16_bf16 v[32:47], v[24:27], v[16:19], v[32:47]
    s_waitcnt lgkmcnt(0)
    v_mfma_f32_32x32x16_bf16 v[32:47], v[28:31], v[20:23], v[32:47]
    s_waitcnt vmcnt(10)
    s_waitcnt lgkmcnt(0)
    s_barrier
    s_add_u32 s77, s87, 7
    s_and_b32 s77, s77, 7
    s_lshl_b32 s78, s77, 16
    s_lshl_b32 s77, s77, 7
    s_add_u32 s77, s77, s84
    s_add_u32 s78, s78, s89
    s_add_u32 m0, s81, 49152
    s_add_u32 s66, s77, 0
    buffer_load_dwordx4 v6, s[44:47], s66 offen lds
    s_add_u32 m0, s81, 53248
    s_add_u32 s66, s77, 32768
    buffer_load_dwordx4 v6, s[44:47], s66 offen lds
    s_add_u32 m0, s81, 57344
    s_add_u32 s66, s77, 65536
    buffer_load_dwordx4 v6, s[44:47], s66 offen lds
    s_add_u32 m0, s81, 61440
    s_add_u32 s66, s77, 98304
    buffer_load_dwordx4 v6, s[44:47], s66 offen lds
    s_add_u32 m0, s81, 77824
    s_nop 0
    buffer_load_dwordx4 v7, s[60:63], s78 offen lds
    ds_read_b128 v[16:19], v8 offset:0
    ds_read_b64_tr_b16 v[24:25], v13 offset:0
    ds_read_b64_tr_b16 v[26:27], v13 offset:256
    ds_read_b128 v[20:23], v9 offset:0
    ds_read_b64_tr_b16 v[28:29], v13 offset:1024
    ds_read_b64_tr_b16 v[30:31], v13 offset:1280
    s_waitcnt lgkmcnt(3)
    v_mfma_f32_32x32x16_bf16 v[32:47], v[24:27], v[16:19], v[32:47]
    ds_read_b128 v[16:19], v10 offset:0
    ds_read_b64_tr_b16 v[24:25], v13 offset:2048
    ds_read_b64_tr_b16 v[26:27], v13 offset:2304
    s_waitcnt lgkmcnt(3)
    v_mfma_f32_32x32x16_bf16 v[32:47], v[28:31], v[20:23], v[32:47]
    ds_read_b128 v[20:23], v11 offset:0
    ds_read_b64_tr_b16 v[28:29], v13 offset:3072
    ds_read_b64_tr_b16 v[30:31], v13 offset:3328
    s_waitcnt lgkmcnt(3)
    v_mfma_f32_32x32x16_bf16 v[32:47], v[24:27], v[16:19], v[32:47]
    s_waitcnt lgkmcnt(0)
    v_mfma_f32_32x32x16_bf16 v[32:47], v[28:31], v[20:23], v[32:47]
    s_waitcnt vmcnt(10)
    s_waitcnt lgkmcnt(0)
    s_barrier
    ds_read_b128 v[16:19], v8 offset:16384
    ds_read_b64_tr_b16 v[24:25], v13 offset:4096
    ds_read_b64_tr_b16 v[26:27], v13 offset:4352
    ds_read_b128 v[20:23], v9 offset:16384
    ds_read_b64_tr_b16 v[28:29], v13 offset:5120
    ds_read_b64_tr_b16 v[30:31], v13 offset:5376
    s_waitcnt lgkmcnt(3)
    v_mfma_f32_32x32x16_bf16 v[32:47], v[24:27], v[16:19], v[32:47]
    ds_read_b128 v[16:19], v10 offset:16384
    ds_read_b64_tr_b16 v[24:25], v13 offset:6144
    ds_read_b64_tr_b16 v[26:27], v13 offset:6400
    s_waitcnt lgkmcnt(3)
    v_mfma_f32_32x32x16_bf16 v[32:47], v[28:31], v[20:23], v[32:47]
    ds_read_b128 v[20:23], v11 offset:16384
    ds_read_b64_tr_b16 v[28:29], v13 offset:7168
    ds_read_b64_tr_b16 v[30:31], v13 offset:7424
    s_waitcnt lgkmcnt(3)
    v_mfma_f32_32x32x16_bf16 v[32:47], v[24:27], v[16:19], v[32:47]
    s_waitcnt lgkmcnt(0)
    v_mfma_f32_32x32x16_bf16 v[32:47], v[28:31], v[20:23], v[32:47]
    s_waitcnt vmcnt(5)
    s_waitcnt lgkmcnt(0)
    s_barrier
    ds_read_b128 v[16:19], v8 offset:32768
    ds_read_b64_tr_b16 v[24:25], v13 offset:8192
    ds_read_b64_tr_b16 v[26:27], v13 offset:8448
    ds_read_b128 v[20:23], v9 offset:32768
    ds_read_b64_tr_b16 v[28:29], v13 offset:9216
    ds_read_b64_tr_b16 v[30:31], v13 offset:9472
    s_waitcnt lgkmcnt(3)
    v_mfma_f32_32x32x16_bf16 v[32:47], v[24:27], v[16:19], v[32:47]
    ds_read_b128 v[16:19], v10 offset:32768
    ds_read_b64_tr_b16 v[24:25], v13 offset:10240
    ds_read_b64_tr_b16 v[26:27], v13 offset:10496
    s_waitcnt lgkmcnt(3)
    v_mfma_f32_32x32x16_bf16 v[32:47], v[28:31], v[20:23], v[32:47]
    ds_read_b128 v[20:23], v11 offset:32768
    ds_read_b64_tr_b16 v[28:29], v13 offset:11264
    ds_read_b64_tr_b16 v[30:31], v13 offset:11520
    s_waitcnt lgkmcnt(3)
    v_mfma_f32_32x32x16_bf16 v[32:47], v[24:27], v[16:19], v[32:47]
    s_waitcnt lgkmcnt(0)
    v_mfma_f32_32x32x16_bf16 v[32:47], v[28:31], v[20:23], v[32:47]
    s_waitcnt vmcnt(0)
    s_waitcnt lgkmcnt(0)
    s_barrier
    ds_read_b128 v[16:19], v8 offset:49152
    ds_read_b64_tr_b16 v[24:25], v13 offset:12288
    ds_read_b64_tr_b16 v[26:27], v13 offset:12544
    ds_read_b128 v[20:23], v9 offset:49152
    ds_read_b64_tr_b16 v[28:29], v13 offset:13312
    ds_read_b64_tr_b16 v[30:31], v13 offset:13568
    s_waitcnt lgkmcnt(3)
    v_mfma_f32_32x32x16_bf16 v[32:47], v[24:27], v[16:19], v[32:47]
    ds_read_b128 v[16:19], v10 offset:49152
    ds_read_b64_tr_b16 v[24:25], v13 offset:14336
    ds_read_b64_tr_b16 v[26:27], v13 offset:14592
    s_waitcnt lgkmcnt(3)
    v_mfma_f32_32x32x16_bf16 v[32:47], v[28:31], v[20:23], v[32:47]
    ds_read_b128 v[20:23], v11 offset:49152
    ds_read_b64_tr_b16 v[28:29], v13 offset:15360
    ds_read_b64_tr_b16 v[30:31], v13 offset:15616
    s_waitcnt lgkmcnt(3)
    v_mfma_f32_32x32x16_bf16 v[32:47], v[24:27], v[16:19], v[32:47]
    s_waitcnt lgkmcnt(0)
    v_mfma_f32_32x32x16_bf16 v[32:47], v[28:31], v[20:23], v[32:47]
    s_cmp_lg_u32 s64, 0
    s_cbranch_scc1 L_norec_9
    s_mov_b32 s76, 0x40000
L_poll_11:
    buffer_load_dwordx2 v[58:59], v62, s[48:51], s90 offen sc1
    buffer_load_dwordx2 v[60:61], v62, s[48:51], s90 offen offset:512 sc1
    s_waitcnt vmcnt(0)
    v_cmp_ne_u32 vcc, s65, v58
    v_cmp_ne_u32 s[78:79], s65, v60
    s_or_b64 vcc, vcc, s[78:79]
    s_cbranch_vccz L_polled_12
    s_sleep 8
    s_sub_u32 s76, s76, 1
    s_cmp_lg_u32 s76, 0
    s_cbranch_scc1 L_poll_11
L_polled_12:
L_seen_10:
    v_cmp_lt_u32 vcc, 0x58800000, v61
    v_mov_b32 v58, 0x7f800000
    s_nop 0
    v_cndmask_b32 v59, v59, v58, vcc
    s_nop 1
    v_max_u32_dpp v59, v59, v59 row_shr:1
    s_nop 1
    v_max_u32_dpp v59, v59, v59 row_shr:2
    s_nop 1
    v_max_u32_dpp v59, v59, v59 row_shr:4
    s_nop 1
    v_max_u32_dpp v59, v59, v59 row_shr:8
    s_nop 1
    v_max_u32_dpp v59, v59, v59 row_bcast:15 row_mask:0xa
    s_nop 1
    v_max_u32_dpp v59, v59, v59 row_bcast:31 row_mask:0xc
    v_mov_b32 v58, 160768
    s_mov_b32 exec_lo, 0
    s_mov_b32 exec_hi, 0x80000000
    ds_write_b32 v58, v59
    s_mov_b64 exec, -1
L_norec_9:
    v_mov_b32 v58, 160872
    v_mov_b32 v59, 2
    s_mov_b64 exec, 1
    ds_add_u32 v58, v59
    s_mov_b64 exec, -1
    s_waitcnt lgkmcnt(0)
    s_barrier
    s_add_u32 s66, s86, 0
    s_and_b32 s66, s66, 31
    s_lshl_b32 s66, s66, 11
    s_add_u32 s67, s66, 131072
    s_add_u32 s66, s66, 65536
    buffer_load_dwordx4 v[64:67], v1, s[48:51], s66 offen offset:0 sc1
    buffer_load_dwordx4 v[128:131], v1, s[48:51], s67 offen offset:0 sc1
    buffer_load_dwordx4 v[68:71], v1, s[48:51], s66 offen offset:1024 sc1
    buffer_load_dwordx4 v[136:139], v1, s[48:51], s67 offen offset:1024 sc1
    s_add_u32 s66, s86, 1
    s_and_b32 s66, s66, 31
    s_lshl_b32 s66, s66, 11
    s_add_u32 s67, s66, 131072
    s_add_u32 s66, s66, 65536
    buffer_load_dwordx4 v[72:75], v1, s[48:51], s66 offen offset:0 sc1
    buffer_load_dwordx4 v[144:147], v1, s[48:51], s67 offen offset:0 sc1
    buffer_load_dwordx4 v[76:79], v1, s[48:51], s66 offen offset:1024 sc1
    buffer_load_dwordx4 v[152:155], v1, s[48:51], s67 offen offset:1024 sc1
    s_add_u32 s66, s86, 2
    s_and_b32 s66, s66, 31
    s_lshl_b32 s66, s66, 11
    s_add_u32 s67, s66, 131072
    s_add_u32 s66, s66, 65536
    buffer_load_dwordx4 v[80:83], v1, s[48:51], s66 offen offset:0 sc1
    buffer_load_dwordx4 v[160:163], v1, s[48:51], s67 offen offset:0 sc1
    buffer_load_dwordx4 v[84:87], v1, s[48:51], s66 offen offset:1024 sc1
    buffer_load_dwordx4 v[168:171], v1, s[48:51], s67 offen offset:1024 sc1
    s_add_u32 s66, s86, 3
    s_and_b32 s66, s66, 31
    s_lshl_b32 s66, s66, 11
    s_add_u32 s67, s66, 131072
    s_add_u32 s66, s66, 65536
    buffer_load_dwordx4 v[88:91], v1, s[48:51], s66 offen offset:0 sc1
    buffer_load_dwordx4 v[176:179], v1, s[48:51], s67 offen offset:0 sc1
    buffer_load_dwordx4 v[92:95], v1, s[48:51], s66 offen offset:1024 sc1
    buffer_load_dwordx4 v[184:187], v1, s[48:51], s67 offen offset:1024 sc1
    s_add_u32 s66, s86, 4
    s_and_b32 s66, s66, 31
    s_lshl_b32 s66, s66, 11
    s_add_u32 s67, s66, 131072
    s_add_u32 s66, s66, 65536
    buffer_load_dwordx4 v[96:99], v1, s[48:51], s66 offen offset:0 sc1
    buffer_load_dwordx4 v[192:195], v1, s[48:51], s67 offen offset:0 sc1
    s_waitcnt vmcnt(16)
    v_permlane16_swap_b32 v128, v132
    v_permlane16_swap_b32 v129, v133
    v_permlane16_swap_b32 v130, v134
    v_permlane16_swap_b32 v131, v135
    buffer_load_dwordx4 v[100:103], v1, s[48:51], s66 offen offset:1024 sc1
    buffer_load_dwordx4 v[200:203], v1, s[48:51], s67 offen offset:1024 sc1
    s_waitcnt vmcnt(16)
    v_permlane16_swap_b32 v136, v140
    v_permlane16_swap_b32 v137, v141
    v_permlane16_swap_b32 v138, v142
    v_permlane16_swap_b32 v139, v143
    s_add_u32 s66, s86, 5
    s_and_b32 s66, s66, 31
    s_lshl_b32 s66, s66, 11
    s_add_u32 s67, s66, 131072
    s_add_u32 s66, s66, 65536
    buffer_load_dwordx4 v[104:107], v1, s[48:51], s66 offen offset:0 sc1
    buffer_load_dwordx4 v[208:211], v1, s[48:51], s67 offen offset:0 sc1
    s_waitcnt vmcnt(16)
    v_permlane16_swap_b32 v144, v148
    v_permlane16_swap_b32 v145, v149
    v_permlane16_swap_b32 v146, v150
    v_permlane16_swap_b32 v147, v151
    buffer_load_dwordx4 v[108:111], v1, s[48:51], s66 offen offset:1024 sc1
    buffer_load_dwordx4 v[216:219], v1, s[48:51], s67 offen offset:1024 sc1
    s_waitcnt vmcnt(16)
    v_permlane16_swap_b32 v152, v156
    v_permlane16_swap_b32 v153, v157
    v_permlane16_swap_b32 v154, v158
    v_permlane16_swap_b32 v155, v159
    s_add_u32 s66, s86, 6
    s_and_b32 s66, s66, 31
    s_lshl_b32 s66, s66, 11
    s_add_u32 s67, s66, 131072
    s_add_u32 s66, s66, 65536
    buffer_load_dwordx4 v[112:115], v1, s[48:51], s66 offen offset:0 sc1
    buffer_load_dwordx4 v[224:227], v1, s[48:51], s67 offen offset:0 sc1
    s_waitcnt vmcnt(16)
    v_permlane16_swap_b32 v160, v164
    v_permlane16_swap_b32 v161, v165
    v_permlane16_swap_b32 v162, v166
    v_permlane16_swap_b32 v163, v167
    buffer_load_dwordx4 v[116:119], v1, s[48:51], s66 offen offset:1024 sc1
    buffer_load_dwordx4 v[232:235], v1, s[48:51], s67 offen offset:1024 sc1
    s_waitcnt vmcnt(16)
    v_permlane16_swap_b32 v168, v172
    v_permlane16_swap_b32 v169, v173
    v_permlane16_swap_b32 v170, v174
    v_permlane16_swap_b32 v171, v175
    s_add_u32 s66, s86, 7
    s_and_b32 s66, s66, 31
    s_lshl_b32 s66, s66, 11
    s_add_u32 s67, s66, 131072
    s_add_u32 s66, s66, 65536
    buffer_load_dwordx4 v[120:123], v1, s[48:51], s66 offen offset:0 sc1
    buffer_load_dwordx4 v[240:243], v1, s[48:51], s67 offen offset:0 sc1
    s_waitcnt vmcnt(16)
    v_permlane16_swap_b32 v176, v180
    v_permlane16_swap_b32 v177, v181
    v_permlane16_swap_b32 v178, v182
    v_permlane16_swap_b32 v179, v183
    buffer_load_dwordx4 v[124:127], v1, s[48:51], s66 offen offset:1024 sc1
    buffer_load_dwordx4 v[248:251], v1, s[48:51], s67 offen offset:1024 sc1
    s_waitcnt vmcnt(16)
    v_permlane16_swap_b32 v184, v188
    v_permlane16_swap_b32 v185, v189
    v_permlane16_swap_b32 v186, v190
    v_permlane16_swap_b32 v187, v191
L_Ajoin_2:
    s_lshl_b32 s66, s82, 2
    s_add_u32 s66, s66, s64
    s_lshl_b32 s84, s66, 7
    s_add_u32 s84, s84, 196608
    s_nop 7
    s_lshl_b32 s66, s64, 8
    s_add_u32 s66, s66, 159744
    v_lshl_add_u32 v15, v0, 2, s66
    v_cvt_pk_bf16_f32 v16, v32, v33
    v_cvt_pk_bf16_f32 v17, v34, v35
    v_cvt_pk_bf16_f32 v18, v36, v37
    v_cvt_pk_bf16_f32 v19, v38, v39
    v_cvt_pk_bf16_f32 v20, v40, v41
    v_cvt_pk_bf16_f32 v21, v42, v43
    v_cvt_pk_bf16_f32 v22, v44, v45
    v_cvt_pk_bf16_f32 v23, v46, v47
    ds_write_b128 v57, v[16:19]
    ds_write_b128 v57, v[20:23] offset:256
    v_mul_f32 v24, v32, v32
    v_mul_f32 v25, v40, v40
    v_fmac_f32 v24, v33, v33
    v_fmac_f32 v25, v41, v41
    v_fmac_f32 v24, v34, v34
    v_fmac_f32 v25, v42, v42
    v_fmac_f32 v24, v35, v35
    v_fmac_f32 v25, v43, v43
    v_fmac_f32 v24, v36, v36
    v_fmac_f32 v25, v44, v44
    v_fmac_f32 v24, v37, v37
    v_fmac_f32 v25, v45, v45
    v_fmac_f32 v24, v38, v38
    v_fmac_f32 v25, v46, v46
    v_fmac_f32 v24, v39, v39
    v_fmac_f32 v25, v47, v47
    v_mov_b32 v26, 160768
    s_nop 0
    v_permlane32_swap_b32 v24, v25
    v_add_f32 v24, v24, v25
    ds_write_b32 v15, v24
    v_lshlrev_b32 v15, 2, v0
    v_add_u32 v15, 159744, v15
    v_mov_b32 v27, 160832
    v_mov_b32 v28, 1
    s_mov_b64 exec, 1
    ds_add_u32 v27, v28
    s_mov_b64 exec, -1
    s_mul_i32 s66, s64, 2176
    s_add_u32 s66, s66, 81920
    v_add_u32 v1, s66, v1
    v_add_u32 v3, s66, v3
L_qsync_13:
    ds_read_b32 v28, v27
    s_waitcnt lgkmcnt(0)
    v_readfirstlane_b32 s66, v28
    s_cmp_lt_u32 s66, 4
    s_cbranch_scc1 L_qsync_13
    v_mov_b32 v27, 160872
L_ringdead_14:
    ds_read_b32 v28, v27
    s_waitcnt lgkmcnt(0)
    v_readfirstlane_b32 s66, v28
    s_cmp_lt_u32 s66, 8
    s_cbranch_scc1 L_ringdead_14
    ds_read_b128 v[8:11], v12
    ds_read2st64_b32 v[20:21], v15 offset0:0 offset1:1
    ds_read2st64_b32 v[22:23], v15 offset0:2 offset1:3
    ds_read_b32 v24, v26
    s_waitcnt lgkmcnt(0)
    v_max3_u32 v20, v20, v21, v22
    v_max_u32 v20, v20, v23
    v_mul_f32 v20, v20, v24
    v_cmp_nge_f32 vcc, 0x45610000, v20
    s_setprio 1
    s_cbranch_vccnz L_slow_15
    s_waitcnt vmcnt(31)
    v_mfma_f32_32x32x16_bf16 v[16:31], v[64:67], v[8:11], 0
    s_nop 11
    v_exp_f32 v16, v16
    v_exp_f32 v17, v17
    v_exp_f32 v18, v18
    v_exp_f32 v19, v19
    v_exp_f32 v20, v20
    v_mfma_f32_32x32x16_bf16 v[32:47], v[68:71], v[8:11], 0
    v_exp_f32 v21, v21
    v_exp_f32 v22, v22
    v_exp_f32 v23, v23
    v_exp_f32 v24, v24
    v_exp_f32 v25, v25
    v_exp_f32 v26, v26
    v_exp_f32 v27, v27
    v_exp_f32 v28, v28
    v_exp_f32 v29, v29
    v_exp_f32 v30, v30
    v_exp_f32 v31, v31
    s_nop 0
    v_exp_f32 v32, v32
    v_exp_f32 v33, v33
    v_smfmac_f32_32x32x32_bf16 v[48:63], v[128:131], v[16:23], v2
    v_exp_f32 v34, v34
    v_exp_f32 v35, v35
    v_exp_f32 v36, v36
    v_smfmac_f32_32x32x32_bf16 v[48:63], v[132:135], v[24:31], v2
    v_exp_f32 v37, v37
    v_exp_f32 v38, v38
    v_exp_f32 v39, v39
    v_mfma_f32_32x32x16_bf16 v[16:31], v[72:75], v[8:11], 0
    v_exp_f32 v40, v40
    v_exp_f32 v41, v41
    v_exp_f32 v42, v42
    v_smfmac_f32_32x32x32_bf16 v[48:63], v[136:139], v[32:39], v2
    v_exp_f32 v43, v43
    v_exp_f32 v44, v44
    v_exp_f32 v45, v45
    v_exp_f32 v46, v46
    v_exp_f32 v47, v47
    s_nop 2
    v_exp_f32 v16, v16
    v_exp_f32 v17, v17
    v_smfmac_f32_32x32x32_bf16 v[48:63], v[140:143], v[40:47], v2
    v_exp_f32 v18, v18
    v_exp_f32 v19, v19
    v_exp_f32 v20, v20
    v_mfma_f32_32x32x16_bf16 v[32:47], v[76:79], v[8:11], 0
    v_exp_f32 v21, v21
    v_exp_f32 v22, v22
    v_exp_f32 v23, v23
    v_exp_f32 v24, v24
    v_exp_f32 v25, v25
    v_exp_f32 v26, v26
    v_smfmac_f32_32x32x32_bf16 v[48:63], v[144:147], v[16:23], v2
    v_exp_f32 v27, v27
    v_exp_f32 v28, v28
    v_exp_f32 v29, v29
    v_exp_f32 v30, v30
    v_exp_f32 v31, v31
    v_exp_f32 v32, v32
    v_exp_f32 v33, v33
    v_smfmac_f32_32x32x32_bf16 v[48:63], v[148:151], v[24:31], v2
    v_exp_f32 v34, v34
    v_exp_f32 v35, v35
    v_exp_f32 v36, v36
    v_mfma_f32_32x32x16_bf16 v[16:31], v[80:83], v[8:11], 0
    v_exp_f32 v37, v37
    v_exp_f32 v38, v38
    v_exp_f32 v39, v39
    v_exp_f32 v40, v40
    v_exp_f32 v41, v41
    v_exp_f32 v42, v42
    v_smfmac_f32_32x32x32_bf16 v[48:63], v[152:155], v[32:39], v2
    v_exp_f32 v43, v43
    v_exp_f32 v44, v44
    v_exp_f32 v45, v45
    v_exp_f32 v46, v46
    v_exp_f32 v47, v47
    v_exp_f32 v16, v16
    v_exp_f32 v17, v17
    v_smfmac_f32_32x32x32_bf16 v[48:63], v[156:159], v[40:47], v2
    v_exp_f32 v18, v18
    v_exp_f32 v19, v19
    v_exp_f32 v20, v20
    v_mfma_f32_32x32x16_bf16 v[32:47], v[84:87], v[8:11], 0
    v_exp_f32 v21, v21
    v_exp_f32 v22, v22
    v_exp_f32 v23, v23
    v_exp_f32 v24, v24
    v_exp_f32 v25, v25
    v_exp_f32 v26, v26
    v_smfmac_f32_32x32x32_bf16 v[48:63], v[160:163], v[16:23], v2
    v_exp_f32 v27, v27
    v_exp_f32 v28, v28
    v_exp_f32 v29, v29
    v_exp_f32 v30, v30
    v_exp_f32 v31, v31
    v_exp_f32 v32, v32
    v_exp_f32 v33, v33
    v_smfmac_f32_32x32x32_bf16 v[48:63], v[164:167], v[24:31], v2
    v_exp_f32 v34, v34
    v_exp_f32 v35, v35
    v_exp_f32 v36, v36
    v_mfma_f32_32x32x16_bf16 v[16:31], v[88:91], v[8:11], 0
    v_exp_f32 v37, v37
    v_exp_f32 v38, v38
    v_exp_f32 v39, v39
    v_exp_f32 v40, v40
    v_exp_f32 v41, v41
    v_exp_f32 v42, v42
    v_smfmac_f32_32x32x32_bf16 v[48:63], v[168:171], v[32:39], v2
    v_exp_f32 v43, v43
    v_exp_f32 v44, v44
    v_exp_f32 v45, v45
    v_exp_f32 v46, v46
    v_exp_f32 v47, v47
    v_exp_f32 v16, v16
    v_exp_f32 v17, v17
    v_smfmac_f32_32x32x32_bf16 v[48:63], v[172:175], v[40:47], v2
    v_exp_f32 v18, v18
    v_exp_f32 v19, v19
    v_exp_f32 v20, v20
    v_mfma_f32_32x32x16_bf16 v[32:47], v[92:95], v[8:11], 0
    v_exp_f32 v21, v21
    v_exp_f32 v22, v22
    v_exp_f32 v23, v23
    v_exp_f32 v24, v24
    v_exp_f32 v25, v25
    v_exp_f32 v26, v26
    v_smfmac_f32_32x32x32_bf16 v[48:63], v[176:179], v[16:23], v2
    v_exp_f32 v27, v27
    v_exp_f32 v28, v28
    v_exp_f32 v29, v29
    v_exp_f32 v30, v30
    v_exp_f32 v31, v31
    v_exp_f32 v32, v32
    v_exp_f32 v33, v33
    v_smfmac_f32_32x32x32_bf16 v[48:63], v[180:183], v[24:31], v2
    v_exp_f32 v34, v34
    v_exp_f32 v35, v35
    v_exp_f32 v36, v36
    s_waitcnt vmcnt(15)
    v_mfma_f32_32x32x16_bf16 v[16:31], v[96:99], v[8:11], 0
    v_exp_f32 v37, v37
    v_exp_f32 v38, v38
    v_exp_f32 v39, v39
    v_exp_f32 v40, v40
    v_exp_f32 v41, v41
    v_exp_f32 v42, v42
    v_smfmac_f32_32x32x32_bf16 v[48:63], v[184:187], v[32:39], v2
    v_exp_f32 v43, v43
    v_exp_f32 v44, v44
    v_exp_f32 v45, v45
    v_exp_f32 v46, v46
    v_exp_f32 v47, v47
    v_exp_f32 v16, v16
    v_exp_f32 v17, v17
    v_smfmac_f32_32x32x32_bf16 v[48:63], v[188:191], v[40:47], v2
    v_exp_f32 v18, v18
    v_exp_f32 v19, v19
    v_exp_f32 v20, v20
    s_waitcnt vmcnt(13)
    v_permlane16_swap_b32 v192, v196
    v_permlane16_swap_b32 v193, v197
    v_permlane16_swap_b32 v194, v198
    v_permlane16_swap_b32 v195, v199
    v_mfma_f32_32x32x16_bf16 v[32:47], v[100:103], v[8:11], 0
    v_exp_f32 v21, v21
    v_exp_f32 v22, v22
    v_exp_f32 v23, v23
    v_exp_f32 v24, v24
    v_exp_f32 v25, v25
    v_exp_f32 v26, v26
    v_smfmac_f32_32x32x32_bf16 v[48:63], v[192:195], v[16:23], v2
    v_exp_f32 v27, v27
    v_exp_f32 v28, v28
    v_exp_f32 v29, v29
    v_exp_f32 v30, v30
    v_exp_f32 v31, v31
    v_exp_f32 v32, v32
    v_exp_f32 v33, v33
    v_smfmac_f32_32x32x32_bf16 v[48:63], v[196:199], v[24:31], v2
    v_exp_f32 v34, v34
    v_exp_f32 v35, v35
    v_exp_f32 v36, v36
    s_waitcnt vmcnt(11)
    v_permlane16_swap_b32 v200, v204
    v_permlane16_swap_b32 v201, v205
    v_permlane16_swap_b32 v202, v206
    v_permlane16_swap_b32 v203, v207
    v_mfma_f32_32x32x16_bf16 v[16:31], v[104:107], v[8:11], 0
    v_exp_f32 v37, v37
    v_exp_f32 v38, v38
    v_exp_f32 v39, v39
    v_exp_f32 v40, v40
    v_exp_f32 v41, v41
    v_exp_f32 v42, v42
    v_smfmac_f32_32x32x32_bf16 v[48:63], v[200:203], v[32:39], v2
    v_exp_f32 v43, v43
    v_exp_f32 v44, v44
    v_exp_f32 v45, v45
    v_exp_f32 v46, v46
    v_exp_f32 v47, v47
    v_exp_f32 v16, v16
    v_exp_f32 v17, v17
    v_smfmac_f32_32x32x32_bf16 v[48:63], v[204:207], v[40:47], v2
    v_exp_f32 v18, v18
    v_exp_f32 v19, v19
    v_exp_f32 v20, v20
    s_waitcnt vmcnt(9)
    v_permlane16_swap_b32 v208, v212
    v_permlane16_swap_b32 v209, v213
    v_permlane16_swap_b32 v210, v214
    v_permlane16_swap_b32 v211, v215
    v_mfma_f32_32x32x16_bf16 v[32:47], v[108:111], v[8:11], 0
    v_exp_f32 v21, v21
    v_exp_f32 v22, v22
    v_exp_f32 v23, v23
    v_exp_f32 v24, v24
    v_exp_f32 v25, v25
    v_exp_f32 v26, v26
    v_smfmac_f32_32x32x32_bf16 v[48:63], v[208:211], v[16:23], v2
    v_exp_f32 v27, v27
    v_exp_f32 v28, v28
    v_exp_f32 v29, v29
    v_exp_f32 v30, v30
    v_exp_f32 v31, v31
    v_exp_f32 v32, v32
    v_exp_f32 v33, v33
    v_smfmac_f32_32x32x32_bf16 v[48:63], v[212:215], v[24:31], v2
    v_exp_f32 v34, v34
    v_exp_f32 v35, v35
    v_exp_f32 v36, v36
    s_waitcnt vmcnt(7)
    v_permlane16_swap_b32 v216, v220
    v_permlane16_swap_b32 v217, v221
    v_permlane16_swap_b32 v218, v222
    v_permlane16_swap_b32 v219, v223
    v_mfma_f32_32x32x16_bf16 v[16:31], v[112:115], v[8:11], 0
    v_exp_f32 v37, v37
    v_exp_f32 v38, v38
    v_exp_f32 v39, v39
    v_exp_f32 v40, v40
    v_exp_f32 v41, v41
    v_exp_f32 v42, v42
    v_smfmac_f32_32x32x32_bf16 v[48:63], v[216:219], v[32:39], v2
    v_exp_f32 v43, v43
    v_exp_f32 v44, v44
    v_exp_f32 v45, v45
    v_exp_f32 v46, v46
    v_exp_f32 v47, v47
    v_exp_f32 v16, v16
    v_exp_f32 v17, v17
    v_smfmac_f32_32x32x32_bf16 v[48:63], v[220:223], v[40:47], v2
    v_exp_f32 v18, v18
    v_exp_f32 v19, v19
    v_exp_f32 v20, v20
    s_waitcnt vmcnt(5)
    v_permlane16_swap_b32 v224, v228
    v_permlane16_swap_b32 v225, v229
    v_permlane16_swap_b32 v226, v230
    v_permlane16_swap_b32 v227, v231
    v_mfma_f32_32x32x16_bf16 v[32:47], v[116:119], v[8:11], 0
    v_exp_f32 v21, v21
    v_exp_f32 v22, v22
    v_exp_f32 v23, v23
    v_exp_f32 v24, v24
    v_exp_f32 v25, v25
    v_exp_f32 v26, v26
    v_smfmac_f32_32x32x32_bf16 v[48:63], v[224:227], v[16:23], v2
    v_exp_f32 v27, v27
    v_exp_f32 v28, v28
    v_exp_f32 v29, v29
    v_exp_f32 v30, v30
    v_exp_f32 v31, v31
    v_exp_f32 v32, v32
    v_exp_f32 v33, v33
    v_smfmac_f32_32x32x32_bf16 v[48:63], v[228:231], v[24:31], v2
    v_exp_f32 v34, v34
    v_exp_f32 v35, v35
    v_exp_f32 v36, v36
    s_waitcnt vmcnt(3)
    v_permlane16_swap_b32 v232, v236
    v_permlane16_swap_b32 v233, v237
    v_permlane16_swap_b32 v234, v238
    v_permlane16_swap_b32 v235, v239
    v_mfma_f32_32x32x16_bf16 v[16:31], v[120:123], v[8:11], 0
    v_exp_f32 v37, v37
    v_exp_f32 v38, v38
    v_exp_f32 v39, v39
    v_exp_f32 v40, v40
    v_exp_f32 v41, v41
    v_exp_f32 v42, v42
    v_smfmac_f32_32x32x32_bf16 v[48:63], v[232:235], v[32:39], v2
    v_exp_f32 v43, v43
    v_exp_f32 v44, v44
    v_exp_f32 v45, v45
    v_exp_f32 v46, v46
    v_exp_f32 v47, v47
    v_exp_f32 v16, v16
    v_exp_f32 v17, v17
    v_smfmac_f32_32x32x32_bf16 v[48:63], v[236:239], v[40:47], v2
    v_exp_f32 v18, v18
    v_exp_f32 v19, v19
    v_exp_f32 v20, v20
    s_waitcnt vmcnt(1)
    v_permlane16_swap_b32 v240, v244
    v_permlane16_swap_b32 v241, v245
    v_permlane16_swap_b32 v242, v246
    v_permlane16_swap_b32 v243, v247
    v_mfma_f32_32x32x16_bf16 v[32:47], v[124:127], v[8:11], 0
    v_exp_f32 v21, v21
    v_exp_f32 v22, v22
    ds_read_b128 v[8:11], v12 offset:1024
    v_exp_f32 v23, v23
    v_exp_f32 v24, v24
    v_exp_f32 v25, v25
    v_exp_f32 v26, v26
    v_smfmac_f32_32x32x32_bf16 v[48:63], v[240:243], v[16:23], v2
    v_exp_f32 v27, v27
    v_exp_f32 v28, v28
    v_exp_f32 v29, v29
    v_exp_f32 v30, v30
    v_exp_f32 v31, v31
    v_exp_f32 v32, v32
    v_exp_f32 v33, v33
    v_smfmac_f32_32x32x32_bf16 v[48:63], v[244:247], v[24:31], v2
    v_exp_f32 v34, v34
    v_exp_f32 v35, v35
    v_exp_f32 v36, v36
    s_waitcnt lgkmcnt(0)
    s_waitcnt vmcnt(0)
    v_permlane16_swap_b32 v248, v252
    v_permlane16_swap_b32 v249, v253
    v_permlane16_swap_b32 v250, v254
    v_permlane16_swap_b32 v251, v255
    v_mfma_f32_32x32x16_bf16 v[16:31], v[64:67], v[8:11], 0
    v_exp_f32 v37, v37
    v_exp_f32 v38, v38
    v_exp_f32 v39, v39
    v_exp_f32 v40, v40
    v_exp_f32 v41, v41
    v_exp_f32 v42, v42
    v_smfmac_f32_32x32x32_bf16 v[48:63], v[248:251], v[32:39], v2
    v_exp_f32 v43, v43
    v_exp_f32 v44, v44
    v_exp_f32 v45, v45
    v_exp_f32 v46, v46
    v_exp_f32 v47, v47
    v_exp_f32 v16, v16
    v_exp_f32 v17, v17
    v_smfmac_f32_32x32x32_bf16 v[48:63], v[252:255], v[40:47], v2
    v_exp_f32 v18, v18
    v_exp_f32 v19, v19
    v_exp_f32 v20, v20
    v_mfma_f32_32x32x16_bf16 v[32:47], v[68:71], v[8:11], 0
    v_exp_f32 v21, v21
    v_exp_f32 v22, v22
    v_exp_f32 v23, v23
    v_exp_f32 v24, v24
    v_exp_f32 v25, v25
    v_exp_f32 v26, v26
    v_exp_f32 v27, v27
    v_exp_f32 v28, v28
    v_exp_f32 v29, v29
    v_exp_f32 v30, v30
    v_exp_f32 v31, v31
    ds_write_b128 v1, v[48:51] offset:0
    ds_write_b128 v1, v[52:55] offset:1024
    ds_write_b32 v3, v56 offset:2048
    v_mov_b64 v[48:49], 0
    v_mov_b64 v[50:51], 0
    v_mov_b64 v[52:53], 0
    v_mov_b64 v[54:55], 0
    v_mov_b32 v56, 0
    v_exp_f32 v32, v32
    v_exp_f32 v33, v33
    v_smfmac_f32_32x32x32_bf16 v[48:63], v[128:131], v[16:23], v2
    v_exp_f32 v34, v34
    v_exp_f32 v35, v35
    v_exp_f32 v36, v36
    v_smfmac_f32_32x32x32_bf16 v[48:63], v[132:135], v[24:31], v2
    v_exp_f32 v37, v37
    v_exp_f32 v38, v38
    v_exp_f32 v39, v39
    v_mfma_f32_32x32x16_bf16 v[16:31], v[72:75], v[8:11], 0
    v_exp_f32 v40, v40
    v_exp_f32 v41, v41
    v_exp_f32 v42, v42
    v_smfmac_f32_32x32x32_bf16 v[48:63], v[136:139], v[32:39], v2
    v_exp_f32 v43, v43
    v_exp_f32 v44, v44
    v_exp_f32 v45, v45
    v_exp_f32 v46, v46
    v_exp_f32 v47, v47
    s_nop 2
    v_exp_f32 v16, v16
    v_exp_f32 v17, v17
    v_smfmac_f32_32x32x32_bf16 v[48:63], v[140:143], v[40:47], v2
    v_exp_f32 v18, v18
    v_exp_f32 v19, v19
    v_exp_f32 v20, v20
    v_mfma_f32_32x32x16_bf16 v[32:47], v[76:79], v[8:11], 0
    v_exp_f32 v21, v21
    v_exp_f32 v22, v22
    v_exp_f32 v23, v23
    v_exp_f32 v24, v24
    v_exp_f32 v25, v25
    v_exp_f32 v26, v26
    v_smfmac_f32_32x32x32_bf16 v[48:63], v[144:147], v[16:23], v2
    v_exp_f32 v27, v27
    v_exp_f32 v28, v28
    v_exp_f32 v29, v29
    v_exp_f32 v30, v30
    v_exp_f32 v31, v31
    v_exp_f32 v32, v32
    v_exp_f32 v33, v33
    v_smfmac_f32_32x32x32_bf16 v[48:63], v[148:151], v[24:31], v2
    v_exp_f32 v34, v34
    v_exp_f32 v35, v35
    v_exp_f32 v36, v36
    v_mfma_f32_32x32x16_bf16 v[16:31], v[80:83], v[8:11], 0
    v_exp_f32 v37, v37
    v_exp_f32 v38, v38
    v_exp_f32 v39, v39
    v_exp_f32 v40, v40
    v_exp_f32 v41, v41
    v_exp_f32 v42, v42
    v_smfmac_f32_32x32x32_bf16 v[48:63], v[152:155], v[32:39], v2
    v_exp_f32 v43, v43
    v_exp_f32 v44, v44
    v_exp_f32 v45, v45
    v_exp_f32 v46, v46
    v_exp_f32 v47, v47
    v_exp_f32 v16, v16
    v_exp_f32 v17, v17
    v_smfmac_f32_32x32x32_bf16 v[48:63], v[156:159], v[40:47], v2
    v_exp_f32 v18, v18
    v_exp_f32 v19, v19
    v_exp_f32 v20, v20
    v_mfma_f32_32x32x16_bf16 v[32:47], v[84:87], v[8:11], 0
    v_exp_f32 v21, v21
    v_exp_f32 v22, v22
    v_exp_f32 v23, v23
    v_exp_f32 v24, v24
    v_exp_f32 v25, v25
    v_exp_f32 v26, v26
    v_smfmac_f32_32x32x32_bf16 v[48:63], v[160:163], v[16:23], v2
    v_exp_f32 v27, v27
    v_exp_f32 v28, v28
    v_exp_f32 v29, v29
    v_exp_f32 v30, v30
    v_exp_f32 v31, v31
    v_exp_f32 v32, v32
    v_exp_f32 v33, v33
    v_smfmac_f32_32x32x32_bf16 v[48:63], v[164:167], v[24:31], v2
    v_exp_f32 v34, v34
    v_exp_f32 v35, v35
    v_exp_f32 v36, v36
    v_mfma_f32_32x32x16_bf16 v[16:31], v[88:91], v[8:11], 0
    v_exp_f32 v37, v37
    v_exp_f32 v38, v38
    v_exp_f32 v39, v39
    v_exp_f32 v40, v40
    v_exp_f32 v41, v41
    v_exp_f32 v42, v42
    v_smfmac_f32_32x32x32_bf16 v[48:63], v[168:171], v[32:39], v2
    v_exp_f32 v43, v43
    v_exp_f32 v44, v44
    v_exp_f32 v45, v45
    v_exp_f32 v46, v46
    v_exp_f32 v47, v47
    v_exp_f32 v16, v16
    v_exp_f32 v17, v17
    v_smfmac_f32_32x32x32_bf16 v[48:63], v[172:175], v[40:47], v2
    v_exp_f32 v18, v18
    v_exp_f32 v19, v19
    v_exp_f32 v20, v20
    v_mfma_f32_32x32x16_bf16 v[32:47], v[92:95], v[8:11], 0
    v_exp_f32 v21, v21
    v_exp_f32 v22, v22
    v_exp_f32 v23, v23
    v_exp_f32 v24, v24
    v_exp_f32 v25, v25
    v_exp_f32 v26, v26
    v_smfmac_f32_32x32x32_bf16 v[48:63], v[176:179], v[16:23], v2
    v_exp_f32 v27, v27
    v_exp_f32 v28, v28
    v_exp_f32 v29, v29
    v_exp_f32 v30, v30
    v_exp_f32 v31, v31
    v_exp_f32 v32, v32
    v_exp_f32 v33, v33
    v_smfmac_f32_32x32x32_bf16 v[48:63], v[180:183], v[24:31], v2
    v_exp_f32 v34, v34
    v_exp_f32 v35, v35
    v_exp_f32 v36, v36
    v_mfma_f32_32x32x16_bf16 v[16:31], v[96:99], v[8:11], 0
    v_exp_f32 v37, v37
    v_exp_f32 v38, v38
    v_exp_f32 v39, v39
    v_exp_f32 v40, v40
    v_exp_f32 v41, v41
    v_exp_f32 v42, v42
    v_smfmac_f32_32x32x32_bf16 v[48:63], v[184:187], v[32:39], v2
    v_exp_f32 v43, v43
    v_exp_f32 v44, v44
    v_exp_f32 v45, v45
    v_exp_f32 v46, v46
    v_exp_f32 v47, v47
    v_exp_f32 v16, v16
    v_exp_f32 v17, v17
    v_smfmac_f32_32x32x32_bf16 v[48:63], v[188:191], v[40:47], v2
    v_exp_f32 v18, v18
    v_exp_f32 v19, v19
    v_exp_f32 v20, v20
    v_mfma_f32_32x32x16_bf16 v[32:47], v[100:103], v[8:11], 0
    v_exp_f32 v21, v21
    v_exp_f32 v22, v22
    v_exp_f32 v23, v23
    v_exp_f32 v24, v24
    v_exp_f32 v25, v25
    v_exp_f32 v26, v26
    v_smfmac_f32_32x32x32_bf16 v[48:63], v[192:195], v[16:23], v2
    v_exp_f32 v27, v27
    v_exp_f32 v28, v28
    v_exp_f32 v29, v29
    v_exp_f32 v30, v30
    v_exp_f32 v31, v31
    v_exp_f32 v32, v32
    v_exp_f32 v33, v33
    v_smfmac_f32_32x32x32_bf16 v[48:63], v[196:199], v[24:31], v2
    v_exp_f32 v34, v34
    v_exp_f32 v35, v35
    v_exp_f32 v36, v36
    v_mfma_f32_32x32x16_bf16 v[16:31], v[104:107], v[8:11], 0
    v_exp_f32 v37, v37
    v_exp_f32 v38, v38
    v_exp_f32 v39, v39
    v_exp_f32 v40, v40
    v_exp_f32 v41, v41
    v_exp_f32 v42, v42
    v_smfmac_f32_32x32x32_bf16 v[48:63], v[200:203], v[32:39], v2
    v_exp_f32 v43, v43
    v_exp_f32 v44, v44
    v_exp_f32 v45, v45
    v_exp_f32 v46, v46
    v_exp_f32 v47, v47
    v_exp_f32 v16, v16
    v_exp_f32 v17, v17
    v_smfmac_f32_32x32x32_bf16 v[48:63], v[204:207], v[40:47], v2
    v_exp_f32 v18, v18
    v_exp_f32 v19, v19
    v_exp_f32 v20, v20
    v_mfma_f32_32x32x16_bf16 v[32:47], v[108:111], v[8:11], 0
    v_exp_f32 v21, v21
    v_exp_f32 v22, v22
    v_exp_f32 v23, v23
    v_exp_f32 v24, v24
    v_exp_f32 v25, v25
    v_exp_f32 v26, v26
    v_smfmac_f32_32x32x32_bf16 v[48:63], v[208:211], v[16:23], v2
    v_exp_f32 v27, v27
    v_exp_f32 v28, v28
    v_exp_f32 v29, v29
    v_exp_f32 v30, v30
    v_exp_f32 v31, v31
    v_exp_f32 v32, v32
    v_exp_f32 v33, v33
    v_smfmac_f32_32x32x32_bf16 v[48:63], v[212:215], v[24:31], v2
    v_exp_f32 v34, v34
    v_exp_f32 v35, v35
    v_exp_f32 v36, v36
    v_mfma_f32_32x32x16_bf16 v[16:31], v[112:115], v[8:11], 0
    v_exp_f32 v37, v37
    v_exp_f32 v38, v38
    v_exp_f32 v39, v39
    v_exp_f32 v40, v40
    v_exp_f32 v41, v41
    v_exp_f32 v42, v42
    v_smfmac_f32_32x32x32_bf16 v[48:63], v[216:219], v[32:39], v2
    v_exp_f32 v43, v43
    v_exp_f32 v44, v44
    v_exp_f32 v45, v45
    v_exp_f32 v46, v46
    v_exp_f32 v47, v47
    v_exp_f32 v16, v16
    v_exp_f32 v17, v17
    v_smfmac_f32_32x32x32_bf16 v[48:63], v[220:223], v[40:47], v2
    v_exp_f32 v18, v18
    v_exp_f32 v19, v19
    v_exp_f32 v20, v20
    v_mfma_f32_32x32x16_bf16 v[32:47], v[116:119], v[8:11], 0
    v_exp_f32 v21, v21
    v_exp_f32 v22, v22
    v_exp_f32 v23, v23
    v_exp_f32 v24, v24
    v_exp_f32 v25, v25
    v_exp_f32 v26, v26
    v_smfmac_f32_32x32x32_bf16 v[48:63], v[224:227], v[16:23], v2
    v_exp_f32 v27, v27
    v_exp_f32 v28, v28
    v_exp_f32 v29, v29
    v_exp_f32 v30, v30
    v_exp_f32 v31, v31
    v_exp_f32 v32, v32
    v_exp_f32 v33, v33
    v_smfmac_f32_32x32x32_bf16 v[48:63], v[228:231], v[24:31], v2
    v_exp_f32 v34, v34
    v_exp_f32 v35, v35
    v_exp_f32 v36, v36
    v_mfma_f32_32x32x16_bf16 v[16:31], v[120:123], v[8:11], 0
    v_exp_f32 v37, v37
    v_exp_f32 v38, v38
    v_exp_f32 v39, v39
    v_exp_f32 v40, v40
    v_exp_f32 v41, v41
    v_exp_f32 v42, v42
    v_smfmac_f32_32x32x32_bf16 v[48:63], v[232:235], v[32:39], v2
    v_exp_f32 v43, v43
    v_exp_f32 v44, v44
    v_exp_f32 v45, v45
    v_exp_f32 v46, v46
    v_exp_f32 v47, v47
    v_exp_f32 v16, v16
    v_exp_f32 v17, v17
    v_smfmac_f32_32x32x32_bf16 v[48:63], v[236:239], v[40:47], v2
    v_exp_f32 v18, v18
    v_exp_f32 v19, v19
    v_exp_f32 v20, v20
    v_mfma_f32_32x32x16_bf16 v[32:47], v[124:127], v[8:11], 0
    v_exp_f32 v21, v21
    v_exp_f32 v22, v22
    ds_read_b128 v[8:11], v12 offset:2048
    v_exp_f32 v23, v23
    v_exp_f32 v24, v24
    v_exp_f32 v25, v25
    v_exp_f32 v26, v26
    v_smfmac_f32_32x32x32_bf16 v[48:63], v[240:243], v[16:23], v2
    v_exp_f32 v27, v27
    v_exp_f32 v28, v28
    v_exp_f32 v29, v29
    v_exp_f32 v30, v30
    v_exp_f32 v31, v31
    v_exp_f32 v32, v32
    v_exp_f32 v33, v33
    v_smfmac_f32_32x32x32_bf16 v[48:63], v[244:247], v[24:31], v2
    v_exp_f32 v34, v34
    v_exp_f32 v35, v35
    v_exp_f32 v36, v36
    s_waitcnt lgkmcnt(0)
    v_mfma_f32_32x32x16_bf16 v[16:31], v[64:67], v[8:11], 0
    v_exp_f32 v37, v37
    v_exp_f32 v38, v38
    v_exp_f32 v39, v39
    v_exp_f32 v40, v40
    v_exp_f32 v41, v41
    v_exp_f32 v42, v42
    v_smfmac_f32_32x32x32_bf16 v[48:63], v[248:251], v[32:39], v2
    v_exp_f32 v43, v43
    v_exp_f32 v44, v44
    v_exp_f32 v45, v45
    v_exp_f32 v46, v46
    v_exp_f32 v47, v47
    v_exp_f32 v16, v16
    v_exp_f32 v17, v17
    v_smfmac_f32_32x32x32_bf16 v[48:63], v[252:255], v[40:47], v2
    v_exp_f32 v18, v18
    v_exp_f32 v19, v19
    v_exp_f32 v20, v20
    v_mfma_f32_32x32x16_bf16 v[32:47], v[68:71], v[8:11], 0
    v_exp_f32 v21, v21
    v_exp_f32 v22, v22
    v_exp_f32 v23, v23
    v_exp_f32 v24, v24
    v_exp_f32 v25, v25
    v_exp_f32 v26, v26
    v_exp_f32 v27, v27
    v_exp_f32 v28, v28
    v_exp_f32 v29, v29
    v_exp_f32 v30, v30
    v_exp_f32 v31, v31
    ds_write_b128 v1, v[48:51] offset:8704
    ds_write_b128 v1, v[52:55] offset:9728
    ds_write_b32 v3, v56 offset:10752
    v_mov_b64 v[48:49], 0
    v_mov_b64 v[50:51], 0
    v_mov_b64 v[52:53], 0
    v_mov_b64 v[54:55], 0
    v_mov_b32 v56, 0
    v_exp_f32 v32, v32
    v_exp_f32 v33, v33
    v_smfmac_f32_32x32x32_bf16 v[48:63], v[128:131], v[16:23], v2
    v_exp_f32 v34, v34
    v_exp_f32 v35, v35
    v_exp_f32 v36, v36
    v_smfmac_f32_32x32x32_bf16 v[48:63], v[132:135], v[24:31], v2
    v_exp_f32 v37, v37
    v_exp_f32 v38, v38
    v_exp_f32 v39, v39
    v_mfma_f32_32x32x16_bf16 v[16:31], v[72:75], v[8:11], 0
    v_exp_f32 v40, v40
    v_exp_f32 v41, v41
    v_exp_f32 v42, v42
    v_smfmac_f32_32x32x32_bf16 v[48:63], v[136:139], v[32:39], v2
    v_exp_f32 v43, v43
    v_exp_f32 v44, v44
    v_exp_f32 v45, v45
    v_exp_f32 v46, v46
    v_exp_f32 v47, v47
    s_nop 2
    v_exp_f32 v16, v16
    v_exp_f32 v17, v17
    v_smfmac_f32_32x32x32_bf16 v[48:63], v[140:143], v[40:47], v2
    v_exp_f32 v18, v18
    v_exp_f32 v19, v19
    v_exp_f32 v20, v20
    v_mfma_f32_32x32x16_bf16 v[32:47], v[76:79], v[8:11], 0
    v_exp_f32 v21, v21
    v_exp_f32 v22, v22
    v_exp_f32 v23, v23
    v_exp_f32 v24, v24
    v_exp_f32 v25, v25
    v_exp_f32 v26, v26
    v_smfmac_f32_32x32x32_bf16 v[48:63], v[144:147], v[16:23], v2
    v_exp_f32 v27, v27
    v_exp_f32 v28, v28
    v_exp_f32 v29, v29
    v_exp_f32 v30, v30
    v_exp_f32 v31, v31
    v_exp_f32 v32, v32
    v_exp_f32 v33, v33
    v_smfmac_f32_32x32x32_bf16 v[48:63], v[148:151], v[24:31], v2
    v_exp_f32 v34, v34
    v_exp_f32 v35, v35
    v_exp_f32 v36, v36
    v_mfma_f32_32x32x16_bf16 v[16:31], v[80:83], v[8:11], 0
    v_exp_f32 v37, v37
    v_exp_f32 v38, v38
    v_exp_f32 v39, v39
    v_exp_f32 v40, v40
    v_exp_f32 v41, v41
    v_exp_f32 v42, v42
    v_smfmac_f32_32x32x32_bf16 v[48:63], v[152:155], v[32:39], v2
    v_exp_f32 v43, v43
    v_exp_f32 v44, v44
    v_exp_f32 v45, v45
    v_exp_f32 v46, v46
    v_exp_f32 v47, v47
    v_exp_f32 v16, v16
    v_exp_f32 v17, v17
    v_smfmac_f32_32x32x32_bf16 v[48:63], v[156:159], v[40:47], v2
    v_exp_f32 v18, v18
    v_exp_f32 v19, v19
    v_exp_f32 v20, v20
    v_mfma_f32_32x32x16_bf16 v[32:47], v[84:87], v[8:11], 0
    v_exp_f32 v21, v21
    v_exp_f32 v22, v22
    v_exp_f32 v23, v23
    v_exp_f32 v24, v24
    v_exp_f32 v25, v25
    v_exp_f32 v26, v26
    v_smfmac_f32_32x32x32_bf16 v[48:63], v[160:163], v[16:23], v2
    v_exp_f32 v27, v27
    v_exp_f32 v28, v28
    v_exp_f32 v29, v29
    v_exp_f32 v30, v30
    v_exp_f32 v31, v31
    v_exp_f32 v32, v32
    v_exp_f32 v33, v33
    v_smfmac_f32_32x32x32_bf16 v[48:63], v[164:167], v[24:31], v2
    v_exp_f32 v34, v34
    v_exp_f32 v35, v35
    v_exp_f32 v36, v36
    v_mfma_f32_32x32x16_bf16 v[16:31], v[88:91], v[8:11], 0
    v_exp_f32 v37, v37
    v_exp_f32 v38, v38
    v_exp_f32 v39, v39
    v_exp_f32 v40, v40
    v_exp_f32 v41, v41
    v_exp_f32 v42, v42
    v_smfmac_f32_32x32x32_bf16 v[48:63], v[168:171], v[32:39], v2
    v_exp_f32 v43, v43
    v_exp_f32 v44, v44
    v_exp_f32 v45, v45
    v_exp_f32 v46, v46
    v_exp_f32 v47, v47
    v_exp_f32 v16, v16
    v_exp_f32 v17, v17
    v_smfmac_f32_32x32x32_bf16 v[48:63], v[172:175], v[40:47], v2
    v_exp_f32 v18, v18
    v_exp_f32 v19, v19
    v_exp_f32 v20, v20
    v_mfma_f32_32x32x16_bf16 v[32:47], v[92:95], v[8:11], 0
    v_exp_f32 v21, v21
    v_exp_f32 v22, v22
    v_exp_f32 v23, v23
    v_exp_f32 v24, v24
    v_exp_f32 v25, v25
    v_exp_f32 v26, v26
    v_smfmac_f32_32x32x32_bf16 v[48:63], v[176:179], v[16:23], v2
    v_exp_f32 v27, v27
    v_exp_f32 v28, v28
    v_exp_f32 v29, v29
    v_exp_f32 v30, v30
    v_exp_f32 v31, v31
    v_exp_f32 v32, v32
    v_exp_f32 v33, v33
    v_smfmac_f32_32x32x32_bf16 v[48:63], v[180:183], v[24:31], v2
    v_exp_f32 v34, v34
    v_exp_f32 v35, v35
    v_exp_f32 v36, v36
    v_mfma_f32_32x32x16_bf16 v[16:31], v[96:99], v[8:11], 0
    v_exp_f32 v37, v37
    v_exp_f32 v38, v38
    v_exp_f32 v39, v39
    v_exp_f32 v40, v40
    v_exp_f32 v41, v41
    v_exp_f32 v42, v42
    v_smfmac_f32_32x32x32_bf16 v[48:63], v[184:187], v[32:39], v2
    v_exp_f32 v43, v43
    v_exp_f32 v44, v44
    v_exp_f32 v45, v45
    v_exp_f32 v46, v46
    v_exp_f32 v47, v47
    v_exp_f32 v16, v16
    v_exp_f32 v17, v17
    v_smfmac_f32_32x32x32_bf16 v[48:63], v[188:191], v[40:47], v2
    v_exp_f32 v18, v18
    v_exp_f32 v19, v19
    v_exp_f32 v20, v20
    v_mfma_f32_32x32x16_bf16 v[32:47], v[100:103], v[8:11], 0
    v_exp_f32 v21, v21
    v_exp_f32 v22, v22
    v_exp_f32 v23, v23
    v_exp_f32 v24, v24
    v_exp_f32 v25, v25
    v_exp_f32 v26, v26
    v_smfmac_f32_32x32x32_bf16 v[48:63], v[192:195], v[16:23], v2
    v_exp_f32 v27, v27
    v_exp_f32 v28, v28
    v_exp_f32 v29, v29
    v_exp_f32 v30, v30
    v_exp_f32 v31, v31
    v_exp_f32 v32, v32
    v_exp_f32 v33, v33
    v_smfmac_f32_32x32x32_bf16 v[48:63], v[196:199], v[24:31], v2
    v_exp_f32 v34, v34
    v_exp_f32 v35, v35
    v_exp_f32 v36, v36
    v_mfma_f32_32x32x16_bf16 v[16:31], v[104:107], v[8:11], 0
    v_exp_f32 v37, v37
    v_exp_f32 v38, v38
    v_exp_f32 v39, v39
    v_exp_f32 v40, v40
    v_exp_f32 v41, v41
    v_exp_f32 v42, v42
    v_smfmac_f32_32x32x32_bf16 v[48:63], v[200:203], v[32:39], v2
    v_exp_f32 v43, v43
    v_exp_f32 v44, v44
    v_exp_f32 v45, v45
    v_exp_f32 v46, v46
    v_exp_f32 v47, v47
    v_exp_f32 v16, v16
    v_exp_f32 v17, v17
    v_smfmac_f32_32x32x32_bf16 v[48:63], v[204:207], v[40:47], v2
    v_exp_f32 v18, v18
    v_exp_f32 v19, v19
    v_exp_f32 v20, v20
    v_mfma_f32_32x32x16_bf16 v[32:47], v[108:111], v[8:11], 0
    v_exp_f32 v21, v21
    v_exp_f32 v22, v22
    v_exp_f32 v23, v23
    v_exp_f32 v24, v24
    v_exp_f32 v25, v25
    v_exp_f32 v26, v26
    v_smfmac_f32_32x32x32_bf16 v[48:63], v[208:211], v[16:23], v2
    v_exp_f32 v27, v27
    v_exp_f32 v28, v28
    v_exp_f32 v29, v29
    v_exp_f32 v30, v30
    v_exp_f32 v31, v31
    v_exp_f32 v32, v32
    v_exp_f32 v33, v33
    v_smfmac_f32_32x32x32_bf16 v[48:63], v[212:215], v[24:31], v2
    v_exp_f32 v34, v34
    v_exp_f32 v35, v35
    v_exp_f32 v36, v36
    v_mfma_f32_32x32x16_bf16 v[16:31], v[112:115], v[8:11], 0
    v_exp_f32 v37, v37
    v_exp_f32 v38, v38
    v_exp_f32 v39, v39
    v_exp_f32 v40, v40
    v_exp_f32 v41, v41
    v_exp_f32 v42, v42
    v_smfmac_f32_32x32x32_bf16 v[48:63], v[216:219], v[32:39], v2
    v_exp_f32 v43, v43
    v_exp_f32 v44, v44
    v_exp_f32 v45, v45
    v_exp_f32 v46, v46
    v_exp_f32 v47, v47
    v_exp_f32 v16, v16
    v_exp_f32 v17, v17
    v_smfmac_f32_32x32x32_bf16 v[48:63], v[220:223], v[40:47], v2
    v_exp_f32 v18, v18
    v_exp_f32 v19, v19
    v_exp_f32 v20, v20
    v_mfma_f32_32x32x16_bf16 v[32:47], v[116:119], v[8:11], 0
    v_exp_f32 v21, v21
    v_exp_f32 v22, v22
    v_exp_f32 v23, v23
    v_exp_f32 v24, v24
    v_exp_f32 v25, v25
    v_exp_f32 v26, v26
    v_smfmac_f32_32x32x32_bf16 v[48:63], v[224:227], v[16:23], v2
    v_exp_f32 v27, v27
    v_exp_f32 v28, v28
    v_exp_f32 v29, v29
    v_exp_f32 v30, v30
    v_exp_f32 v31, v31
    v_exp_f32 v32, v32
    v_exp_f32 v33, v33
    v_smfmac_f32_32x32x32_bf16 v[48:63], v[228:231], v[24:31], v2
    v_exp_f32 v34, v34
    v_exp_f32 v35, v35
    v_exp_f32 v36, v36
    v_mfma_f32_32x32x16_bf16 v[16:31], v[120:123], v[8:11], 0
    v_exp_f32 v37, v37
    v_exp_f32 v38, v38
    v_exp_f32 v39, v39
    v_exp_f32 v40, v40
    v_exp_f32 v41, v41
    v_exp_f32 v42, v42
    v_smfmac_f32_32x32x32_bf16 v[48:63], v[232:235], v[32:39], v2
    v_exp_f32 v43, v43
    v_exp_f32 v44, v44
    v_exp_f32 v45, v45
    v_exp_f32 v46, v46
    v_exp_f32 v47, v47
    v_exp_f32 v16, v16
    v_exp_f32 v17, v17
    v_smfmac_f32_32x32x32_bf16 v[48:63], v[236:239], v[40:47], v2
    v_exp_f32 v18, v18
    v_exp_f32 v19, v19
    v_exp_f32 v20, v20
    v_mfma_f32_32x32x16_bf16 v[32:47], v[124:127], v[8:11], 0
    v_exp_f32 v21, v21
    v_exp_f32 v22, v22
    ds_read_b128 v[8:11], v12 offset:3072
    v_exp_f32 v23, v23
    v_exp_f32 v24, v24
    v_exp_f32 v25, v25
    v_exp_f32 v26, v26
    v_smfmac_f32_32x32x32_bf16 v[48:63], v[240:243], v[16:23], v2
    v_exp_f32 v27, v27
    v_exp_f32 v28, v28
    v_exp_f32 v29, v29
    v_exp_f32 v30, v30
    v_exp_f32 v31, v31
    v_exp_f32 v32, v32
    v_exp_f32 v33, v33
    v_smfmac_f32_32x32x32_bf16 v[48:63], v[244:247], v[24:31], v2
    v_exp_f32 v34, v34
    v_exp_f32 v35, v35
    v_exp_f32 v36, v36
    s_waitcnt lgkmcnt(0)
    v_mfma_f32_32x32x16_bf16 v[16:31], v[64:67], v[8:11], 0
    v_exp_f32 v37, v37
    v_exp_f32 v38, v38
    v_exp_f32 v39, v39
    v_exp_f32 v40, v40
    v_exp_f32 v41, v41
    v_exp_f32 v42, v42
    v_smfmac_f32_32x32x32_bf16 v[48:63], v[248:251], v[32:39], v2
    v_exp_f32 v43, v43
    v_exp_f32 v44, v44
    v_exp_f32 v45, v45
    v_exp_f32 v46, v46
    v_exp_f32 v47, v47
    v_exp_f32 v16, v16
    v_exp_f32 v17, v17
    v_smfmac_f32_32x32x32_bf16 v[48:63], v[252:255], v[40:47], v2
    v_exp_f32 v18, v18
    v_exp_f32 v19, v19
    v_exp_f32 v20, v20
    v_mfma_f32_32x32x16_bf16 v[32:47], v[68:71], v[8:11], 0
    v_exp_f32 v21, v21
    v_exp_f32 v22, v22
    v_exp_f32 v23, v23
    v_exp_f32 v24, v24
    v_exp_f32 v25, v25
    v_exp_f32 v26, v26
    v_exp_f32 v27, v27
    v_exp_f32 v28, v28
    v_exp_f32 v29, v29
    v_exp_f32 v30, v30
    v_exp_f32 v31, v31
    ds_write_b128 v1, v[48:51] offset:17408
    ds_write_b128 v1, v[52:55] offset:18432
    ds_write_b32 v3, v56 offset:19456
    v_mov_b64 v[48:49], 0
    v_mov_b64 v[50:51], 0
    v_mov_b64 v[52:53], 0
    v_mov_b64 v[54:55], 0
    v_mov_b32 v56, 0
    v_exp_f32 v32, v32
    v_exp_f32 v33, v33
    v_smfmac_f32_32x32x32_bf16 v[48:63], v[128:131], v[16:23], v2
    v_exp_f32 v34, v34
    v_exp_f32 v35, v35
    v_exp_f32 v36, v36
    v_smfmac_f32_32x32x32_bf16 v[48:63], v[132:135], v[24:31], v2
    v_exp_f32 v37, v37
    v_exp_f32 v38, v38
    v_exp_f32 v39, v39
    v_mfma_f32_32x32x16_bf16 v[16:31], v[72:75], v[8:11], 0
    v_exp_f32 v40, v40
    v_exp_f32 v41, v41
    v_exp_f32 v42, v42
    v_smfmac_f32_32x32x32_bf16 v[48:63], v[136:139], v[32:39], v2
    v_exp_f32 v43, v43
    v_exp_f32 v44, v44
    v_exp_f32 v45, v45
    v_exp_f32 v46, v46
    v_exp_f32 v47, v47
    s_nop 2
    v_exp_f32 v16, v16
    v_exp_f32 v17, v17
    v_smfmac_f32_32x32x32_bf16 v[48:63], v[140:143], v[40:47], v2
    v_exp_f32 v18, v18
    v_exp_f32 v19, v19
    v_exp_f32 v20, v20
    v_mfma_f32_32x32x16_bf16 v[32:47], v[76:79], v[8:11], 0
    v_exp_f32 v21, v21
    v_exp_f32 v22, v22
    v_exp_f32 v23, v23
    v_exp_f32 v24, v24
    v_exp_f32 v25, v25
    v_exp_f32 v26, v26
    v_smfmac_f32_32x32x32_bf16 v[48:63], v[144:147], v[16:23], v2
    v_exp_f32 v27, v27
    v_exp_f32 v28, v28
    v_exp_f32 v29, v29
    v_exp_f32 v30, v30
    v_exp_f32 v31, v31
    v_exp_f32 v32, v32
    v_exp_f32 v33, v33
    v_smfmac_f32_32x32x32_bf16 v[48:63], v[148:151], v[24:31], v2
    v_exp_f32 v34, v34
    v_exp_f32 v35, v35
    v_exp_f32 v36, v36
    v_mfma_f32_32x32x16_bf16 v[16:31], v[80:83], v[8:11], 0
    v_exp_f32 v37, v37
    v_exp_f32 v38, v38
    v_exp_f32 v39, v39
    v_exp_f32 v40, v40
    v_exp_f32 v41, v41
    v_exp_f32 v42, v42
    v_smfmac_f32_32x32x32_bf16 v[48:63], v[152:155], v[32:39], v2
    v_exp_f32 v43, v43
    v_exp_f32 v44, v44
    v_exp_f32 v45, v45
    v_exp_f32 v46, v46
    v_exp_f32 v47, v47
    v_exp_f32 v16, v16
    v_exp_f32 v17, v17
    v_smfmac_f32_32x32x32_bf16 v[48:63], v[156:159], v[40:47], v2
    v_exp_f32 v18, v18
    v_exp_f32 v19, v19
    v_exp_f32 v20, v20
    v_mfma_f32_32x32x16_bf16 v[32:47], v[84:87], v[8:11], 0
    v_exp_f32 v21, v21
    v_exp_f32 v22, v22
    v_exp_f32 v23, v23
    v_exp_f32 v24, v24
    v_exp_f32 v25, v25
    v_exp_f32 v26, v26
    v_smfmac_f32_32x32x32_bf16 v[48:63], v[160:163], v[16:23], v2
    v_exp_f32 v27, v27
    v_exp_f32 v28, v28
    v_exp_f32 v29, v29
    v_exp_f32 v30, v30
    v_exp_f32 v31, v31
    v_exp_f32 v32, v32
    v_exp_f32 v33, v33
    v_smfmac_f32_32x32x32_bf16 v[48:63], v[164:167], v[24:31], v2
    v_exp_f32 v34, v34
    v_exp_f32 v35, v35
    v_exp_f32 v36, v36
    v_mfma_f32_32x32x16_bf16 v[16:31], v[88:91], v[8:11], 0
    v_exp_f32 v37, v37
    v_exp_f32 v38, v38
    v_exp_f32 v39, v39
    v_exp_f32 v40, v40
    v_exp_f32 v41, v41
    v_exp_f32 v42, v42
    v_smfmac_f32_32x32x32_bf16 v[48:63], v[168:171], v[32:39], v2
    v_exp_f32 v43, v43
    v_exp_f32 v44, v44
    v_exp_f32 v45, v45
    v_exp_f32 v46, v46
    v_exp_f32 v47, v47
    v_exp_f32 v16, v16
    v_exp_f32 v17, v17
    v_smfmac_f32_32x32x32_bf16 v[48:63], v[172:175], v[40:47], v2
    v_exp_f32 v18, v18
    v_exp_f32 v19, v19
    v_exp_f32 v20, v20
    v_mfma_f32_32x32x16_bf16 v[32:47], v[92:95], v[8:11], 0
    v_exp_f32 v21, v21
    v_exp_f32 v22, v22
    v_exp_f32 v23, v23
    v_exp_f32 v24, v24
    v_exp_f32 v25, v25
    v_exp_f32 v26, v26
    v_smfmac_f32_32x32x32_bf16 v[48:63], v[176:179], v[16:23], v2
    v_exp_f32 v27, v27
    v_exp_f32 v28, v28
    v_exp_f32 v29, v29
    v_exp_f32 v30, v30
    v_exp_f32 v31, v31
    v_exp_f32 v32, v32
    v_exp_f32 v33, v33
    v_smfmac_f32_32x32x32_bf16 v[48:63], v[180:183], v[24:31], v2
    v_exp_f32 v34, v34
    v_exp_f32 v35, v35
    v_exp_f32 v36, v36
    v_mfma_f32_32x32x16_bf16 v[16:31], v[96:99], v[8:11], 0
    v_exp_f32 v37, v37
    v_exp_f32 v38, v38
    v_exp_f32 v39, v39
    v_exp_f32 v40, v40
    v_exp_f32 v41, v41
    v_exp_f32 v42, v42
    v_smfmac_f32_32x32x32_bf16 v[48:63], v[184:187], v[32:39], v2
    v_exp_f32 v43, v43
    v_exp_f32 v44, v44
    v_exp_f32 v45, v45
    v_exp_f32 v46, v46
    v_exp_f32 v47, v47
    v_exp_f32 v16, v16
    v_exp_f32 v17, v17
    v_smfmac_f32_32x32x32_bf16 v[48:63], v[188:191], v[40:47], v2
    v_exp_f32 v18, v18
    v_exp_f32 v19, v19
    v_exp_f32 v20, v20
    v_mfma_f32_32x32x16_bf16 v[32:47], v[100:103], v[8:11], 0
    v_exp_f32 v21, v21
    v_exp_f32 v22, v22
    v_exp_f32 v23, v23
    v_exp_f32 v24, v24
    v_exp_f32 v25, v25
    v_exp_f32 v26, v26
    v_smfmac_f32_32x32x32_bf16 v[48:63], v[192:195], v[16:23], v2
    v_exp_f32 v27, v27
    v_exp_f32 v28, v28
    v_exp_f32 v29, v29
    v_exp_f32 v30, v30
    v_exp_f32 v31, v31
    v_exp_f32 v32, v32
    v_exp_f32 v33, v33
    v_smfmac_f32_32x32x32_bf16 v[48:63], v[196:199], v[24:31], v2
    v_exp_f32 v34, v34
    v_exp_f32 v35, v35
    v_exp_f32 v36, v36
    v_mfma_f32_32x32x16_bf16 v[16:31], v[104:107], v[8:11], 0
    v_exp_f32 v37, v37
    v_exp_f32 v38, v38
    v_exp_f32 v39, v39
    v_exp_f32 v40, v40
    v_exp_f32 v41, v41
    v_exp_f32 v42, v42
    v_smfmac_f32_32x32x32_bf16 v[48:63], v[200:203], v[32:39], v2
    v_exp_f32 v43, v43
    v_exp_f32 v44, v44
    v_exp_f32 v45, v45
    v_exp_f32 v46, v46
    v_exp_f32 v47, v47
    v_exp_f32 v16, v16
    v_exp_f32 v17, v17
    v_smfmac_f32_32x32x32_bf16 v[48:63], v[204:207], v[40:47], v2
    v_exp_f32 v18, v18
    v_exp_f32 v19, v19
    v_exp_f32 v20, v20
    v_mfma_f32_32x32x16_bf16 v[32:47], v[108:111], v[8:11], 0
    v_exp_f32 v21, v21
    v_exp_f32 v22, v22
    v_exp_f32 v23, v23
    v_exp_f32 v24, v24
    v_exp_f32 v25, v25
    v_exp_f32 v26, v26
    v_smfmac_f32_32x32x32_bf16 v[48:63], v[208:211], v[16:23], v2
    v_exp_f32 v27, v27
    v_exp_f32 v28, v28
    v_exp_f32 v29, v29
    v_exp_f32 v30, v30
    v_exp_f32 v31, v31
    v_exp_f32 v32, v32
    v_exp_f32 v33, v33
    v_smfmac_f32_32x32x32_bf16 v[48:63], v[212:215], v[24:31], v2
    v_exp_f32 v34, v34
    v_exp_f32 v35, v35
    v_exp_f32 v36, v36
    v_mfma_f32_32x32x16_bf16 v[16:31], v[112:115], v[8:11], 0
    v_exp_f32 v37, v37
    v_exp_f32 v38, v38
    v_exp_f32 v39, v39
    v_exp_f32 v40, v40
    v_exp_f32 v41, v41
    v_exp_f32 v42, v42
    v_smfmac_f32_32x32x32_bf16 v[48:63], v[216:219], v[32:39], v2
    v_exp_f32 v43, v43
    v_exp_f32 v44, v44
    v_exp_f32 v45, v45
    v_exp_f32 v46, v46
    v_exp_f32 v47, v47
    v_exp_f32 v16, v16
    v_exp_f32 v17, v17
    v_smfmac_f32_32x32x32_bf16 v[48:63], v[220:223], v[40:47], v2
    v_exp_f32 v18, v18
    v_exp_f32 v19, v19
    v_exp_f32 v20, v20
    v_mfma_f32_32x32x16_bf16 v[32:47], v[116:119], v[8:11], 0
    v_exp_f32 v21, v21
    v_exp_f32 v22, v22
    v_exp_f32 v23, v23
    v_exp_f32 v24, v24
    v_exp_f32 v25, v25
    v_exp_f32 v26, v26
    v_smfmac_f32_32x32x32_bf16 v[48:63], v[224:227], v[16:23], v2
    v_exp_f32 v27, v27
    v_exp_f32 v28, v28
    v_exp_f32 v29, v29
    v_exp_f32 v30, v30
    v_exp_f32 v31, v31
    v_exp_f32 v32, v32
    v_exp_f32 v33, v33
    v_smfmac_f32_32x32x32_bf16 v[48:63], v[228:231], v[24:31], v2
    v_exp_f32 v34, v34
    v_exp_f32 v35, v35
    v_exp_f32 v36, v36
    v_mfma_f32_32x32x16_bf16 v[16:31], v[120:123], v[8:11], 0
    v_exp_f32 v37, v37
    v_exp_f32 v38, v38
    v_exp_f32 v39, v39
    v_exp_f32 v40, v40
    v_exp_f32 v41, v41
    v_exp_f32 v42, v42
    v_smfmac_f32_32x32x32_bf16 v[48:63], v[232:235], v[32:39], v2
    v_exp_f32 v43, v43
    v_exp_f32 v44, v44
    v_exp_f32 v45, v45
    v_exp_f32 v46, v46
    v_exp_f32 v47, v47
    v_exp_f32 v16, v16
    v_exp_f32 v17, v17
    v_smfmac_f32_32x32x32_bf16 v[48:63], v[236:239], v[40:47], v2
    v_exp_f32 v18, v18
    v_exp_f32 v19, v19
    v_exp_f32 v20, v20
    v_mfma_f32_32x32x16_bf16 v[32:47], v[124:127], v[8:11], 0
    v_exp_f32 v21, v21
    v_exp_f32 v22, v22
    ds_read_b128 v[8:11], v12 offset:4096
    v_exp_f32 v23, v23
    v_exp_f32 v24, v24
    v_exp_f32 v25, v25
    v_exp_f32 v26, v26
    v_smfmac_f32_32x32x32_bf16 v[48:63], v[240:243], v[16:23], v2
    v_exp_f32 v27, v27
    v_exp_f32 v28, v28
    v_exp_f32 v29, v29
    v_exp_f32 v30, v30
    v_exp_f32 v31, v31
    v_exp_f32 v32, v32
    v_exp_f32 v33, v33
    v_smfmac_f32_32x32x32_bf16 v[48:63], v[244:247], v[24:31], v2
    v_exp_f32 v34, v34
    v_exp_f32 v35, v35
    v_exp_f32 v36, v36
    s_waitcnt lgkmcnt(0)
    v_mfma_f32_32x32x16_bf16 v[16:31], v[64:67], v[8:11], 0
    v_exp_f32 v37, v37
    v_exp_f32 v38, v38
    v_exp_f32 v39, v39
    v_exp_f32 v40, v40
    v_exp_f32 v41, v41
    v_exp_f32 v42, v42
    v_smfmac_f32_32x32x32_bf16 v[48:63], v[248:251], v[32:39], v2
    v_exp_f32 v43, v43
    v_exp_f32 v44, v44
    v_exp_f32 v45, v45
    v_exp_f32 v46, v46
    v_exp_f32 v47, v47
    v_exp_f32 v16, v16
    v_exp_f32 v17, v17
    v_smfmac_f32_32x32x32_bf16 v[48:63], v[252:255], v[40:47], v2
    v_exp_f32 v18, v18
    v_exp_f32 v19, v19
    v_exp_f32 v20, v20
    v_mfma_f32_32x32x16_bf16 v[32:47], v[68:71], v[8:11], 0
    v_exp_f32 v21, v21
    v_exp_f32 v22, v22
    v_exp_f32 v23, v23
    v_exp_f32 v24, v24
    v_exp_f32 v25, v25
    v_exp_f32 v26, v26
    v_exp_f32 v27, v27
    v_exp_f32 v28, v28
    v_exp_f32 v29, v29
    v_exp_f32 v30, v30
    v_exp_f32 v31, v31
    ds_write_b128 v1, v[48:51] offset:26112
    ds_write_b128 v1, v[52:55] offset:27136
    ds_write_b32 v3, v56 offset:28160
    v_mov_b64 v[48:49], 0
    v_mov_b64 v[50:51], 0
    v_mov_b64 v[52:53], 0
    v_mov_b64 v[54:55], 0
    v_mov_b32 v56, 0
    v_exp_f32 v32, v32
    v_exp_f32 v33, v33
    v_smfmac_f32_32x32x32_bf16 v[48:63], v[128:131], v[16:23], v2
    v_exp_f32 v34, v34
    v_exp_f32 v35, v35
    v_exp_f32 v36, v36
    v_smfmac_f32_32x32x32_bf16 v[48:63], v[132:135], v[24:31], v2
    v_exp_f32 v37, v37
    v_exp_f32 v38, v38
    v_exp_f32 v39, v39
    v_mfma_f32_32x32x16_bf16 v[16:31], v[72:75], v[8:11], 0
    v_exp_f32 v40, v40
    v_exp_f32 v41, v41
    v_exp_f32 v42, v42
    v_smfmac_f32_32x32x32_bf16 v[48:63], v[136:139], v[32:39], v2
    v_exp_f32 v43, v43
    v_exp_f32 v44, v44
    v_exp_f32 v45, v45
    v_exp_f32 v46, v46
    v_exp_f32 v47, v47
    s_nop 2
    v_exp_f32 v16, v16
    v_exp_f32 v17, v17
    v_smfmac_f32_32x32x32_bf16 v[48:63], v[140:143], v[40:47], v2
    v_exp_f32 v18, v18
    v_exp_f32 v19, v19
    v_exp_f32 v20, v20
    v_mfma_f32_32x32x16_bf16 v[32:47], v[76:79], v[8:11], 0
    v_exp_f32 v21, v21
    v_exp_f32 v22, v22
    v_exp_f32 v23, v23
    v_exp_f32 v24, v24
    v_exp_f32 v25, v25
    v_exp_f32 v26, v26
    v_smfmac_f32_32x32x32_bf16 v[48:63], v[144:147], v[16:23], v2
    v_exp_f32 v27, v27
    v_exp_f32 v28, v28
    v_exp_f32 v29, v29
    v_exp_f32 v30, v30
    v_exp_f32 v31, v31
    v_exp_f32 v32, v32
    v_exp_f32 v33, v33
    v_smfmac_f32_32x32x32_bf16 v[48:63], v[148:151], v[24:31], v2
    v_exp_f32 v34, v34
    v_exp_f32 v35, v35
    v_exp_f32 v36, v36
    v_mfma_f32_32x32x16_bf16 v[16:31], v[80:83], v[8:11], 0
    v_exp_f32 v37, v37
    v_exp_f32 v38, v38
    v_exp_f32 v39, v39
    v_exp_f32 v40, v40
    v_exp_f32 v41, v41
    v_exp_f32 v42, v42
    v_smfmac_f32_32x32x32_bf16 v[48:63], v[152:155], v[32:39], v2
    v_exp_f32 v43, v43
    v_exp_f32 v44, v44
    v_exp_f32 v45, v45
    v_exp_f32 v46, v46
    v_exp_f32 v47, v47
    v_exp_f32 v16, v16
    v_exp_f32 v17, v17
    v_smfmac_f32_32x32x32_bf16 v[48:63], v[156:159], v[40:47], v2
    v_exp_f32 v18, v18
    v_exp_f32 v19, v19
    v_exp_f32 v20, v20
    v_mfma_f32_32x32x16_bf16 v[32:47], v[84:87], v[8:11], 0
    v_exp_f32 v21, v21
    v_exp_f32 v22, v22
    v_exp_f32 v23, v23
    v_exp_f32 v24, v24
    v_exp_f32 v25, v25
    v_exp_f32 v26, v26
    v_smfmac_f32_32x32x32_bf16 v[48:63], v[160:163], v[16:23], v2
    v_exp_f32 v27, v27
    v_exp_f32 v28, v28
    v_exp_f32 v29, v29
    v_exp_f32 v30, v30
    v_exp_f32 v31, v31
    v_exp_f32 v32, v32
    v_exp_f32 v33, v33
    v_smfmac_f32_32x32x32_bf16 v[48:63], v[164:167], v[24:31], v2
    v_exp_f32 v34, v34
    v_exp_f32 v35, v35
    v_exp_f32 v36, v36
    v_mfma_f32_32x32x16_bf16 v[16:31], v[88:91], v[8:11], 0
    v_exp_f32 v37, v37
    v_exp_f32 v38, v38
    v_exp_f32 v39, v39
    v_exp_f32 v40, v40
    v_exp_f32 v41, v41
    v_exp_f32 v42, v42
    v_smfmac_f32_32x32x32_bf16 v[48:63], v[168:171], v[32:39], v2
    v_exp_f32 v43, v43
    v_exp_f32 v44, v44
    v_exp_f32 v45, v45
    v_exp_f32 v46, v46
    v_exp_f32 v47, v47
    v_exp_f32 v16, v16
    v_exp_f32 v17, v17
    v_smfmac_f32_32x32x32_bf16 v[48:63], v[172:175], v[40:47], v2
    v_exp_f32 v18, v18
    v_exp_f32 v19, v19
    v_exp_f32 v20, v20
    v_mfma_f32_32x32x16_bf16 v[32:47], v[92:95], v[8:11], 0
    v_exp_f32 v21, v21
    v_exp_f32 v22, v22
    v_exp_f32 v23, v23
    v_exp_f32 v24, v24
    v_exp_f32 v25, v25
    v_exp_f32 v26, v26
    v_smfmac_f32_32x32x32_bf16 v[48:63], v[176:179], v[16:23], v2
    v_exp_f32 v27, v27
    v_exp_f32 v28, v28
    v_exp_f32 v29, v29
    v_exp_f32 v30, v30
    v_exp_f32 v31, v31
    v_exp_f32 v32, v32
    v_exp_f32 v33, v33
    v_smfmac_f32_32x32x32_bf16 v[48:63], v[180:183], v[24:31], v2
    v_exp_f32 v34, v34
    v_exp_f32 v35, v35
    v_exp_f32 v36, v36
    v_mfma_f32_32x32x16_bf16 v[16:31], v[96:99], v[8:11], 0
    v_exp_f32 v37, v37
    v_exp_f32 v38, v38
    v_exp_f32 v39, v39
    v_exp_f32 v40, v40
    v_exp_f32 v41, v41
    v_exp_f32 v42, v42
    v_smfmac_f32_32x32x32_bf16 v[48:63], v[184:187], v[32:39], v2
    v_exp_f32 v43, v43
    v_exp_f32 v44, v44
    v_exp_f32 v45, v45
    v_exp_f32 v46, v46
    v_exp_f32 v47, v47
    v_exp_f32 v16, v16
    v_exp_f32 v17, v17
    v_smfmac_f32_32x32x32_bf16 v[48:63], v[188:191], v[40:47], v2
    v_exp_f32 v18, v18
    v_exp_f32 v19, v19
    v_exp_f32 v20, v20
    v_mfma_f32_32x32x16_bf16 v[32:47], v[100:103], v[8:11], 0
    v_exp_f32 v21, v21
    v_exp_f32 v22, v22
    v_exp_f32 v23, v23
    v_exp_f32 v24, v24
    v_exp_f32 v25, v25
    v_exp_f32 v26, v26
    v_smfmac_f32_32x32x32_bf16 v[48:63], v[192:195], v[16:23], v2
    v_exp_f32 v27, v27
    v_exp_f32 v28, v28
    v_exp_f32 v29, v29
    v_exp_f32 v30, v30
    v_exp_f32 v31, v31
    v_exp_f32 v32, v32
    v_exp_f32 v33, v33
    v_smfmac_f32_32x32x32_bf16 v[48:63], v[196:199], v[24:31], v2
    v_exp_f32 v34, v34
    v_exp_f32 v35, v35
    v_exp_f32 v36, v36
    v_mfma_f32_32x32x16_bf16 v[16:31], v[104:107], v[8:11], 0
    v_exp_f32 v37, v37
    v_exp_f32 v38, v38
    v_exp_f32 v39, v39
    v_exp_f32 v40, v40
    v_exp_f32 v41, v41
    v_exp_f32 v42, v42
    v_smfmac_f32_32x32x32_bf16 v[48:63], v[200:203], v[32:39], v2
    v_exp_f32 v43, v43
    v_exp_f32 v44, v44
    v_exp_f32 v45, v45
    v_exp_f32 v46, v46
    v_exp_f32 v47, v47
    v_exp_f32 v16, v16
    v_exp_f32 v17, v17
    v_smfmac_f32_32x32x32_bf16 v[48:63], v[204:207], v[40:47], v2
    v_exp_f32 v18, v18
    v_exp_f32 v19, v19
    v_exp_f32 v20, v20
    v_mfma_f32_32x32x16_bf16 v[32:47], v[108:111], v[8:11], 0
    v_exp_f32 v21, v21
    v_exp_f32 v22, v22
    v_exp_f32 v23, v23
    v_exp_f32 v24, v24
    v_exp_f32 v25, v25
    v_exp_f32 v26, v26
    v_smfmac_f32_32x32x32_bf16 v[48:63], v[208:211], v[16:23], v2
    v_exp_f32 v27, v27
    v_exp_f32 v28, v28
    v_exp_f32 v29, v29
    v_exp_f32 v30, v30
    v_exp_f32 v31, v31
    v_exp_f32 v32, v32
    v_exp_f32 v33, v33
    v_smfmac_f32_32x32x32_bf16 v[48:63], v[212:215], v[24:31], v2
    v_exp_f32 v34, v34
    v_exp_f32 v35, v35
    v_exp_f32 v36, v36
    v_mfma_f32_32x32x16_bf16 v[16:31], v[112:115], v[8:11], 0
    v_exp_f32 v37, v37
    v_exp_f32 v38, v38
    v_exp_f32 v39, v39
    v_exp_f32 v40, v40
    v_exp_f32 v41, v41
    v_exp_f32 v42, v42
    v_smfmac_f32_32x32x32_bf16 v[48:63], v[216:219], v[32:39], v2
    v_exp_f32 v43, v43
    v_exp_f32 v44, v44
    v_exp_f32 v45, v45
    v_exp_f32 v46, v46
    v_exp_f32 v47, v47
    v_exp_f32 v16, v16
    v_exp_f32 v17, v17
    v_smfmac_f32_32x32x32_bf16 v[48:63], v[220:223], v[40:47], v2
    v_exp_f32 v18, v18
    v_exp_f32 v19, v19
    v_exp_f32 v20, v20
    v_mfma_f32_32x32x16_bf16 v[32:47], v[116:119], v[8:11], 0
    v_exp_f32 v21, v21
    v_exp_f32 v22, v22
    v_exp_f32 v23, v23
    v_exp_f32 v24, v24
    v_exp_f32 v25, v25
    v_exp_f32 v26, v26
    v_smfmac_f32_32x32x32_bf16 v[48:63], v[224:227], v[16:23], v2
    v_exp_f32 v27, v27
    v_exp_f32 v28, v28
    v_exp_f32 v29, v29
    v_exp_f32 v30, v30
    v_exp_f32 v31, v31
    v_exp_f32 v32, v32
    v_exp_f32 v33, v33
    v_smfmac_f32_32x32x32_bf16 v[48:63], v[228:231], v[24:31], v2
    v_exp_f32 v34, v34
    v_exp_f32 v35, v35
    v_exp_f32 v36, v36
    v_mfma_f32_32x32x16_bf16 v[16:31], v[120:123], v[8:11], 0
    v_exp_f32 v37, v37
    v_exp_f32 v38, v38
    v_exp_f32 v39, v39
    v_exp_f32 v40, v40
    v_exp_f32 v41, v41
    v_exp_f32 v42, v42
    v_smfmac_f32_32x32x32_bf16 v[48:63], v[232:235], v[32:39], v2
    v_exp_f32 v43, v43
    v_exp_f32 v44, v44
    v_exp_f32 v45, v45
    v_exp_f32 v46, v46
    v_exp_f32 v47, v47
    v_exp_f32 v16, v16
    v_exp_f32 v17, v17
    v_smfmac_f32_32x32x32_bf16 v[48:63], v[236:239], v[40:47], v2
    v_exp_f32 v18, v18
    v_exp_f32 v19, v19
    v_exp_f32 v20, v20
    v_mfma_f32_32x32x16_bf16 v[32:47], v[124:127], v[8:11], 0
    v_exp_f32 v21, v21
    v_exp_f32 v22, v22
    ds_read_b128 v[8:11], v12 offset:5120
    v_exp_f32 v23, v23
    v_exp_f32 v24, v24
    v_exp_f32 v25, v25
    v_exp_f32 v26, v26
    v_smfmac_f32_32x32x32_bf16 v[48:63], v[240:243], v[16:23], v2
    v_exp_f32 v27, v27
    v_exp_f32 v28, v28
    v_exp_f32 v29, v29
    v_exp_f32 v30, v30
    v_exp_f32 v31, v31
    v_exp_f32 v32, v32
    v_exp_f32 v33, v33
    v_smfmac_f32_32x32x32_bf16 v[48:63], v[244:247], v[24:31], v2
    v_exp_f32 v34, v34
    v_exp_f32 v35, v35
    v_exp_f32 v36, v36
    s_waitcnt lgkmcnt(0)
    v_mfma_f32_32x32x16_bf16 v[16:31], v[64:67], v[8:11], 0
    v_exp_f32 v37, v37
    v_exp_f32 v38, v38
    v_exp_f32 v39, v39
    v_exp_f32 v40, v40
    v_exp_f32 v41, v41
    v_exp_f32 v42, v42
    v_smfmac_f32_32x32x32_bf16 v[48:63], v[248:251], v[32:39], v2
    v_exp_f32 v43, v43
    v_exp_f32 v44, v44
    v_exp_f32 v45, v45
    v_exp_f32 v46, v46
    v_exp_f32 v47, v47
    v_exp_f32 v16, v16
    v_exp_f32 v17, v17
    v_smfmac_f32_32x32x32_bf16 v[48:63], v[252:255], v[40:47], v2
    v_exp_f32 v18, v18
    v_exp_f32 v19, v19
    v_exp_f32 v20, v20
    v_mfma_f32_32x32x16_bf16 v[32:47], v[68:71], v[8:11], 0
    v_exp_f32 v21, v21
    v_exp_f32 v22, v22
    v_exp_f32 v23, v23
    v_exp_f32 v24, v24
    v_exp_f32 v25, v25
    v_exp_f32 v26, v26
    v_exp_f32 v27, v27
    v_exp_f32 v28, v28
    v_exp_f32 v29, v29
    v_exp_f32 v30, v30
    v_exp_f32 v31, v31
    ds_write_b128 v1, v[48:51] offset:34816
    ds_write_b128 v1, v[52:55] offset:35840
    ds_write_b32 v3, v56 offset:36864
    v_mov_b64 v[48:49], 0
    v_mov_b64 v[50:51], 0
    v_mov_b64 v[52:53], 0
    v_mov_b64 v[54:55], 0
    v_mov_b32 v56, 0
    v_exp_f32 v32, v32
    v_exp_f32 v33, v33
    v_smfmac_f32_32x32x32_bf16 v[48:63], v[128:131], v[16:23], v2
    v_exp_f32 v34, v34
    v_exp_f32 v35, v35
    v_exp_f32 v36, v36
    v_smfmac_f32_32x32x32_bf16 v[48:63], v[132:135], v[24:31], v2
    v_exp_f32 v37, v37
    v_exp_f32 v38, v38
    v_exp_f32 v39, v39
    v_mfma_f32_32x32x16_bf16 v[16:31], v[72:75], v[8:11], 0
    v_exp_f32 v40, v40
    v_exp_f32 v41, v41
    v_exp_f32 v42, v42
    v_smfmac_f32_32x32x32_bf16 v[48:63], v[136:139], v[32:39], v2
    v_exp_f32 v43, v43
    v_exp_f32 v44, v44
    v_exp_f32 v45, v45
    v_exp_f32 v46, v46
    v_exp_f32 v47, v47
    s_nop 2
    v_exp_f32 v16, v16
    v_exp_f32 v17, v17
    v_smfmac_f32_32x32x32_bf16 v[48:63], v[140:143], v[40:47], v2
    v_exp_f32 v18, v18
    v_exp_f32 v19, v19
    v_exp_f32 v20, v20
    v_mfma_f32_32x32x16_bf16 v[32:47], v[76:79], v[8:11], 0
    v_exp_f32 v21, v21
    v_exp_f32 v22, v22
    v_exp_f32 v23, v23
    v_exp_f32 v24, v24
    v_exp_f32 v25, v25
    v_exp_f32 v26, v26
    v_smfmac_f32_32x32x32_bf16 v[48:63], v[144:147], v[16:23], v2
    v_exp_f32 v27, v27
    v_exp_f32 v28, v28
    v_exp_f32 v29, v29
    v_exp_f32 v30, v30
    v_exp_f32 v31, v31
    v_exp_f32 v32, v32
    v_exp_f32 v33, v33
    v_smfmac_f32_32x32x32_bf16 v[48:63], v[148:151], v[24:31], v2
    v_exp_f32 v34, v34
    v_exp_f32 v35, v35
    v_exp_f32 v36, v36
    v_mfma_f32_32x32x16_bf16 v[16:31], v[80:83], v[8:11], 0
    v_exp_f32 v37, v37
    v_exp_f32 v38, v38
    v_exp_f32 v39, v39
    v_exp_f32 v40, v40
    v_exp_f32 v41, v41
    v_exp_f32 v42, v42
    v_smfmac_f32_32x32x32_bf16 v[48:63], v[152:155], v[32:39], v2
    v_exp_f32 v43, v43
    v_exp_f32 v44, v44
    v_exp_f32 v45, v45
    v_exp_f32 v46, v46
    v_exp_f32 v47, v47
    v_exp_f32 v16, v16
    v_exp_f32 v17, v17
    v_smfmac_f32_32x32x32_bf16 v[48:63], v[156:159], v[40:47], v2
    v_exp_f32 v18, v18
    v_exp_f32 v19, v19
    v_exp_f32 v20, v20
    v_mfma_f32_32x32x16_bf16 v[32:47], v[84:87], v[8:11], 0
    v_exp_f32 v21, v21
    v_exp_f32 v22, v22
    v_exp_f32 v23, v23
    v_exp_f32 v24, v24
    v_exp_f32 v25, v25
    v_exp_f32 v26, v26
    v_smfmac_f32_32x32x32_bf16 v[48:63], v[160:163], v[16:23], v2
    v_exp_f32 v27, v27
    v_exp_f32 v28, v28
    v_exp_f32 v29, v29
    v_exp_f32 v30, v30
    v_exp_f32 v31, v31
    v_exp_f32 v32, v32
    v_exp_f32 v33, v33
    v_smfmac_f32_32x32x32_bf16 v[48:63], v[164:167], v[24:31], v2
    v_exp_f32 v34, v34
    v_exp_f32 v35, v35
    v_exp_f32 v36, v36
    v_mfma_f32_32x32x16_bf16 v[16:31], v[88:91], v[8:11], 0
    v_exp_f32 v37, v37
    v_exp_f32 v38, v38
    v_exp_f32 v39, v39
    v_exp_f32 v40, v40
    v_exp_f32 v41, v41
    v_exp_f32 v42, v42
    v_smfmac_f32_32x32x32_bf16 v[48:63], v[168:171], v[32:39], v2
    v_exp_f32 v43, v43
    v_exp_f32 v44, v44
    v_exp_f32 v45, v45
    v_exp_f32 v46, v46
    v_exp_f32 v47, v47
    v_exp_f32 v16, v16
    v_exp_f32 v17, v17
    v_smfmac_f32_32x32x32_bf16 v[48:63], v[172:175], v[40:47], v2
    v_exp_f32 v18, v18
    v_exp_f32 v19, v19
    v_exp_f32 v20, v20
    v_mfma_f32_32x32x16_bf16 v[32:47], v[92:95], v[8:11], 0
    v_exp_f32 v21, v21
    v_exp_f32 v22, v22
    v_exp_f32 v23, v23
    v_exp_f32 v24, v24
    v_exp_f32 v25, v25
    v_exp_f32 v26, v26
    v_smfmac_f32_32x32x32_bf16 v[48:63], v[176:179], v[16:23], v2
    v_exp_f32 v27, v27
    v_exp_f32 v28, v28
    v_exp_f32 v29, v29
    v_exp_f32 v30, v30
    v_exp_f32 v31, v31
    v_exp_f32 v32, v32
    v_exp_f32 v33, v33
    v_smfmac_f32_32x32x32_bf16 v[48:63], v[180:183], v[24:31], v2
    v_exp_f32 v34, v34
    v_exp_f32 v35, v35
    v_exp_f32 v36, v36
    v_mfma_f32_32x32x16_bf16 v[16:31], v[96:99], v[8:11], 0
    v_exp_f32 v37, v37
    v_exp_f32 v38, v38
    v_exp_f32 v39, v39
    v_exp_f32 v40, v40
    v_exp_f32 v41, v41
    v_exp_f32 v42, v42
    v_smfmac_f32_32x32x32_bf16 v[48:63], v[184:187], v[32:39], v2
    v_exp_f32 v43, v43
    v_exp_f32 v44, v44
    v_exp_f32 v45, v45
    v_exp_f32 v46, v46
    v_exp_f32 v47, v47
    v_exp_f32 v16, v16
    v_exp_f32 v17, v17
    v_smfmac_f32_32x32x32_bf16 v[48:63], v[188:191], v[40:47], v2
    v_exp_f32 v18, v18
    v_exp_f32 v19, v19
    v_exp_f32 v20, v20
    v_mfma_f32_32x32x16_bf16 v[32:47], v[100:103], v[8:11], 0
    v_exp_f32 v21, v21
    v_exp_f32 v22, v22
    v_exp_f32 v23, v23
    v_exp_f32 v24, v24
    v_exp_f32 v25, v25
    v_exp_f32 v26, v26
    v_smfmac_f32_32x32x32_bf16 v[48:63], v[192:195], v[16:23], v2
    v_exp_f32 v27, v27
    v_exp_f32 v28, v28
    v_exp_f32 v29, v29
    v_exp_f32 v30, v30
    v_exp_f32 v31, v31
    v_exp_f32 v32, v32
    v_exp_f32 v33, v33
    v_smfmac_f32_32x32x32_bf16 v[48:63], v[196:199], v[24:31], v2
    v_exp_f32 v34, v34
    v_exp_f32 v35, v35
    v_exp_f32 v36, v36
    v_mfma_f32_32x32x16_bf16 v[16:31], v[104:107], v[8:11], 0
    v_exp_f32 v37, v37
    v_exp_f32 v38, v38
    v_exp_f32 v39, v39
    v_exp_f32 v40, v40
    v_exp_f32 v41, v41
    v_exp_f32 v42, v42
    v_smfmac_f32_32x32x32_bf16 v[48:63], v[200:203], v[32:39], v2
    v_exp_f32 v43, v43
    v_exp_f32 v44, v44
    v_exp_f32 v45, v45
    v_exp_f32 v46, v46
    v_exp_f32 v47, v47
    v_exp_f32 v16, v16
    v_exp_f32 v17, v17
    v_smfmac_f32_32x32x32_bf16 v[48:63], v[204:207], v[40:47], v2
    v_exp_f32 v18, v18
    v_exp_f32 v19, v19
    v_exp_f32 v20, v20
    v_mfma_f32_32x32x16_bf16 v[32:47], v[108:111], v[8:11], 0
    v_exp_f32 v21, v21
    v_exp_f32 v22, v22
    v_exp_f32 v23, v23
    v_exp_f32 v24, v24
    v_exp_f32 v25, v25
    v_exp_f32 v26, v26
    v_smfmac_f32_32x32x32_bf16 v[48:63], v[208:211], v[16:23], v2
    v_exp_f32 v27, v27
    v_exp_f32 v28, v28
    v_exp_f32 v29, v29
    v_exp_f32 v30, v30
    v_exp_f32 v31, v31
    v_exp_f32 v32, v32
    v_exp_f32 v33, v33
    v_smfmac_f32_32x32x32_bf16 v[48:63], v[212:215], v[24:31], v2
    v_exp_f32 v34, v34
    v_exp_f32 v35, v35
    v_exp_f32 v36, v36
    v_mfma_f32_32x32x16_bf16 v[16:31], v[112:115], v[8:11], 0
    v_exp_f32 v37, v37
    v_exp_f32 v38, v38
    v_exp_f32 v39, v39
    v_exp_f32 v40, v40
    v_exp_f32 v41, v41
    v_exp_f32 v42, v42
    v_smfmac_f32_32x32x32_bf16 v[48:63], v[216:219], v[32:39], v2
    v_exp_f32 v43, v43
    v_exp_f32 v44, v44
    v_exp_f32 v45, v45
    v_exp_f32 v46, v46
    v_exp_f32 v47, v47
    v_exp_f32 v16, v16
    v_exp_f32 v17, v17
    v_smfmac_f32_32x32x32_bf16 v[48:63], v[220:223], v[40:47], v2
    v_exp_f32 v18, v18
    v_exp_f32 v19, v19
    v_exp_f32 v20, v20
    v_mfma_f32_32x32x16_bf16 v[32:47], v[116:119], v[8:11], 0
    v_exp_f32 v21, v21
    v_exp_f32 v22, v22
    v_exp_f32 v23, v23
    v_exp_f32 v24, v24
    v_exp_f32 v25, v25
    v_exp_f32 v26, v26
    v_smfmac_f32_32x32x32_bf16 v[48:63], v[224:227], v[16:23], v2
    v_exp_f32 v27, v27
    v_exp_f32 v28, v28
    v_exp_f32 v29, v29
    v_exp_f32 v30, v30
    v_exp_f32 v31, v31
    v_exp_f32 v32, v32
    v_exp_f32 v33, v33
    v_smfmac_f32_32x32x32_bf16 v[48:63], v[228:231], v[24:31], v2
    v_exp_f32 v34, v34
    v_exp_f32 v35, v35
    v_exp_f32 v36, v36
    v_mfma_f32_32x32x16_bf16 v[16:31], v[120:123], v[8:11], 0
    v_exp_f32 v37, v37
    v_exp_f32 v38, v38
    v_exp_f32 v39, v39
    v_exp_f32 v40, v40
    v_exp_f32 v41, v41
    v_exp_f32 v42, v42
    v_smfmac_f32_32x32x32_bf16 v[48:63], v[232:235], v[32:39], v2
    v_exp_f32 v43, v43
    v_exp_f32 v44, v44
    v_exp_f32 v45, v45
    v_exp_f32 v46, v46
    v_exp_f32 v47, v47
    v_exp_f32 v16, v16
    v_exp_f32 v17, v17
    v_smfmac_f32_32x32x32_bf16 v[48:63], v[236:239], v[40:47], v2
    v_exp_f32 v18, v18
    v_exp_f32 v19, v19
    v_exp_f32 v20, v20
    v_mfma_f32_32x32x16_bf16 v[32:47], v[124:127], v[8:11], 0
    v_exp_f32 v21, v21
    v_exp_f32 v22, v22
    ds_read_b128 v[8:11], v12 offset:6144
    v_exp_f32 v23, v23
    v_exp_f32 v24, v24
    v_exp_f32 v25, v25
    v_exp_f32 v26, v26
    v_smfmac_f32_32x32x32_bf16 v[48:63], v[240:243], v[16:23], v2
    v_exp_f32 v27, v27
    v_exp_f32 v28, v28
    v_exp_f32 v29, v29
    v_exp_f32 v30, v30
    v_exp_f32 v31, v31
    v_exp_f32 v32, v32
    v_exp_f32 v33, v33
    v_smfmac_f32_32x32x32_bf16 v[48:63], v[244:247], v[24:31], v2
    v_exp_f32 v34, v34
    v_exp_f32 v35, v35
    v_exp_f32 v36, v36
    s_waitcnt lgkmcnt(0)
    v_mfma_f32_32x32x16_bf16 v[16:31], v[64:67], v[8:11], 0
    v_exp_f32 v37, v37
    v_exp_f32 v38, v38
    v_exp_f32 v39, v39
    v_exp_f32 v40, v40
    v_exp_f32 v41, v41
    v_exp_f32 v42, v42
    v_smfmac_f32_32x32x32_bf16 v[48:63], v[248:251], v[32:39], v2
    v_exp_f32 v43, v43
    v_exp_f32 v44, v44
    v_exp_f32 v45, v45
    v_exp_f32 v46, v46
    v_exp_f32 v47, v47
    v_exp_f32 v16, v16
    v_exp_f32 v17, v17
    v_smfmac_f32_32x32x32_bf16 v[48:63], v[252:255], v[40:47], v2
    v_exp_f32 v18, v18
    v_exp_f32 v19, v19
    v_exp_f32 v20, v20
    v_mfma_f32_32x32x16_bf16 v[32:47], v[68:71], v[8:11], 0
    v_exp_f32 v21, v21
    v_exp_f32 v22, v22
    v_exp_f32 v23, v23
    v_exp_f32 v24, v24
    v_exp_f32 v25, v25
    v_exp_f32 v26, v26
    v_exp_f32 v27, v27
    v_exp_f32 v28, v28
    v_exp_f32 v29, v29
    v_exp_f32 v30, v30
    v_exp_f32 v31, v31
    ds_write_b128 v1, v[48:51] offset:43520
    ds_write_b128 v1, v[52:55] offset:44544
    ds_write_b32 v3, v56 offset:45568
    v_mov_b64 v[48:49], 0
    v_mov_b64 v[50:51], 0
    v_mov_b64 v[52:53], 0
    v_mov_b64 v[54:55], 0
    v_mov_b32 v56, 0
    v_exp_f32 v32, v32
    v_exp_f32 v33, v33
    v_smfmac_f32_32x32x32_bf16 v[48:63], v[128:131], v[16:23], v2
    v_exp_f32 v34, v34
    v_exp_f32 v35, v35
    v_exp_f32 v36, v36
    v_smfmac_f32_32x32x32_bf16 v[48:63], v[132:135], v[24:31], v2
    v_exp_f32 v37, v37
    v_exp_f32 v38, v38
    v_exp_f32 v39, v39
    v_mfma_f32_32x32x16_bf16 v[16:31], v[72:75], v[8:11], 0
    v_exp_f32 v40, v40
    v_exp_f32 v41, v41
    v_exp_f32 v42, v42
    v_smfmac_f32_32x32x32_bf16 v[48:63], v[136:139], v[32:39], v2
    v_exp_f32 v43, v43
    v_exp_f32 v44, v44
    v_exp_f32 v45, v45
    v_exp_f32 v46, v46
    v_exp_f32 v47, v47
    s_nop 2
    v_exp_f32 v16, v16
    v_exp_f32 v17, v17
    v_smfmac_f32_32x32x32_bf16 v[48:63], v[140:143], v[40:47], v2
    v_exp_f32 v18, v18
    v_exp_f32 v19, v19
    v_exp_f32 v20, v20
    v_mfma_f32_32x32x16_bf16 v[32:47], v[76:79], v[8:11], 0
    v_exp_f32 v21, v21
    v_exp_f32 v22, v22
    v_exp_f32 v23, v23
    v_exp_f32 v24, v24
    v_exp_f32 v25, v25
    v_exp_f32 v26, v26
    v_smfmac_f32_32x32x32_bf16 v[48:63], v[144:147], v[16:23], v2
    v_exp_f32 v27, v27
    v_exp_f32 v28, v28
    v_exp_f32 v29, v29
    v_exp_f32 v30, v30
    v_exp_f32 v31, v31
    v_exp_f32 v32, v32
    v_exp_f32 v33, v33
    v_smfmac_f32_32x32x32_bf16 v[48:63], v[148:151], v[24:31], v2
    v_exp_f32 v34, v34
    v_exp_f32 v35, v35
    v_exp_f32 v36, v36
    v_mfma_f32_32x32x16_bf16 v[16:31], v[80:83], v[8:11], 0
    v_exp_f32 v37, v37
    v_exp_f32 v38, v38
    v_exp_f32 v39, v39
    v_exp_f32 v40, v40
    v_exp_f32 v41, v41
    v_exp_f32 v42, v42
    v_smfmac_f32_32x32x32_bf16 v[48:63], v[152:155], v[32:39], v2
    v_exp_f32 v43, v43
    v_exp_f32 v44, v44
    v_exp_f32 v45, v45
    v_exp_f32 v46, v46
    v_exp_f32 v47, v47
    v_exp_f32 v16, v16
    v_exp_f32 v17, v17
    v_smfmac_f32_32x32x32_bf16 v[48:63], v[156:159], v[40:47], v2
    v_exp_f32 v18, v18
    v_exp_f32 v19, v19
    v_exp_f32 v20, v20
    v_mfma_f32_32x32x16_bf16 v[32:47], v[84:87], v[8:11], 0
    v_exp_f32 v21, v21
    v_exp_f32 v22, v22
    v_exp_f32 v23, v23
    v_exp_f32 v24, v24
    v_exp_f32 v25, v25
    v_exp_f32 v26, v26
    v_smfmac_f32_32x32x32_bf16 v[48:63], v[160:163], v[16:23], v2
    v_exp_f32 v27, v27
    v_exp_f32 v28, v28
    v_exp_f32 v29, v29
    v_exp_f32 v30, v30
    v_exp_f32 v31, v31
    v_exp_f32 v32, v32
    v_exp_f32 v33, v33
    v_smfmac_f32_32x32x32_bf16 v[48:63], v[164:167], v[24:31], v2
    v_exp_f32 v34, v34
    v_exp_f32 v35, v35
    v_exp_f32 v36, v36
    v_mfma_f32_32x32x16_bf16 v[16:31], v[88:91], v[8:11], 0
    v_exp_f32 v37, v37
    v_exp_f32 v38, v38
    v_exp_f32 v39, v39
    v_exp_f32 v40, v40
    v_exp_f32 v41, v41
    v_exp_f32 v42, v42
    v_smfmac_f32_32x32x32_bf16 v[48:63], v[168:171], v[32:39], v2
    v_exp_f32 v43, v43
    v_exp_f32 v44, v44
    v_exp_f32 v45, v45
    v_exp_f32 v46, v46
    v_exp_f32 v47, v47
    v_exp_f32 v16, v16
    v_exp_f32 v17, v17
    v_smfmac_f32_32x32x32_bf16 v[48:63], v[172:175], v[40:47], v2
    v_exp_f32 v18, v18
    v_exp_f32 v19, v19
    v_exp_f32 v20, v20
    v_mfma_f32_32x32x16_bf16 v[32:47], v[92:95], v[8:11], 0
    v_exp_f32 v21, v21
    v_exp_f32 v22, v22
    v_exp_f32 v23, v23
    v_exp_f32 v24, v24
    v_exp_f32 v25, v25
    v_exp_f32 v26, v26
    v_smfmac_f32_32x32x32_bf16 v[48:63], v[176:179], v[16:23], v2
    v_exp_f32 v27, v27
    v_exp_f32 v28, v28
    v_exp_f32 v29, v29
    v_exp_f32 v30, v30
    v_exp_f32 v31, v31
    v_exp_f32 v32, v32
    v_exp_f32 v33, v33
    v_smfmac_f32_32x32x32_bf16 v[48:63], v[180:183], v[24:31], v2
    v_exp_f32 v34, v34
    v_exp_f32 v35, v35
    v_exp_f32 v36, v36
    v_mfma_f32_32x32x16_bf16 v[16:31], v[96:99], v[8:11], 0
    v_exp_f32 v37, v37
    v_exp_f32 v38, v38
    v_exp_f32 v39, v39
    v_exp_f32 v40, v40
    v_exp_f32 v41, v41
    v_exp_f32 v42, v42
    v_smfmac_f32_32x32x32_bf16 v[48:63], v[184:187], v[32:39], v2
    v_exp_f32 v43, v43
    v_exp_f32 v44, v44
    v_exp_f32 v45, v45
    v_exp_f32 v46, v46
    v_exp_f32 v47, v47
    v_exp_f32 v16, v16
    v_exp_f32 v17, v17
    v_smfmac_f32_32x32x32_bf16 v[48:63], v[188:191], v[40:47], v2
    v_exp_f32 v18, v18
    v_exp_f32 v19, v19
    v_exp_f32 v20, v20
    v_mfma_f32_32x32x16_bf16 v[32:47], v[100:103], v[8:11], 0
    v_exp_f32 v21, v21
    v_exp_f32 v22, v22
    v_exp_f32 v23, v23
    v_exp_f32 v24, v24
    v_exp_f32 v25, v25
    v_exp_f32 v26, v26
    v_smfmac_f32_32x32x32_bf16 v[48:63], v[192:195], v[16:23], v2
    v_exp_f32 v27, v27
    v_exp_f32 v28, v28
    v_exp_f32 v29, v29
    v_exp_f32 v30, v30
    v_exp_f32 v31, v31
    v_exp_f32 v32, v32
    v_exp_f32 v33, v33
    v_smfmac_f32_32x32x32_bf16 v[48:63], v[196:199], v[24:31], v2
    v_exp_f32 v34, v34
    v_exp_f32 v35, v35
    v_exp_f32 v36, v36
    v_mfma_f32_32x32x16_bf16 v[16:31], v[104:107], v[8:11], 0
    v_exp_f32 v37, v37
    v_exp_f32 v38, v38
    v_exp_f32 v39, v39
    v_exp_f32 v40, v40
    v_exp_f32 v41, v41
    v_exp_f32 v42, v42
    v_smfmac_f32_32x32x32_bf16 v[48:63], v[200:203], v[32:39], v2
    v_exp_f32 v43, v43
    v_exp_f32 v44, v44
    v_exp_f32 v45, v45
    v_exp_f32 v46, v46
    v_exp_f32 v47, v47
    v_exp_f32 v16, v16
    v_exp_f32 v17, v17
    v_smfmac_f32_32x32x32_bf16 v[48:63], v[204:207], v[40:47], v2
    v_exp_f32 v18, v18
    v_exp_f32 v19, v19
    v_exp_f32 v20, v20
    v_mfma_f32_32x32x16_bf16 v[32:47], v[108:111], v[8:11], 0
    v_exp_f32 v21, v21
    v_exp_f32 v22, v22
    v_exp_f32 v23, v23
    v_exp_f32 v24, v24
    v_exp_f32 v25, v25
    v_exp_f32 v26, v26
    v_smfmac_f32_32x32x32_bf16 v[48:63], v[208:211], v[16:23], v2
    v_exp_f32 v27, v27
    v_exp_f32 v28, v28
    v_exp_f32 v29, v29
    v_exp_f32 v30, v30
    v_exp_f32 v31, v31
    v_exp_f32 v32, v32
    v_exp_f32 v33, v33
    v_smfmac_f32_32x32x32_bf16 v[48:63], v[212:215], v[24:31], v2
    v_exp_f32 v34, v34
    v_exp_f32 v35, v35
    v_exp_f32 v36, v36
    v_mfma_f32_32x32x16_bf16 v[16:31], v[112:115], v[8:11], 0
    v_exp_f32 v37, v37
    v_exp_f32 v38, v38
    v_exp_f32 v39, v39
    v_exp_f32 v40, v40
    v_exp_f32 v41, v41
    v_exp_f32 v42, v42
    v_smfmac_f32_32x32x32_bf16 v[48:63], v[216:219], v[32:39], v2
    v_exp_f32 v43, v43
    v_exp_f32 v44, v44
    v_exp_f32 v45, v45
    v_exp_f32 v46, v46
    v_exp_f32 v47, v47
    v_exp_f32 v16, v16
    v_exp_f32 v17, v17
    v_smfmac_f32_32x32x32_bf16 v[48:63], v[220:223], v[40:47], v2
    v_exp_f32 v18, v18
    v_exp_f32 v19, v19
    v_exp_f32 v20, v20
    v_mfma_f32_32x32x16_bf16 v[32:47], v[116:119], v[8:11], 0
    v_exp_f32 v21, v21
    v_exp_f32 v22, v22
    v_exp_f32 v23, v23
    v_exp_f32 v24, v24
    v_exp_f32 v25, v25
    v_exp_f32 v26, v26
    v_smfmac_f32_32x32x32_bf16 v[48:63], v[224:227], v[16:23], v2
    v_exp_f32 v27, v27
    v_exp_f32 v28, v28
    v_exp_f32 v29, v29
    v_exp_f32 v30, v30
    v_exp_f32 v31, v31
    v_exp_f32 v32, v32
    v_exp_f32 v33, v33
    v_smfmac_f32_32x32x32_bf16 v[48:63], v[228:231], v[24:31], v2
    v_exp_f32 v34, v34
    v_exp_f32 v35, v35
    v_exp_f32 v36, v36
    v_mfma_f32_32x32x16_bf16 v[16:31], v[120:123], v[8:11], 0
    v_exp_f32 v37, v37
    v_exp_f32 v38, v38
    v_exp_f32 v39, v39
    v_exp_f32 v40, v40
    v_exp_f32 v41, v41
    v_exp_f32 v42, v42
    v_smfmac_f32_32x32x32_bf16 v[48:63], v[232:235], v[32:39], v2
    v_exp_f32 v43, v43
    v_exp_f32 v44, v44
    v_exp_f32 v45, v45
    v_exp_f32 v46, v46
    v_exp_f32 v47, v47
    v_exp_f32 v16, v16
    v_exp_f32 v17, v17
    v_smfmac_f32_32x32x32_bf16 v[48:63], v[236:239], v[40:47], v2
    v_exp_f32 v18, v18
    v_exp_f32 v19, v19
    v_exp_f32 v20, v20
    v_mfma_f32_32x32x16_bf16 v[32:47], v[124:127], v[8:11], 0
    v_exp_f32 v21, v21
    v_exp_f32 v22, v22
    ds_read_b128 v[8:11], v12 offset:7168
    v_exp_f32 v23, v23
    v_exp_f32 v24, v24
    v_exp_f32 v25, v25
    v_exp_f32 v26, v26
    v_smfmac_f32_32x32x32_bf16 v[48:63], v[240:243], v[16:23], v2
    v_exp_f32 v27, v27
    v_exp_f32 v28, v28
    v_exp_f32 v29, v29
    v_exp_f32 v30, v30
    v_exp_f32 v31, v31
    v_exp_f32 v32, v32
    v_exp_f32 v33, v33
    v_smfmac_f32_32x32x32_bf16 v[48:63], v[244:247], v[24:31], v2
    v_exp_f32 v34, v34
    v_exp_f32 v35, v35
    v_exp_f32 v36, v36
    s_waitcnt lgkmcnt(0)
    v_mfma_f32_32x32x16_bf16 v[16:31], v[64:67], v[8:11], 0
    v_exp_f32 v37, v37
    v_exp_f32 v38, v38
    v_exp_f32 v39, v39
    v_exp_f32 v40, v40
    v_exp_f32 v41, v41
    v_exp_f32 v42, v42
    v_smfmac_f32_32x32x32_bf16 v[48:63], v[248:251], v[32:39], v2
    v_exp_f32 v43, v43
    v_exp_f32 v44, v44
    v_exp_f32 v45, v45
    v_exp_f32 v46, v46
    v_exp_f32 v47, v47
    v_exp_f32 v16, v16
    v_exp_f32 v17, v17
    v_smfmac_f32_32x32x32_bf16 v[48:63], v[252:255], v[40:47], v2
    v_exp_f32 v18, v18
    v_exp_f32 v19, v19
    v_exp_f32 v20, v20
    v_mfma_f32_32x32x16_bf16 v[32:47], v[68:71], v[8:11], 0
    v_exp_f32 v21, v21
    v_exp_f32 v22, v22
    v_exp_f32 v23, v23
    v_exp_f32 v24, v24
    v_exp_f32 v25, v25
    v_exp_f32 v26, v26
    v_exp_f32 v27, v27
    v_exp_f32 v28, v28
    v_exp_f32 v29, v29
    v_exp_f32 v30, v30
    v_exp_f32 v31, v31
    ds_write_b128 v1, v[48:51] offset:52224
    ds_write_b128 v1, v[52:55] offset:53248
    ds_write_b32 v3, v56 offset:54272
    v_mov_b64 v[48:49], 0
    v_mov_b64 v[50:51], 0
    v_mov_b64 v[52:53], 0
    v_mov_b64 v[54:55], 0
    v_mov_b32 v56, 0
    buffer_load_dword v6, v5, s[48:51], s84 offen offset:0 sc1
    buffer_load_dword v7, v5, s[48:51], s84 offen offset:64 sc1
    v_exp_f32 v32, v32
    v_exp_f32 v33, v33
    v_smfmac_f32_32x32x32_bf16 v[48:63], v[128:131], v[16:23], v2
    v_exp_f32 v34, v34
    v_exp_f32 v35, v35
    v_exp_f32 v36, v36
    v_smfmac_f32_32x32x32_bf16 v[48:63], v[132:135], v[24:31], v2
    v_exp_f32 v37, v37
    v_exp_f32 v38, v38
    v_exp_f32 v39, v39
    v_mfma_f32_32x32x16_bf16 v[16:31], v[72:75], v[8:11], 0
    v_exp_f32 v40, v40
    v_exp_f32 v41, v41
    v_exp_f32 v42, v42
    v_smfmac_f32_32x32x32_bf16 v[48:63], v[136:139], v[32:39], v2
    v_exp_f32 v43, v43
    v_exp_f32 v44, v44
    v_exp_f32 v45, v45
    v_exp_f32 v46, v46
    v_exp_f32 v47, v47
    s_nop 2
    v_exp_f32 v16, v16
    v_exp_f32 v17, v17
    v_smfmac_f32_32x32x32_bf16 v[48:63], v[140:143], v[40:47], v2
    v_exp_f32 v18, v18
    v_exp_f32 v19, v19
    v_exp_f32 v20, v20
    v_mfma_f32_32x32x16_bf16 v[32:47], v[76:79], v[8:11], 0
    v_exp_f32 v21, v21
    v_exp_f32 v22, v22
    v_exp_f32 v23, v23
    v_exp_f32 v24, v24
    v_exp_f32 v25, v25
    v_exp_f32 v26, v26
    v_smfmac_f32_32x32x32_bf16 v[48:63], v[144:147], v[16:23], v2
    v_exp_f32 v27, v27
    v_exp_f32 v28, v28
    v_exp_f32 v29, v29
    v_exp_f32 v30, v30
    v_exp_f32 v31, v31
    v_exp_f32 v32, v32
    v_exp_f32 v33, v33
    v_smfmac_f32_32x32x32_bf16 v[48:63], v[148:151], v[24:31], v2
    v_exp_f32 v34, v34
    v_exp_f32 v35, v35
    v_exp_f32 v36, v36
    v_mfma_f32_32x32x16_bf16 v[16:31], v[80:83], v[8:11], 0
    v_exp_f32 v37, v37
    v_exp_f32 v38, v38
    v_exp_f32 v39, v39
    v_exp_f32 v40, v40
    v_exp_f32 v41, v41
    v_exp_f32 v42, v42
    v_smfmac_f32_32x32x32_bf16 v[48:63], v[152:155], v[32:39], v2
    v_exp_f32 v43, v43
    v_exp_f32 v44, v44
    v_exp_f32 v45, v45
    v_exp_f32 v46, v46
    v_exp_f32 v47, v47
    v_exp_f32 v16, v16
    v_exp_f32 v17, v17
    v_smfmac_f32_32x32x32_bf16 v[48:63], v[156:159], v[40:47], v2
    v_exp_f32 v18, v18
    v_exp_f32 v19, v19
    v_exp_f32 v20, v20
    v_mfma_f32_32x32x16_bf16 v[32:47], v[84:87], v[8:11], 0
    v_exp_f32 v21, v21
    v_exp_f32 v22, v22
    v_exp_f32 v23, v23
    v_exp_f32 v24, v24
    v_exp_f32 v25, v25
    v_exp_f32 v26, v26
    v_smfmac_f32_32x32x32_bf16 v[48:63], v[160:163], v[16:23], v2
    v_exp_f32 v27, v27
    v_exp_f32 v28, v28
    v_exp_f32 v29, v29
    v_exp_f32 v30, v30
    v_exp_f32 v31, v31
    v_exp_f32 v32, v32
    v_exp_f32 v33, v33
    v_smfmac_f32_32x32x32_bf16 v[48:63], v[164:167], v[24:31], v2
    v_exp_f32 v34, v34
    v_exp_f32 v35, v35
    v_exp_f32 v36, v36
    v_mfma_f32_32x32x16_bf16 v[16:31], v[88:91], v[8:11], 0
    v_exp_f32 v37, v37
    v_exp_f32 v38, v38
    v_exp_f32 v39, v39
    v_exp_f32 v40, v40
    v_exp_f32 v41, v41
    v_exp_f32 v42, v42
    v_smfmac_f32_32x32x32_bf16 v[48:63], v[168:171], v[32:39], v2
    v_exp_f32 v43, v43
    v_exp_f32 v44, v44
    v_exp_f32 v45, v45
    v_exp_f32 v46, v46
    v_exp_f32 v47, v47
    v_exp_f32 v16, v16
    v_exp_f32 v17, v17
    v_smfmac_f32_32x32x32_bf16 v[48:63], v[172:175], v[40:47], v2
    v_exp_f32 v18, v18
    v_exp_f32 v19, v19
    v_exp_f32 v20, v20
    v_mfma_f32_32x32x16_bf16 v[32:47], v[92:95], v[8:11], 0
    v_exp_f32 v21, v21
    v_exp_f32 v22, v22
    v_exp_f32 v23, v23
    v_exp_f32 v24, v24
    v_exp_f32 v25, v25
    v_exp_f32 v26, v26
    v_smfmac_f32_32x32x32_bf16 v[48:63], v[176:179], v[16:23], v2
    v_exp_f32 v27, v27
    v_exp_f32 v28, v28
    v_exp_f32 v29, v29
    v_exp_f32 v30, v30
    v_exp_f32 v31, v31
    v_exp_f32 v32, v32
    v_exp_f32 v33, v33
    v_smfmac_f32_32x32x32_bf16 v[48:63], v[180:183], v[24:31], v2
    v_exp_f32 v34, v34
    v_exp_f32 v35, v35
    v_exp_f32 v36, v36
    v_mfma_f32_32x32x16_bf16 v[16:31], v[96:99], v[8:11], 0
    v_exp_f32 v37, v37
    v_exp_f32 v38, v38
    v_exp_f32 v39, v39
    v_exp_f32 v40, v40
    v_exp_f32 v41, v41
    v_exp_f32 v42, v42
    v_smfmac_f32_32x32x32_bf16 v[48:63], v[184:187], v[32:39], v2
    v_exp_f32 v43, v43
    v_exp_f32 v44, v44
    v_exp_f32 v45, v45
    v_exp_f32 v46, v46
    v_exp_f32 v47, v47
    v_exp_f32 v16, v16
    v_exp_f32 v17, v17
    v_smfmac_f32_32x32x32_bf16 v[48:63], v[188:191], v[40:47], v2
    v_exp_f32 v18, v18
    v_exp_f32 v19, v19
    v_exp_f32 v20, v20
    v_mfma_f32_32x32x16_bf16 v[32:47], v[100:103], v[8:11], 0
    v_exp_f32 v21, v21
    v_exp_f32 v22, v22
    v_exp_f32 v23, v23
    v_exp_f32 v24, v24
    v_exp_f32 v25, v25
    v_exp_f32 v26, v26
    v_smfmac_f32_32x32x32_bf16 v[48:63], v[192:195], v[16:23], v2
    v_exp_f32 v27, v27
    v_exp_f32 v28, v28
    v_exp_f32 v29, v29
    v_exp_f32 v30, v30
    v_exp_f32 v31, v31
    v_exp_f32 v32, v32
    v_exp_f32 v33, v33
    v_smfmac_f32_32x32x32_bf16 v[48:63], v[196:199], v[24:31], v2
    v_exp_f32 v34, v34
    v_exp_f32 v35, v35
    v_exp_f32 v36, v36
    v_mfma_f32_32x32x16_bf16 v[16:31], v[104:107], v[8:11], 0
    v_exp_f32 v37, v37
    v_exp_f32 v38, v38
    v_exp_f32 v39, v39
    v_exp_f32 v40, v40
    v_exp_f32 v41, v41
    v_exp_f32 v42, v42
    v_smfmac_f32_32x32x32_bf16 v[48:63], v[200:203], v[32:39], v2
    v_exp_f32 v43, v43
    v_exp_f32 v44, v44
    v_exp_f32 v45, v45
    v_exp_f32 v46, v46
    v_exp_f32 v47, v47
    v_exp_f32 v16, v16
    v_exp_f32 v17, v17
    v_smfmac_f32_32x32x32_bf16 v[48:63], v[204:207], v[40:47], v2
    v_exp_f32 v18, v18
    v_exp_f32 v19, v19
    v_exp_f32 v20, v20
    v_mfma_f32_32x32x16_bf16 v[32:47], v[108:111], v[8:11], 0
    v_exp_f32 v21, v21
    v_exp_f32 v22, v22
    v_exp_f32 v23, v23
    v_exp_f32 v24, v24
    v_exp_f32 v25, v25
    v_exp_f32 v26, v26
    v_smfmac_f32_32x32x32_bf16 v[48:63], v[208:211], v[16:23], v2
    v_exp_f32 v27, v27
    v_exp_f32 v28, v28
    v_exp_f32 v29, v29
    v_exp_f32 v30, v30
    v_exp_f32 v31, v31
    v_exp_f32 v32, v32
    v_exp_f32 v33, v33
    v_smfmac_f32_32x32x32_bf16 v[48:63], v[212:215], v[24:31], v2
    v_exp_f32 v34, v34
    v_exp_f32 v35, v35
    v_exp_f32 v36, v36
    v_mfma_f32_32x32x16_bf16 v[16:31], v[112:115], v[8:11], 0
    v_exp_f32 v37, v37
    v_exp_f32 v38, v38
    v_exp_f32 v39, v39
    v_exp_f32 v40, v40
    v_exp_f32 v41, v41
    v_exp_f32 v42, v42
    v_smfmac_f32_32x32x32_bf16 v[48:63], v[216:219], v[32:39], v2
    v_exp_f32 v43, v43
    v_exp_f32 v44, v44
    v_exp_f32 v45, v45
    v_exp_f32 v46, v46
    v_exp_f32 v47, v47
    v_exp_f32 v16, v16
    v_exp_f32 v17, v17
    v_smfmac_f32_32x32x32_bf16 v[48:63], v[220:223], v[40:47], v2
    v_exp_f32 v18, v18
    v_exp_f32 v19, v19
    v_exp_f32 v20, v20
    v_mfma_f32_32x32x16_bf16 v[32:47], v[116:119], v[8:11], 0
    v_exp_f32 v21, v21
    v_exp_f32 v22, v22
    v_exp_f32 v23, v23
    v_exp_f32 v24, v24
    v_exp_f32 v25, v25
    v_exp_f32 v26, v26
    v_smfmac_f32_32x32x32_bf16 v[48:63], v[224:227], v[16:23], v2
    v_exp_f32 v27, v27
    v_exp_f32 v28, v28
    v_exp_f32 v29, v29
    v_exp_f32 v30, v30
    v_exp_f32 v31, v31
    v_exp_f32 v32, v32
    v_exp_f32 v33, v33
    v_smfmac_f32_32x32x32_bf16 v[48:63], v[228:231], v[24:31], v2
    v_exp_f32 v34, v34
    v_exp_f32 v35, v35
    v_exp_f32 v36, v36
    v_mfma_f32_32x32x16_bf16 v[16:31], v[120:123], v[8:11], 0
    v_exp_f32 v37, v37
    v_exp_f32 v38, v38
    v_exp_f32 v39, v39
    v_exp_f32 v40, v40
    v_exp_f32 v41, v41
    v_exp_f32 v42, v42
    v_smfmac_f32_32x32x32_bf16 v[48:63], v[232:235], v[32:39], v2
    v_exp_f32 v43, v43
    v_exp_f32 v44, v44
    v_exp_f32 v45, v45
    v_exp_f32 v46, v46
    v_exp_f32 v47, v47
    v_exp_f32 v16, v16
    v_exp_f32 v17, v17
    v_smfmac_f32_32x32x32_bf16 v[48:63], v[236:239], v[40:47], v2
    v_exp_f32 v18, v18
    v_exp_f32 v19, v19
    v_exp_f32 v20, v20
    v_mfma_f32_32x32x16_bf16 v[32:47], v[124:127], v[8:11], 0
    v_exp_f32 v21, v21
    v_exp_f32 v22, v22
    v_exp_f32 v23, v23
    v_exp_f32 v24, v24
    v_exp_f32 v25, v25
    v_exp_f32 v26, v26
    v_smfmac_f32_32x32x32_bf16 v[48:63], v[240:243], v[16:23], v2
    v_exp_f32 v27, v27
    v_exp_f32 v28, v28
    v_exp_f32 v29, v29
    v_exp_f32 v30, v30
    v_exp_f32 v31, v31
    v_exp_f32 v32, v32
    v_exp_f32 v33, v33
    v_smfmac_f32_32x32x32_bf16 v[48:63], v[244:247], v[24:31], v2
    v_exp_f32 v34, v34
    v_exp_f32 v35, v35
    v_exp_f32 v36, v36
    v_exp_f32 v37, v37
    v_exp_f32 v38, v38
    v_exp_f32 v39, v39
    v_exp_f32 v40, v40
    v_exp_f32 v41, v41
    v_exp_f32 v42, v42
    v_smfmac_f32_32x32x32_bf16 v[48:63], v[248:251], v[32:39], v2
    v_exp_f32 v43, v43
    v_exp_f32 v44, v44
    v_exp_f32 v45, v45
    v_exp_f32 v46, v46
    v_exp_f32 v47, v47
    s_setprio 3
    s_nop 0
    v_smfmac_f32_32x32x32_bf16 v[48:63], v[252:255], v[40:47], v2
    s_nop 11
    ds_write_b128 v1, v[48:51] offset:60928
    ds_write_b128 v1, v[52:55] offset:61952
    ds_write_b32 v3, v56 offset:62976
L_reduce_16:
    s_mul_i32 s66, s64, 17408
    s_add_u32 s66, s66, 81920
    v_lshl_add_u32 v1, v0, 4, s66
    v_and_b32 v3, 31, v0
    v_lshl_add_u32 v3, v3, 2, s66
    v_mov_b32 v18, 160844
L_marked_17:
    ds_read_b32 v19, v18
    v_mov_b32 v16, 160836
    v_mov_b32 v17, 1
    s_mov_b64 exec, 1
    ds_add_u32 v16, v17
    s_mov_b64 exec, -1
L_ls_18:
    ds_read_b32 v17, v16
    s_waitcnt lgkmcnt(0)
    v_readfirstlane_b32 s76, v17
    s_cmp_lt_u32 s76, 4
    s_cbranch_scc1 L_ls_18
L_markw_20:
    v_readfirstlane_b32 s66, v19
    s_cmp_ge_u32 s66, 4
    s_cbranch_scc1 L_markok_19
    ds_read_b32 v19, v18
    s_waitcnt lgkmcnt(0)
    s_branch L_markw_20
L_markok_19:
    ds_read_b32 v72, v3 offset:2048
    ds_read_b32 v84, v3 offset:4224
    ds_read_b32 v96, v3 offset:6400
    ds_read_b32 v108, v3 offset:8576
    ds_read_b128 v[64:67], v1 offset:0
    ds_read_b128 v[68:71], v1 offset:1024
    ds_read_b128 v[76:79], v1 offset:2176
    ds_read_b128 v[80:83], v1 offset:3200
    ds_read_b128 v[88:91], v1 offset:4352
    ds_read_b128 v[92:95], v1 offset:5376
    ds_read_b128 v[100:103], v1 offset:6528
    ds_read_b128 v[104:107], v1 offset:7552
    s_waitcnt lgkmcnt(8)
    v_add_f32 v72, v72, v84
    v_add_f32 v96, v96, v108
    v_add_f32 v72, v72, v96
    v_rcp_f32 v72, v72
    ds_read_b32 v120, v3 offset:10752
    ds_read_b32 v132, v3 offset:12928
    ds_read_b32 v144, v3 offset:15104
    ds_read_b32 v156, v3 offset:17280
    ds_read_b128 v[112:115], v1 offset:8704
    ds_read_b128 v[116:119], v1 offset:9728
    ds_read_b128 v[124:127], v1 offset:10880
    ds_read_b128 v[128:131], v1 offset:11904
    ds_read_b128 v[136:139], v1 offset:13056
    ds_read_b128 v[140:143], v1 offset:14080
    ds_read_b128 v[148:151], v1 offset:15232
    ds_read_b128 v[152:155], v1 offset:16256
    s_waitcnt lgkmcnt(8)
    v_add_f32 v120, v120, v132
    v_add_f32 v144, v144, v156
    v_add_f32 v120, v120, v144
    v_rcp_f32 v120, v120
    s_waitcnt vmcnt(0)
    v_mul_f32 v72, v72, v6
    v_add_f32 v64, v64, v76
    v_add_f32 v88, v88, v100
    v_add_f32 v65, v65, v77
    v_add_f32 v89, v89, v101
    v_add_f32 v66, v66, v78
    v_add_f32 v90, v90, v102
    v_add_f32 v67, v67, v79
    v_add_f32 v91, v91, v103
    v_add_f32 v68, v68, v80
    v_add_f32 v92, v92, v104
    v_add_f32 v69, v69, v81
    v_add_f32 v93, v93, v105
    v_add_f32 v70, v70, v82
    v_add_f32 v94, v94, v106
    v_add_f32 v71, v71, v83
    v_add_f32 v95, v95, v107
    v_add_f32 v64, v64, v88
    v_add_f32 v65, v65, v89
    v_add_f32 v66, v66, v90
    v_add_f32 v67, v67, v91
    v_add_f32 v68, v68, v92
    v_add_f32 v69, v69, v93
    v_add_f32 v70, v70, v94
    v_add_f32 v71, v71, v95
    v_mul_f32 v64, v64, v72
    v_mul_f32 v65, v65, v72
    v_mul_f32 v66, v66, v72
    v_mul_f32 v67, v67, v72
    v_mul_f32 v68, v68, v72
    v_mul_f32 v69, v69, v72
    v_mul_f32 v70, v70, v72
    v_mul_f32 v71, v71, v72
    v_cvt_pk_bf16_f32 v76, v64, v65
    v_cvt_pk_bf16_f32 v77, v66, v67
    v_cvt_pk_bf16_f32 v78, v68, v69
    v_cvt_pk_bf16_f32 v79, v70, v71
    buffer_store_dwordx4 v[76:79], v4, s[48:51], s88 offen offset:0 sc1
    s_waitcnt lgkmcnt(0)
    v_mul_f32 v120, v120, v7
    v_add_f32 v112, v112, v124
    v_add_f32 v136, v136, v148
    v_add_f32 v113, v113, v125
    v_add_f32 v137, v137, v149
    v_add_f32 v114, v114, v126
    v_add_f32 v138, v138, v150
    v_add_f32 v115, v115, v127
    v_add_f32 v139, v139, v151
    v_add_f32 v116, v116, v128
    v_add_f32 v140, v140, v152
    v_add_f32 v117, v117, v129
    v_add_f32 v141, v141, v153
    v_add_f32 v118, v118, v130
    v_add_f32 v142, v142, v154
    v_add_f32 v119, v119, v131
    v_add_f32 v143, v143, v155
    v_add_f32 v112, v112, v136
    v_add_f32 v113, v113, v137
    v_add_f32 v114, v114, v138
    v_add_f32 v115, v115, v139
    v_add_f32 v116, v116, v140
    v_add_f32 v117, v117, v141
    v_add_f32 v118, v118, v142
    v_add_f32 v119, v119, v143
    v_mul_f32 v112, v112, v120
    v_mul_f32 v113, v113, v120
    v_mul_f32 v114, v114, v120
    v_mul_f32 v115, v115, v120
    v_mul_f32 v116, v116, v120
    v_mul_f32 v117, v117, v120
    v_mul_f32 v118, v118, v120
    v_mul_f32 v119, v119, v120
    v_cvt_pk_bf16_f32 v124, v112, v113
    v_cvt_pk_bf16_f32 v125, v114, v115
    v_cvt_pk_bf16_f32 v126, v116, v117
    v_cvt_pk_bf16_f32 v127, v118, v119
    buffer_store_dwordx4 v[124:127], v4, s[48:51], s88 offen offset:256 sc1
    s_endpgm
L_slow_15:
    s_waitcnt vmcnt(0)
    v_permlane16_swap_b32 v192, v196
    v_permlane16_swap_b32 v193, v197
    v_permlane16_swap_b32 v194, v198
    v_permlane16_swap_b32 v195, v199
    v_permlane16_swap_b32 v200, v204
    v_permlane16_swap_b32 v201, v205
    v_permlane16_swap_b32 v202, v206
    v_permlane16_swap_b32 v203, v207
    v_permlane16_swap_b32 v208, v212
    v_permlane16_swap_b32 v209, v213
    v_permlane16_swap_b32 v210, v214
    v_permlane16_swap_b32 v211, v215
    v_permlane16_swap_b32 v216, v220
    v_permlane16_swap_b32 v217, v221
    v_permlane16_swap_b32 v218, v222
    v_permlane16_swap_b32 v219, v223
    v_permlane16_swap_b32 v224, v228
    v_permlane16_swap_b32 v225, v229
    v_permlane16_swap_b32 v226, v230
    v_permlane16_swap_b32 v227, v231
    v_permlane16_swap_b32 v232, v236
    v_permlane16_swap_b32 v233, v237
    v_permlane16_swap_b32 v234, v238
    v_permlane16_swap_b32 v235, v239
    v_permlane16_swap_b32 v240, v244
    v_permlane16_swap_b32 v241, v245
    v_permlane16_swap_b32 v242, v246
    v_permlane16_swap_b32 v243, v247
    v_permlane16_swap_b32 v248, v252
    v_permlane16_swap_b32 v249, v253
    v_permlane16_swap_b32 v250, v254
    v_permlane16_swap_b32 v251, v255
    v_lshlrev_b32 v6, 2, v0
    v_add_u32 v6, 161792, v6
    s_lshl_b32 s91, s64, 8
    s_mov_b32 s90, 4
L_slowq_21:
    ds_read_b128 v[8:11], v12
    v_add_u32 v12, 1024, v12
    v_mov_b64 v[48:49], 0
    v_mov_b64 v[50:51], 0
    v_mov_b64 v[52:53], 0
    v_mov_b64 v[54:55], 0
    v_mov_b32 v56, 0
    v_mov_b32 v7, 0xff800000
    s_waitcnt lgkmcnt(0)
    v_mfma_f32_32x32x16_bf16 v[16:31], v[64:67], v[8:11], 0
    s_nop 12
    v_max3_f32 v7, v7, v16, v17
    v_max3_f32 v7, v7, v18, v19
    v_max3_f32 v7, v7, v20, v21
    v_max3_f32 v7, v7, v22, v23
    v_max3_f32 v7, v7, v24, v25
    v_max3_f32 v7, v7, v26, v27
    v_max3_f32 v7, v7, v28, v29
    v_max3_f32 v7, v7, v30, v31
    v_mfma_f32_32x32x16_bf16 v[16:31], v[68:71], v[8:11], 0
    s_nop 12
    v_max3_f32 v7, v7, v16, v17
    v_max3_f32 v7, v7, v18, v19
    v_max3_f32 v7, v7, v20, v21
    v_max3_f32 v7, v7, v22, v23
    v_max3_f32 v7, v7, v24, v25
    v_max3_f32 v7, v7, v26, v27
    v_max3_f32 v7, v7, v28, v29
    v_max3_f32 v7, v7, v30, v31
    v_mfma_f32_32x32x16_bf16 v[16:31], v[72:75], v[8:11], 0
    s_nop 12
    v_max3_f32 v7, v7, v16, v17
    v_max3_f32 v7, v7, v18, v19
    v_max3_f32 v7, v7, v20, v21
    v_max3_f32 v7, v7, v22, v23
    v_max3_f32 v7, v7, v24, v25
    v_max3_f32 v7, v7, v26, v27
    v_max3_f32 v7, v7, v28, v29
    v_max3_f32 v7, v7, v30, v31
    v_mfma_f32_32x32x16_bf16 v[16:31], v[76:79], v[8:11], 0
    s_nop 12
    v_max3_f32 v7, v7, v16, v17
    v_max3_f32 v7, v7, v18, v19
    v_max3_f32 v7, v7, v20, v21
    v_max3_f32 v7, v7, v22, v23
    v_max3_f32 v7, v7, v24, v25
    v_max3_f32 v7, v7, v26, v27
    v_max3_f32 v7, v7, v28, v29
    v_max3_f32 v7, v7, v30, v31
    v_mfma_f32_32x32x16_bf16 v[16:31], v[80:83], v[8:11], 0
    s_nop 12
    v_max3_f32 v7, v7, v16, v17
    v_max3_f32 v7, v7, v18, v19
    v_max3_f32 v7, v7, v20, v21
    v_max3_f32 v7, v7, v22, v23
    v_max3_f32 v7, v7, v24, v25
    v_max3_f32 v7, v7, v26, v27
    v_max3_f32 v7, v7, v28, v29
    v_max3_f32 v7, v7, v30, v31
    v_mfma_f32_32x32x16_bf16 v[16:31], v[84:87], v[8:11], 0
    s_nop 12
    v_max3_f32 v7, v7, v16, v17
    v_max3_f32 v7, v7, v18, v19
    v_max3_f32 v7, v7, v20, v21
    v_max3_f32 v7, v7, v22, v23
    v_max3_f32 v7, v7, v24, v25
    v_max3_f32 v7, v7, v26, v27
    v_max3_f32 v7, v7, v28, v29
    v_max3_f32 v7, v7, v30, v31
    v_mfma_f32_32x32x16_bf16 v[16:31], v[88:91], v[8:11], 0
    s_nop 12
    v_max3_f32 v7, v7, v16, v17
    v_max3_f32 v7, v7, v18, v19
    v_max3_f32 v7, v7, v20, v21
    v_max3_f32 v7, v7, v22, v23
    v_max3_f32 v7, v7, v24, v25
    v_max3_f32 v7, v7, v26, v27
    v_max3_f32 v7, v7, v28, v29
    v_max3_f32 v7, v7, v30, v31
    v_mfma_f32_32x32x16_bf16 v[16:31], v[92:95], v[8:11], 0
    s_nop 12
    v_max3_f32 v7, v7, v16, v17
    v_max3_f32 v7, v7, v18, v19
    v_max3_f32 v7, v7, v20, v21
    v_max3_f32 v7, v7, v22, v23
    v_max3_f32 v7, v7, v24, v25
    v_max3_f32 v7, v7, v26, v27
    v_max3_f32 v7, v7, v28, v29
    v_max3_f32 v7, v7, v30, v31
    v_mfma_f32_32x32x16_bf16 v[16:31], v[96:99], v[8:11], 0
    s_nop 12
    v_max3_f32 v7, v7, v16, v17
    v_max3_f32 v7, v7, v18, v19
    v_max3_f32 v7, v7, v20, v21
    v_max3_f32 v7, v7, v22, v23
    v_max3_f32 v7, v7, v24, v25
    v_max3_f32 v7, v7, v26, v27
    v_max3_f32 v7, v7, v28, v29
    v_max3_f32 v7, v7, v30, v31
    v_mfma_f32_32x32x16_bf16 v[16:31], v[100:103], v[8:11], 0
    s_nop 12
    v_max3_f32 v7, v7, v16, v17
    v_max3_f32 v7, v7, v18, v19
    v_max3_f32 v7, v7, v20, v21
    v_max3_f32 v7, v7, v22, v23
    v_max3_f32 v7, v7, v24, v25
    v_max3_f32 v7, v7, v26, v27
    v_max3_f32 v7, v7, v28, v29
    v_max3_f32 v7, v7, v30, v31
    v_mfma_f32_32x32x16_bf16 v[16:31], v[104:107], v[8:11], 0
    s_nop 12
    v_max3_f32 v7, v7, v16, v17
    v_max3_f32 v7, v7, v18, v19
    v_max3_f32 v7, v7, v20, v21
    v_max3_f32 v7, v7, v22, v23
    v_max3_f32 v7, v7, v24, v25
    v_max3_f32 v7, v7, v26, v27
    v_max3_f32 v7, v7, v28, v29
    v_max3_f32 v7, v7, v30, v31
    v_mfma_f32_32x32x16_bf16 v[16:31], v[108:111], v[8:11], 0
    s_nop 12
    v_max3_f32 v7, v7, v16, v17
    v_max3_f32 v7, v7, v18, v19
    v_max3_f32 v7, v7, v20, v21
    v_max3_f32 v7, v7, v22, v23
    v_max3_f32 v7, v7, v24, v25
    v_max3_f32 v7, v7, v26, v27
    v_max3_f32 v7, v7, v28, v29
    v_max3_f32 v7, v7, v30, v31
    v_mfma_f32_32x32x16_bf16 v[16:31], v[112:115], v[8:11], 0
    s_nop 12
    v_max3_f32 v7, v7, v16, v17
    v_max3_f32 v7, v7, v18, v19
    v_max3_f32 v7, v7, v20, v21
    v_max3_f32 v7, v7, v22, v23
    v_max3_f32 v7, v7, v24, v25
    v_max3_f32 v7, v7, v26, v27
    v_max3_f32 v7, v7, v28, v29
    v_max3_f32 v7, v7, v30, v31
    v_mfma_f32_32x32x16_bf16 v[16:31], v[116:119], v[8:11], 0
    s_nop 12
    v_max3_f32 v7, v7, v16, v17
    v_max3_f32 v7, v7, v18, v19
    v_max3_f32 v7, v7, v20, v21
    v_max3_f32 v7, v7, v22, v23
    v_max3_f32 v7, v7, v24, v25
    v_max3_f32 v7, v7, v26, v27
    v_max3_f32 v7, v7, v28, v29
    v_max3_f32 v7, v7, v30, v31
    v_mfma_f32_32x32x16_bf16 v[16:31], v[120:123], v[8:11], 0
    s_nop 12
    v_max3_f32 v7, v7, v16, v17
    v_max3_f32 v7, v7, v18, v19
    v_max3_f32 v7, v7, v20, v21
    v_max3_f32 v7, v7, v22, v23
    v_max3_f32 v7, v7, v24, v25
    v_max3_f32 v7, v7, v26, v27
    v_max3_f32 v7, v7, v28, v29
    v_max3_f32 v7, v7, v30, v31
    v_mfma_f32_32x32x16_bf16 v[16:31], v[124:127], v[8:11], 0
    s_nop 12
    v_max3_f32 v7, v7, v16, v17
    v_max3_f32 v7, v7, v18, v19
    v_max3_f32 v7, v7, v20, v21
    v_max3_f32 v7, v7, v22, v23
    v_max3_f32 v7, v7, v24, v25
    v_max3_f32 v7, v7, v26, v27
    v_max3_f32 v7, v7, v28, v29
    v_max3_f32 v7, v7, v30, v31
    v_mov_b32 v13, v7
    s_nop 1
    v_permlane32_swap_b32 v7, v13
    v_max_f32 v7, v7, v13
    v_add_u32 v13, s91, v6
    ds_write_b32 v13, v7
    v_mov_b32 v14, 160840
    v_mov_b32 v15, 1
    s_mov_b64 exec, 1
    ds_add_u32 v14, v15
    s_mov_b64 exec, -1
L_slows_22:
    ds_read_b32 v15, v14
    s_waitcnt lgkmcnt(0)
    v_readfirstlane_b32 s66, v15
    s_cmp_lt_u32 s66, s90
    s_cbranch_scc1 L_slows_22
    ds_read2st64_b32 v[14:15], v6 offset0:0 offset1:1
    ds_read2st64_b32 v[16:17], v6 offset0:2 offset1:3
    s_waitcnt lgkmcnt(0)
    v_max3_f32 v7, v14, v15, v16
    v_max_f32 v7, v7, v17
    v_sub_f32 v32, 0, v7
    v_sub_f32 v33, 0, v7
    v_sub_f32 v34, 0, v7
    v_sub_f32 v35, 0, v7
    v_sub_f32 v36, 0, v7
    v_sub_f32 v37, 0, v7
    v_sub_f32 v38, 0, v7
    v_sub_f32 v39, 0, v7
    v_sub_f32 v40, 0, v7
    v_sub_f32 v41, 0, v7
    v_sub_f32 v42, 0, v7
    v_sub_f32 v43, 0, v7
    v_sub_f32 v44, 0, v7
    v_sub_f32 v45, 0, v7
    v_sub_f32 v46, 0, v7
    v_sub_f32 v47, 0, v7
    s_nop 1
    v_mfma_f32_32x32x16_bf16 v[16:31], v[64:67], v[8:11], v[32:47]
    s_nop 12
    v_exp_f32 v16, v16
    v_exp_f32 v17, v17
    v_exp_f32 v18, v18
    v_exp_f32 v19, v19
    v_exp_f32 v20, v20
    v_exp_f32 v21, v21
    v_exp_f32 v22, v22
    v_exp_f32 v23, v23
    v_exp_f32 v24, v24
    v_exp_f32 v25, v25
    v_exp_f32 v26, v26
    v_exp_f32 v27, v27
    v_exp_f32 v28, v28
    v_exp_f32 v29, v29
    v_exp_f32 v30, v30
    v_exp_f32 v31, v31
    s_nop 1
    v_smfmac_f32_32x32x32_bf16 v[48:63], v[128:131], v[16:23], v2
    v_smfmac_f32_32x32x32_bf16 v[48:63], v[132:135], v[24:31], v2
    v_mfma_f32_32x32x16_bf16 v[16:31], v[68:71], v[8:11], v[32:47]
    s_nop 12
    v_exp_f32 v16, v16
    v_exp_f32 v17, v17
    v_exp_f32 v18, v18
    v_exp_f32 v19, v19
    v_exp_f32 v20, v20
    v_exp_f32 v21, v21
    v_exp_f32 v22, v22
    v_exp_f32 v23, v23
    v_exp_f32 v24, v24
    v_exp_f32 v25, v25
    v_exp_f32 v26, v26
    v_exp_f32 v27, v27
    v_exp_f32 v28, v28
    v_exp_f32 v29, v29
    v_exp_f32 v30, v30
    v_exp_f32 v31, v31
    s_nop 1
    v_smfmac_f32_32x32x32_bf16 v[48:63], v[136:139], v[16:23], v2
    v_smfmac_f32_32x32x32_bf16 v[48:63], v[140:143], v[24:31], v2
    v_mfma_f32_32x32x16_bf16 v[16:31], v[72:75], v[8:11], v[32:47]
    s_nop 12
    v_exp_f32 v16, v16
    v_exp_f32 v17, v17
    v_exp_f32 v18, v18
    v_exp_f32 v19, v19
    v_exp_f32 v20, v20
    v_exp_f32 v21, v21
    v_exp_f32 v22, v22
    v_exp_f32 v23, v23
    v_exp_f32 v24, v24
    v_exp_f32 v25, v25
    v_exp_f32 v26, v26
    v_exp_f32 v27, v27
    v_exp_f32 v28, v28
    v_exp_f32 v29, v29
    v_exp_f32 v30, v30
    v_exp_f32 v31, v31
    s_nop 1
    v_smfmac_f32_32x32x32_bf16 v[48:63], v[144:147], v[16:23], v2
    v_smfmac_f32_32x32x32_bf16 v[48:63], v[148:151], v[24:31], v2
    v_mfma_f32_32x32x16_bf16 v[16:31], v[76:79], v[8:11], v[32:47]
    s_nop 12
    v_exp_f32 v16, v16
    v_exp_f32 v17, v17
    v_exp_f32 v18, v18
    v_exp_f32 v19, v19
    v_exp_f32 v20, v20
    v_exp_f32 v21, v21
    v_exp_f32 v22, v22
    v_exp_f32 v23, v23
    v_exp_f32 v24, v24
    v_exp_f32 v25, v25
    v_exp_f32 v26, v26
    v_exp_f32 v27, v27
    v_exp_f32 v28, v28
    v_exp_f32 v29, v29
    v_exp_f32 v30, v30
    v_exp_f32 v31, v31
    s_nop 1
    v_smfmac_f32_32x32x32_bf16 v[48:63], v[152:155], v[16:23], v2
    v_smfmac_f32_32x32x32_bf16 v[48:63], v[156:159], v[24:31], v2
    v_mfma_f32_32x32x16_bf16 v[16:31], v[80:83], v[8:11], v[32:47]
    s_nop 12
    v_exp_f32 v16, v16
    v_exp_f32 v17, v17
    v_exp_f32 v18, v18
    v_exp_f32 v19, v19
    v_exp_f32 v20, v20
    v_exp_f32 v21, v21
    v_exp_f32 v22, v22
    v_exp_f32 v23, v23
    v_exp_f32 v24, v24
    v_exp_f32 v25, v25
    v_exp_f32 v26, v26
    v_exp_f32 v27, v27
    v_exp_f32 v28, v28
    v_exp_f32 v29, v29
    v_exp_f32 v30, v30
    v_exp_f32 v31, v31
    s_nop 1
    v_smfmac_f32_32x32x32_bf16 v[48:63], v[160:163], v[16:23], v2
    v_smfmac_f32_32x32x32_bf16 v[48:63], v[164:167], v[24:31], v2
    v_mfma_f32_32x32x16_bf16 v[16:31], v[84:87], v[8:11], v[32:47]
    s_nop 12
    v_exp_f32 v16, v16
    v_exp_f32 v17, v17
    v_exp_f32 v18, v18
    v_exp_f32 v19, v19
    v_exp_f32 v20, v20
    v_exp_f32 v21, v21
    v_exp_f32 v22, v22
    v_exp_f32 v23, v23
    v_exp_f32 v24, v24
    v_exp_f32 v25, v25
    v_exp_f32 v26, v26
    v_exp_f32 v27, v27
    v_exp_f32 v28, v28
    v_exp_f32 v29, v29
    v_exp_f32 v30, v30
    v_exp_f32 v31, v31
    s_nop 1
    v_smfmac_f32_32x32x32_bf16 v[48:63], v[168:171], v[16:23], v2
    v_smfmac_f32_32x32x32_bf16 v[48:63], v[172:175], v[24:31], v2
    v_mfma_f32_32x32x16_bf16 v[16:31], v[88:91], v[8:11], v[32:47]
    s_nop 12
    v_exp_f32 v16, v16
    v_exp_f32 v17, v17
    v_exp_f32 v18, v18
    v_exp_f32 v19, v19
    v_exp_f32 v20, v20
    v_exp_f32 v21, v21
    v_exp_f32 v22, v22
    v_exp_f32 v23, v23
    v_exp_f32 v24, v24
    v_exp_f32 v25, v25
    v_exp_f32 v26, v26
    v_exp_f32 v27, v27
    v_exp_f32 v28, v28
    v_exp_f32 v29, v29
    v_exp_f32 v30, v30
    v_exp_f32 v31, v31
    s_nop 1
    v_smfmac_f32_32x32x32_bf16 v[48:63], v[176:179], v[16:23], v2
    v_smfmac_f32_32x32x32_bf16 v[48:63], v[180:183], v[24:31], v2
    v_mfma_f32_32x32x16_bf16 v[16:31], v[92:95], v[8:11], v[32:47]
    s_nop 12
    v_exp_f32 v16, v16
    v_exp_f32 v17, v17
    v_exp_f32 v18, v18
    v_exp_f32 v19, v19
    v_exp_f32 v20, v20
    v_exp_f32 v21, v21
    v_exp_f32 v22, v22
    v_exp_f32 v23, v23
    v_exp_f32 v24, v24
    v_exp_f32 v25, v25
    v_exp_f32 v26, v26
    v_exp_f32 v27, v27
    v_exp_f32 v28, v28
    v_exp_f32 v29, v29
    v_exp_f32 v30, v30
    v_exp_f32 v31, v31
    s_nop 1
    v_smfmac_f32_32x32x32_bf16 v[48:63], v[184:187], v[16:23], v2
    v_smfmac_f32_32x32x32_bf16 v[48:63], v[188:191], v[24:31], v2
    v_mfma_f32_32x32x16_bf16 v[16:31], v[96:99], v[8:11], v[32:47]
    s_nop 12
    v_exp_f32 v16, v16
    v_exp_f32 v17, v17
    v_exp_f32 v18, v18
    v_exp_f32 v19, v19
    v_exp_f32 v20, v20
    v_exp_f32 v21, v21
    v_exp_f32 v22, v22
    v_exp_f32 v23, v23
    v_exp_f32 v24, v24
    v_exp_f32 v25, v25
    v_exp_f32 v26, v26
    v_exp_f32 v27, v27
    v_exp_f32 v28, v28
    v_exp_f32 v29, v29
    v_exp_f32 v30, v30
    v_exp_f32 v31, v31
    s_nop 1
    v_smfmac_f32_32x32x32_bf16 v[48:63], v[192:195], v[16:23], v2
    v_smfmac_f32_32x32x32_bf16 v[48:63], v[196:199], v[24:31], v2
    v_mfma_f32_32x32x16_bf16 v[16:31], v[100:103], v[8:11], v[32:47]
    s_nop 12
    v_exp_f32 v16, v16
    v_exp_f32 v17, v17
    v_exp_f32 v18, v18
    v_exp_f32 v19, v19
    v_exp_f32 v20, v20
    v_exp_f32 v21, v21
    v_exp_f32 v22, v22
    v_exp_f32 v23, v23
    v_exp_f32 v24, v24
    v_exp_f32 v25, v25
    v_exp_f32 v26, v26
    v_exp_f32 v27, v27
    v_exp_f32 v28, v28
    v_exp_f32 v29, v29
    v_exp_f32 v30, v30
    v_exp_f32 v31, v31
    s_nop 1
    v_smfmac_f32_32x32x32_bf16 v[48:63], v[200:203], v[16:23], v2
    v_smfmac_f32_32x32x32_bf16 v[48:63], v[204:207], v[24:31], v2
    v_mfma_f32_32x32x16_bf16 v[16:31], v[104:107], v[8:11], v[32:47]
    s_nop 12
    v_exp_f32 v16, v16
    v_exp_f32 v17, v17
    v_exp_f32 v18, v18
    v_exp_f32 v19, v19
    v_exp_f32 v20, v20
    v_exp_f32 v21, v21
    v_exp_f32 v22, v22
    v_exp_f32 v23, v23
    v_exp_f32 v24, v24
    v_exp_f32 v25, v25
    v_exp_f32 v26, v26
    v_exp_f32 v27, v27
    v_exp_f32 v28, v28
    v_exp_f32 v29, v29
    v_exp_f32 v30, v30
    v_exp_f32 v31, v31
    s_nop 1
    v_smfmac_f32_32x32x32_bf16 v[48:63], v[208:211], v[16:23], v2
    v_smfmac_f32_32x32x32_bf16 v[48:63], v[212:215], v[24:31], v2
    v_mfma_f32_32x32x16_bf16 v[16:31], v[108:111], v[8:11], v[32:47]
    s_nop 12
    v_exp_f32 v16, v16
    v_exp_f32 v17, v17
    v_exp_f32 v18, v18
    v_exp_f32 v19, v19
    v_exp_f32 v20, v20
    v_exp_f32 v21, v21
    v_exp_f32 v22, v22
    v_exp_f32 v23, v23
    v_exp_f32 v24, v24
    v_exp_f32 v25, v25
    v_exp_f32 v26, v26
    v_exp_f32 v27, v27
    v_exp_f32 v28, v28
    v_exp_f32 v29, v29
    v_exp_f32 v30, v30
    v_exp_f32 v31, v31
    s_nop 1
    v_smfmac_f32_32x32x32_bf16 v[48:63], v[216:219], v[16:23], v2
    v_smfmac_f32_32x32x32_bf16 v[48:63], v[220:223], v[24:31], v2
    v_mfma_f32_32x32x16_bf16 v[16:31], v[112:115], v[8:11], v[32:47]
    s_nop 12
    v_exp_f32 v16, v16
    v_exp_f32 v17, v17
    v_exp_f32 v18, v18
    v_exp_f32 v19, v19
    v_exp_f32 v20, v20
    v_exp_f32 v21, v21
    v_exp_f32 v22, v22
    v_exp_f32 v23, v23
    v_exp_f32 v24, v24
    v_exp_f32 v25, v25
    v_exp_f32 v26, v26
    v_exp_f32 v27, v27
    v_exp_f32 v28, v28
    v_exp_f32 v29, v29
    v_exp_f32 v30, v30
    v_exp_f32 v31, v31
    s_nop 1
    v_smfmac_f32_32x32x32_bf16 v[48:63], v[224:227], v[16:23], v2
    v_smfmac_f32_32x32x32_bf16 v[48:63], v[228:231], v[24:31], v2
    v_mfma_f32_32x32x16_bf16 v[16:31], v[116:119], v[8:11], v[32:47]
    s_nop 12
    v_exp_f32 v16, v16
    v_exp_f32 v17, v17
    v_exp_f32 v18, v18
    v_exp_f32 v19, v19
    v_exp_f32 v20, v20
    v_exp_f32 v21, v21
    v_exp_f32 v22, v22
    v_exp_f32 v23, v23
    v_exp_f32 v24, v24
    v_exp_f32 v25, v25
    v_exp_f32 v26, v26
    v_exp_f32 v27, v27
    v_exp_f32 v28, v28
    v_exp_f32 v29, v29
    v_exp_f32 v30, v30
    v_exp_f32 v31, v31
    s_nop 1
    v_smfmac_f32_32x32x32_bf16 v[48:63], v[232:235], v[16:23], v2
    v_smfmac_f32_32x32x32_bf16 v[48:63], v[236:239], v[24:31], v2
    v_mfma_f32_32x32x16_bf16 v[16:31], v[120:123], v[8:11], v[32:47]
    s_nop 12
    v_exp_f32 v16, v16
    v_exp_f32 v17, v17
    v_exp_f32 v18, v18
    v_exp_f32 v19, v19
    v_exp_f32 v20, v20
    v_exp_f32 v21, v21
    v_exp_f32 v22, v22
    v_exp_f32 v23, v23
    v_exp_f32 v24, v24
    v_exp_f32 v25, v25
    v_exp_f32 v26, v26
    v_exp_f32 v27, v27
    v_exp_f32 v28, v28
    v_exp_f32 v29, v29
    v_exp_f32 v30, v30
    v_exp_f32 v31, v31
    s_nop 1
    v_smfmac_f32_32x32x32_bf16 v[48:63], v[240:243], v[16:23], v2
    v_smfmac_f32_32x32x32_bf16 v[48:63], v[244:247], v[24:31], v2
    v_mfma_f32_32x32x16_bf16 v[16:31], v[124:127], v[8:11], v[32:47]
    s_nop 12
    v_exp_f32 v16, v16
    v_exp_f32 v17, v17
    v_exp_f32 v18, v18
    v_exp_f32 v19, v19
    v_exp_f32 v20, v20
    v_exp_f32 v21, v21
    v_exp_f32 v22, v22
    v_exp_f32 v23, v23
    v_exp_f32 v24, v24
    v_exp_f32 v25, v25
    v_exp_f32 v26, v26
    v_exp_f32 v27, v27
    v_exp_f32 v28, v28
    v_exp_f32 v29, v29
    v_exp_f32 v30, v30
    v_exp_f32 v31, v31
    s_nop 1
    v_smfmac_f32_32x32x32_bf16 v[48:63], v[248:251], v[16:23], v2
    v_smfmac_f32_32x32x32_bf16 v[48:63], v[252:255], v[24:31], v2
    s_nop 15
    ds_write_b128 v1, v[48:51] offset:0
    ds_write_b128 v1, v[52:55] offset:1024
    ds_write_b32 v3, v56 offset:2048
    v_add_u32 v1, 8704, v1
    v_add_u32 v3, 8704, v3
    v_xor_b32 v6, 1024, v6
    s_add_u32 s90, s90, 4
    s_cmp_le_u32 s90, 32
    s_cbranch_scc1 L_slowq_21
    buffer_load_dword v6, v5, s[48:51], s84 offen offset:0 sc1
    buffer_load_dword v7, v5, s[48:51], s84 offen offset:64 sc1
    s_branch L_reduce_16
.p2align 6
L_roleF:
    s_setprio 2
    s_getpc_b64 s[70:71]
L_pc:
    s_sub_u32 s70, s70, L_pc - gated_mix__grouped_kv_mqa__glu_gated_geglu__prompt_kernel
    s_subb_u32 s71, s71, 0
    s_lshr_b32 s72, s80, 3
    s_lshl_b32 s72, s72, 2
    s_add_u32 s72, s72, s64
    s_lshl_b32 s72, s72, 10
    s_cmp_ge_u32 s72, L_exit - gated_mix__grouped_kv_mqa__glu_gated_geglu__prompt_kernel - 1024
    s_cbranch_scc1 L_nocpf
    s_add_u32 s70, s70, s72
    s_addc_u32 s71, s71, 0
    v_lshlrev_b32 v30, 4, v0
    v_mov_b32 v31, s71
    v_add_co_u32 v30, vcc, s70, v30
    s_nop 1
    v_addc_co_u32 v31, vcc, 0, v31, vcc
    global_load_dwordx4 v[112:115], v[30:31], off
L_nocpf:
    v_bfe_u32 v5, v0, 4, 1
    v_lshlrev_b32 v66, 10, v5
    v_and_b32 v5, 32, v0
    v_lshl_add_u32 v66, v5, 4, v66
    v_and_b32 v5, 15, v0
    v_lshl_add_u32 v66, v5, 4, v66
    s_lshl_b32 s66, s82, 2
    s_add_u32 s66, s66, s64
    s_lshl_b32 s88, s66, 15
    s_lshl_b32 s66, s83, 11
    s_add_u32 s88, s88, s66
    s_add_u32 s88, s88, 3145728
    s_cmp_ge_u32 s80, 224
    s_cbranch_scc1 L_Fidle_23
    s_and_b32 s66, s64, 1
    s_lshl_b32 s66, s66, 13
    v_and_b32 v5, 15, v0
    v_lshrrev_b32 v6, 4, v0
    v_bfe_u32 v7, v0, 1, 3
    v_xor_b32 v7, v7, v6
    v_lshlrev_b32 v5, 7, v5
    v_add_u32 v5, s66, v5
    v_lshl_add_u32 v8, v7, 4, v5
    v_xor_b32 v7, 4, v7
    v_lshl_add_u32 v9, v7, 4, v5
    v_bfe_u32 v5, v0, 2, 2
    v_bfe_u32 v7, v0, 4, 1
    v_lshl_add_u32 v16, v7, 3, v5
    v_lshlrev_b32 v16, 8, v16
    v_lshrrev_b32 v17, 5, v0
    v_lshl_add_u32 v16, v17, 13, v16
    v_and_b32 v17, 3, v0
    v_lshl_add_u32 v16, v17, 3, v16
    v_add_u32 v16, 61440, v16
    v_lshl_or_b32 v5, v7, 2, v5
    s_and_b32 s66, s64, 2
    s_lshl_b32 s66, s66, 1
    v_xor_b32 v5, s66, v5
    v_xor_b32 v12, 0, v5
    v_lshl_add_u32 v12, v12, 5, v16
    v_add_u32 v68, 0x8000, v12
    v_xor_b32 v13, 1, v5
    v_lshl_add_u32 v13, v13, 5, v16
    v_add_u32 v69, 0x8000, v13
    v_xor_b32 v14, 2, v5
    v_lshl_add_u32 v14, v14, 5, v16
    v_add_u32 v70, 0x8000, v14
    v_xor_b32 v15, 3, v5
    v_lshl_add_u32 v15, v15, 5, v16
    v_add_u32 v71, 0x8000, v15
    s_waitcnt lgkmcnt(0)
    s_load_dword s65, s[40:41], 0
    s_mov_b32 s44, s16
    s_mov_b32 s45, s17
    s_mov_b32 s46, 0x200000
    s_mov_b32 s47, 0x20000
    s_mov_b32 s48, s40
    s_mov_b32 s49, s41
    s_mov_b32 s50, 0x10000000
    s_mov_b32 s51, 0x20000
    s_lshl_b32 s68, s2, 5
    s_lshl_b32 s69, s64, 2
    s_add_u32 s68, s68, s69
    s_add_u32 s68, s68, 24592
    v_mov_b32 v65, 0
    s_waitcnt lgkmcnt(0)
    s_mul_i32 s65, s65, 0x9E3779B1
    s_add_u32 s65, s65, 0x7F4A7C15
    v_mov_b32 v64, s65
    s_mov_b64 exec, 1
    buffer_store_dword v64, v65, s[48:51], s68 offen sc1
    s_mov_b64 exec, -1
    s_barrier
    ds_read_b128 v[16:19], v8 offset:0
    ds_read_b128 v[20:23], v8 offset:2048
    ds_read_b128 v[24:27], v8 offset:4096
    ds_read_b128 v[28:31], v8 offset:6144
    ds_read_b64_tr_b16 v[80:81], v12 offset:0
    ds_read_b64_tr_b16 v[82:83], v12 offset:1024
    ds_read_b64_tr_b16 v[84:85], v12 offset:4096
    ds_read_b64_tr_b16 v[86:87], v12 offset:5120
    ds_read_b64_tr_b16 v[88:89], v13 offset:0
    ds_read_b64_tr_b16 v[90:91], v13 offset:1024
    ds_read_b64_tr_b16 v[92:93], v13 offset:4096
    ds_read_b64_tr_b16 v[94:95], v13 offset:5120
    ds_read_b64_tr_b16 v[96:97], v14 offset:0
    ds_read_b64_tr_b16 v[98:99], v14 offset:1024
    s_waitcnt lgkmcnt(8)
    ds_read_b64_tr_b16 v[100:101], v14 offset:4096
    ds_read_b64_tr_b16 v[102:103], v14 offset:5120
    ds_read_b64_tr_b16 v[104:105], v15 offset:0
    ds_read_b64_tr_b16 v[106:107], v15 offset:1024
    ds_read_b64_tr_b16 v[108:109], v15 offset:4096
    ds_read_b64_tr_b16 v[110:111], v15 offset:5120
    s_barrier
    s_waitcnt lgkmcnt(14)
    v_mfma_f32_16x16x32_bf16 v[128:131], v[80:83], v[16:19], 0
    ds_read_b128 v[32:35], v9 offset:0
    v_mfma_f32_16x16x32_bf16 v[132:135], v[80:83], v[20:23], 0
    ds_read_b128 v[36:39], v9 offset:2048
    v_mfma_f32_16x16x32_bf16 v[136:139], v[80:83], v[24:27], 0
    ds_read_b128 v[40:43], v9 offset:4096
    v_mfma_f32_16x16x32_bf16 v[140:143], v[80:83], v[28:31], 0
    s_waitcnt lgkmcnt(15)
    v_mfma_f32_16x16x32_bf16 v[144:147], v[84:87], v[16:19], 0
    ds_read_b128 v[44:47], v9 offset:6144
    v_mfma_f32_16x16x32_bf16 v[148:151], v[84:87], v[20:23], 0
    ds_read_b64_tr_b16 v[80:81], v12 offset:16384
    v_mfma_f32_16x16x32_bf16 v[152:155], v[84:87], v[24:27], 0
    ds_read_b64_tr_b16 v[82:83], v12 offset:17408
    v_mfma_f32_16x16x32_bf16 v[156:159], v[84:87], v[28:31], 0
    s_waitcnt lgkmcnt(15)
    v_mfma_f32_16x16x32_bf16 v[160:163], v[88:91], v[16:19], 0
    ds_read_b64_tr_b16 v[84:85], v12 offset:20480
    v_mfma_f32_16x16x32_bf16 v[164:167], v[88:91], v[20:23], 0
    ds_read_b64_tr_b16 v[86:87], v12 offset:21504
    v_mfma_f32_16x16x32_bf16 v[168:171], v[88:91], v[24:27], 0
    v_mfma_f32_16x16x32_bf16 v[172:175], v[88:91], v[28:31], 0
    s_waitcnt lgkmcnt(15)
    v_mfma_f32_16x16x32_bf16 v[176:179], v[92:95], v[16:19], 0
    ds_read_b64_tr_b16 v[88:89], v13 offset:16384
    v_mfma_f32_16x16x32_bf16 v[180:183], v[92:95], v[20:23], 0
    ds_read_b64_tr_b16 v[90:91], v13 offset:17408
    v_mfma_f32_16x16x32_bf16 v[184:187], v[92:95], v[24:27], 0
    v_mfma_f32_16x16x32_bf16 v[188:191], v[92:95], v[28:31], 0
    s_waitcnt lgkmcnt(15)
    v_mfma_f32_16x16x32_bf16 v[192:195], v[96:99], v[16:19], 0
    ds_read_b64_tr_b16 v[92:93], v13 offset:20480
    v_mfma_f32_16x16x32_bf16 v[196:199], v[96:99], v[20:23], 0
    ds_read_b64_tr_b16 v[94:95], v13 offset:21504
    v_mfma_f32_16x16x32_bf16 v[200:203], v[96:99], v[24:27], 0
    v_mfma_f32_16x16x32_bf16 v[204:207], v[96:99], v[28:31], 0
    s_waitcnt lgkmcnt(15)
    v_mfma_f32_16x16x32_bf16 v[208:211], v[100:103], v[16:19], 0
    ds_read_b64_tr_b16 v[96:97], v14 offset:16384
    v_mfma_f32_16x16x32_bf16 v[212:215], v[100:103], v[20:23], 0
    ds_read_b64_tr_b16 v[98:99], v14 offset:17408
    v_mfma_f32_16x16x32_bf16 v[216:219], v[100:103], v[24:27], 0
    v_mfma_f32_16x16x32_bf16 v[220:223], v[100:103], v[28:31], 0
    s_waitcnt lgkmcnt(15)
    v_mfma_f32_16x16x32_bf16 v[224:227], v[104:107], v[16:19], 0
    ds_read_b64_tr_b16 v[100:101], v14 offset:20480
    v_mfma_f32_16x16x32_bf16 v[228:231], v[104:107], v[20:23], 0
    ds_read_b64_tr_b16 v[102:103], v14 offset:21504
    v_mfma_f32_16x16x32_bf16 v[232:235], v[104:107], v[24:27], 0
    v_mfma_f32_16x16x32_bf16 v[236:239], v[104:107], v[28:31], 0
    s_waitcnt lgkmcnt(15)
    v_mfma_f32_16x16x32_bf16 v[240:243], v[108:111], v[16:19], 0
    ds_read_b64_tr_b16 v[104:105], v15 offset:16384
    v_mfma_f32_16x16x32_bf16 v[244:247], v[108:111], v[20:23], 0
    ds_read_b64_tr_b16 v[106:107], v15 offset:17408
    v_mfma_f32_16x16x32_bf16 v[248:251], v[108:111], v[24:27], 0
    v_mfma_f32_16x16x32_bf16 v[252:255], v[108:111], v[28:31], 0
    ds_read_b64_tr_b16 v[108:109], v15 offset:20480
    ds_read_b64_tr_b16 v[110:111], v15 offset:21504
    s_barrier
    s_waitcnt lgkmcnt(14)
    v_mfma_f32_16x16x32_bf16 v[128:131], v[80:83], v[32:35], v[128:131]
    ds_read_b128 v[16:19], v8 offset:16384
    v_mfma_f32_16x16x32_bf16 v[132:135], v[80:83], v[36:39], v[132:135]
    ds_read_b128 v[20:23], v8 offset:18432
    v_mfma_f32_16x16x32_bf16 v[136:139], v[80:83], v[40:43], v[136:139]
    ds_read_b128 v[24:27], v8 offset:20480
    v_mfma_f32_16x16x32_bf16 v[140:143], v[80:83], v[44:47], v[140:143]
    s_waitcnt lgkmcnt(15)
    v_mfma_f32_16x16x32_bf16 v[144:147], v[84:87], v[32:35], v[144:147]
    ds_read_b128 v[28:31], v8 offset:22528
    v_mfma_f32_16x16x32_bf16 v[148:151], v[84:87], v[36:39], v[148:151]
    ds_read_b64_tr_b16 v[80:81], v68 offset:0
    v_mfma_f32_16x16x32_bf16 v[152:155], v[84:87], v[40:43], v[152:155]
    ds_read_b64_tr_b16 v[82:83], v68 offset:1024
    v_mfma_f32_16x16x32_bf16 v[156:159], v[84:87], v[44:47], v[156:159]
    s_waitcnt lgkmcnt(15)
    v_mfma_f32_16x16x32_bf16 v[160:163], v[88:91], v[32:35], v[160:163]
    ds_read_b64_tr_b16 v[84:85], v68 offset:4096
    v_mfma_f32_16x16x32_bf16 v[164:167], v[88:91], v[36:39], v[164:167]
    ds_read_b64_tr_b16 v[86:87], v68 offset:5120
    v_mfma_f32_16x16x32_bf16 v[168:171], v[88:91], v[40:43], v[168:171]
    v_mfma_f32_16x16x32_bf16 v[172:175], v[88:91], v[44:47], v[172:175]
    s_waitcnt lgkmcnt(15)
    v_mfma_f32_16x16x32_bf16 v[176:179], v[92:95], v[32:35], v[176:179]
    ds_read_b64_tr_b16 v[88:89], v69 offset:0
    v_mfma_f32_16x16x32_bf16 v[180:183], v[92:95], v[36:39], v[180:183]
    ds_read_b64_tr_b16 v[90:91], v69 offset:1024
    v_mfma_f32_16x16x32_bf16 v[184:187], v[92:95], v[40:43], v[184:187]
    v_mfma_f32_16x16x32_bf16 v[188:191], v[92:95], v[44:47], v[188:191]
    s_waitcnt lgkmcnt(15)
    v_mfma_f32_16x16x32_bf16 v[192:195], v[96:99], v[32:35], v[192:195]
    ds_read_b64_tr_b16 v[92:93], v69 offset:4096
    v_mfma_f32_16x16x32_bf16 v[196:199], v[96:99], v[36:39], v[196:199]
    ds_read_b64_tr_b16 v[94:95], v69 offset:5120
    v_mfma_f32_16x16x32_bf16 v[200:203], v[96:99], v[40:43], v[200:203]
    v_mfma_f32_16x16x32_bf16 v[204:207], v[96:99], v[44:47], v[204:207]
    s_waitcnt lgkmcnt(15)
    v_mfma_f32_16x16x32_bf16 v[208:211], v[100:103], v[32:35], v[208:211]
    ds_read_b64_tr_b16 v[96:97], v70 offset:0
    v_mfma_f32_16x16x32_bf16 v[212:215], v[100:103], v[36:39], v[212:215]
    ds_read_b64_tr_b16 v[98:99], v70 offset:1024
    v_mfma_f32_16x16x32_bf16 v[216:219], v[100:103], v[40:43], v[216:219]
    v_mfma_f32_16x16x32_bf16 v[220:223], v[100:103], v[44:47], v[220:223]
    s_waitcnt lgkmcnt(15)
    v_mfma_f32_16x16x32_bf16 v[224:227], v[104:107], v[32:35], v[224:227]
    ds_read_b64_tr_b16 v[100:101], v70 offset:4096
    v_mfma_f32_16x16x32_bf16 v[228:231], v[104:107], v[36:39], v[228:231]
    ds_read_b64_tr_b16 v[102:103], v70 offset:5120
    v_mfma_f32_16x16x32_bf16 v[232:235], v[104:107], v[40:43], v[232:235]
    v_mfma_f32_16x16x32_bf16 v[236:239], v[104:107], v[44:47], v[236:239]
    s_waitcnt lgkmcnt(15)
    v_mfma_f32_16x16x32_bf16 v[240:243], v[108:111], v[32:35], v[240:243]
    ds_read_b64_tr_b16 v[104:105], v71 offset:0
    v_mfma_f32_16x16x32_bf16 v[244:247], v[108:111], v[36:39], v[244:247]
    ds_read_b64_tr_b16 v[106:107], v71 offset:1024
    v_mfma_f32_16x16x32_bf16 v[248:251], v[108:111], v[40:43], v[248:251]
    v_mfma_f32_16x16x32_bf16 v[252:255], v[108:111], v[44:47], v[252:255]
    ds_read_b64_tr_b16 v[108:109], v71 offset:4096
    ds_read_b64_tr_b16 v[110:111], v71 offset:5120
    s_barrier
    s_waitcnt lgkmcnt(14)
    v_mfma_f32_16x16x32_bf16 v[128:131], v[80:83], v[16:19], v[128:131]
    ds_read_b128 v[32:35], v9 offset:16384
    v_mfma_f32_16x16x32_bf16 v[132:135], v[80:83], v[20:23], v[132:135]
    ds_read_b128 v[36:39], v9 offset:18432
    v_mfma_f32_16x16x32_bf16 v[136:139], v[80:83], v[24:27], v[136:139]
    ds_read_b128 v[40:43], v9 offset:20480
    v_mfma_f32_16x16x32_bf16 v[140:143], v[80:83], v[28:31], v[140:143]
    s_waitcnt lgkmcnt(15)
    v_mfma_f32_16x16x32_bf16 v[144:147], v[84:87], v[16:19], v[144:147]
    ds_read_b128 v[44:47], v9 offset:22528
    v_mfma_f32_16x16x32_bf16 v[148:151], v[84:87], v[20:23], v[148:151]
    ds_read_b64_tr_b16 v[80:81], v68 offset:16384
    v_mfma_f32_16x16x32_bf16 v[152:155], v[84:87], v[24:27], v[152:155]
    ds_read_b64_tr_b16 v[82:83], v68 offset:17408
    v_mfma_f32_16x16x32_bf16 v[156:159], v[84:87], v[28:31], v[156:159]
    s_waitcnt lgkmcnt(15)
    v_mfma_f32_16x16x32_bf16 v[160:163], v[88:91], v[16:19], v[160:163]
    ds_read_b64_tr_b16 v[84:85], v68 offset:20480
    v_mfma_f32_16x16x32_bf16 v[164:167], v[88:91], v[20:23], v[164:167]
    ds_read_b64_tr_b16 v[86:87], v68 offset:21504
    v_mfma_f32_16x16x32_bf16 v[168:171], v[88:91], v[24:27], v[168:171]
    v_mfma_f32_16x16x32_bf16 v[172:175], v[88:91], v[28:31], v[172:175]
    s_waitcnt lgkmcnt(15)
    v_mfma_f32_16x16x32_bf16 v[176:179], v[92:95], v[16:19], v[176:179]
    ds_read_b64_tr_b16 v[88:89], v69 offset:16384
    v_mfma_f32_16x16x32_bf16 v[180:183], v[92:95], v[20:23], v[180:183]
    ds_read_b64_tr_b16 v[90:91], v69 offset:17408
    v_mfma_f32_16x16x32_bf16 v[184:187], v[92:95], v[24:27], v[184:187]
    v_mfma_f32_16x16x32_bf16 v[188:191], v[92:95], v[28:31], v[188:191]
    s_waitcnt lgkmcnt(15)
    v_mfma_f32_16x16x32_bf16 v[192:195], v[96:99], v[16:19], v[192:195]
    ds_read_b64_tr_b16 v[92:93], v69 offset:20480
    v_mfma_f32_16x16x32_bf16 v[196:199], v[96:99], v[20:23], v[196:199]
    ds_read_b64_tr_b16 v[94:95], v69 offset:21504
    v_mfma_f32_16x16x32_bf16 v[200:203], v[96:99], v[24:27], v[200:203]
    v_mfma_f32_16x16x32_bf16 v[204:207], v[96:99], v[28:31], v[204:207]
    s_waitcnt lgkmcnt(15)
    v_mfma_f32_16x16x32_bf16 v[208:211], v[100:103], v[16:19], v[208:211]
    ds_read_b64_tr_b16 v[96:97], v70 offset:16384
    v_mfma_f32_16x16x32_bf16 v[212:215], v[100:103], v[20:23], v[212:215]
    ds_read_b64_tr_b16 v[98:99], v70 offset:17408
    v_mfma_f32_16x16x32_bf16 v[216:219], v[100:103], v[24:27], v[216:219]
    v_mfma_f32_16x16x32_bf16 v[220:223], v[100:103], v[28:31], v[220:223]
    s_waitcnt lgkmcnt(15)
    v_mfma_f32_16x16x32_bf16 v[224:227], v[104:107], v[16:19], v[224:227]
    ds_read_b64_tr_b16 v[100:101], v70 offset:20480
    v_mfma_f32_16x16x32_bf16 v[228:231], v[104:107], v[20:23], v[228:231]
    ds_read_b64_tr_b16 v[102:103], v70 offset:21504
    v_mfma_f32_16x16x32_bf16 v[232:235], v[104:107], v[24:27], v[232:235]
    v_mfma_f32_16x16x32_bf16 v[236:239], v[104:107], v[28:31], v[236:239]
    s_waitcnt lgkmcnt(15)
    v_mfma_f32_16x16x32_bf16 v[240:243], v[108:111], v[16:19], v[240:243]
    ds_read_b64_tr_b16 v[104:105], v71 offset:16384
    v_mfma_f32_16x16x32_bf16 v[244:247], v[108:111], v[20:23], v[244:247]
    ds_read_b64_tr_b16 v[106:107], v71 offset:17408
    v_mfma_f32_16x16x32_bf16 v[248:251], v[108:111], v[24:27], v[248:251]
    v_mfma_f32_16x16x32_bf16 v[252:255], v[108:111], v[28:31], v[252:255]
    ds_read_b64_tr_b16 v[108:109], v71 offset:20480
    ds_read_b64_tr_b16 v[110:111], v71 offset:21504
    s_barrier
    s_waitcnt lgkmcnt(14)
    v_mfma_f32_16x16x32_bf16 v[128:131], v[80:83], v[32:35], v[128:131]
    ds_read_b128 v[16:19], v8 offset:32768
    v_mfma_f32_16x16x32_bf16 v[132:135], v[80:83], v[36:39], v[132:135]
    ds_read_b128 v[20:23], v8 offset:34816
    v_mfma_f32_16x16x32_bf16 v[136:139], v[80:83], v[40:43], v[136:139]
    ds_read_b128 v[24:27], v8 offset:36864
    v_mfma_f32_16x16x32_bf16 v[140:143], v[80:83], v[44:47], v[140:143]
    s_waitcnt lgkmcnt(15)
    v_mfma_f32_16x16x32_bf16 v[144:147], v[84:87], v[32:35], v[144:147]
    ds_read_b128 v[28:31], v8 offset:38912
    v_mfma_f32_16x16x32_bf16 v[148:151], v[84:87], v[36:39], v[148:151]
    ds_read_b64_tr_b16 v[80:81], v68 offset:32768
    v_mfma_f32_16x16x32_bf16 v[152:155], v[84:87], v[40:43], v[152:155]
    ds_read_b64_tr_b16 v[82:83], v68 offset:33792
    v_mfma_f32_16x16x32_bf16 v[156:159], v[84:87], v[44:47], v[156:159]
    s_waitcnt lgkmcnt(15)
    v_mfma_f32_16x16x32_bf16 v[160:163], v[88:91], v[32:35], v[160:163]
    ds_read_b64_tr_b16 v[84:85], v68 offset:36864
    v_mfma_f32_16x16x32_bf16 v[164:167], v[88:91], v[36:39], v[164:167]
    ds_read_b64_tr_b16 v[86:87], v68 offset:37888
    v_mfma_f32_16x16x32_bf16 v[168:171], v[88:91], v[40:43], v[168:171]
    v_mfma_f32_16x16x32_bf16 v[172:175], v[88:91], v[44:47], v[172:175]
    s_waitcnt lgkmcnt(15)
    v_mfma_f32_16x16x32_bf16 v[176:179], v[92:95], v[32:35], v[176:179]
    ds_read_b64_tr_b16 v[88:89], v69 offset:32768
    v_mfma_f32_16x16x32_bf16 v[180:183], v[92:95], v[36:39], v[180:183]
    ds_read_b64_tr_b16 v[90:91], v69 offset:33792
    v_mfma_f32_16x16x32_bf16 v[184:187], v[92:95], v[40:43], v[184:187]
    v_mfma_f32_16x16x32_bf16 v[188:191], v[92:95], v[44:47], v[188:191]
    s_waitcnt lgkmcnt(15)
    v_mfma_f32_16x16x32_bf16 v[192:195], v[96:99], v[32:35], v[192:195]
    ds_read_b64_tr_b16 v[92:93], v69 offset:36864
    v_mfma_f32_16x16x32_bf16 v[196:199], v[96:99], v[36:39], v[196:199]
    ds_read_b64_tr_b16 v[94:95], v69 offset:37888
    v_mfma_f32_16x16x32_bf16 v[200:203], v[96:99], v[40:43], v[200:203]
    v_mfma_f32_16x16x32_bf16 v[204:207], v[96:99], v[44:47], v[204:207]
    s_waitcnt lgkmcnt(15)
    v_mfma_f32_16x16x32_bf16 v[208:211], v[100:103], v[32:35], v[208:211]
    ds_read_b64_tr_b16 v[96:97], v70 offset:32768
    v_mfma_f32_16x16x32_bf16 v[212:215], v[100:103], v[36:39], v[212:215]
    ds_read_b64_tr_b16 v[98:99], v70 offset:33792
    v_mfma_f32_16x16x32_bf16 v[216:219], v[100:103], v[40:43], v[216:219]
    v_mfma_f32_16x16x32_bf16 v[220:223], v[100:103], v[44:47], v[220:223]
    s_waitcnt lgkmcnt(15)
    v_mfma_f32_16x16x32_bf16 v[224:227], v[104:107], v[32:35], v[224:227]
    ds_read_b64_tr_b16 v[100:101], v70 offset:36864
    v_mfma_f32_16x16x32_bf16 v[228:231], v[104:107], v[36:39], v[228:231]
    ds_read_b64_tr_b16 v[102:103], v70 offset:37888
    v_mfma_f32_16x16x32_bf16 v[232:235], v[104:107], v[40:43], v[232:235]
    v_mfma_f32_16x16x32_bf16 v[236:239], v[104:107], v[44:47], v[236:239]
    s_waitcnt lgkmcnt(15)
    v_mfma_f32_16x16x32_bf16 v[240:243], v[108:111], v[32:35], v[240:243]
    ds_read_b64_tr_b16 v[104:105], v71 offset:32768
    v_mfma_f32_16x16x32_bf16 v[244:247], v[108:111], v[36:39], v[244:247]
    ds_read_b64_tr_b16 v[106:107], v71 offset:33792
    v_mfma_f32_16x16x32_bf16 v[248:251], v[108:111], v[40:43], v[248:251]
    v_mfma_f32_16x16x32_bf16 v[252:255], v[108:111], v[44:47], v[252:255]
    ds_read_b64_tr_b16 v[108:109], v71 offset:36864
    ds_read_b64_tr_b16 v[110:111], v71 offset:37888
    s_waitcnt vmcnt(0)
    v_lshlrev_b32 v2, 4, v0
    v_mov_b32 v4, 0xc0135761
    v_mov_b32 v5, 0xc0135761
    s_mov_b32 s92, 0xbdd2d3e8
    s_mov_b32 s93, 0xbdd2d3e8
    s_lshl_b32 s66, s82, 2
    s_and_b32 s67, s64, 1
    s_lshl_b32 s67, s67, 1
    s_add_u32 s66, s66, s67
    s_mul_i32 s66, s66, 112
    s_lshl_b32 s67, s83, 3
    s_add_u32 s66, s66, s67
    s_and_b32 s67, s64, 2
    s_lshl_b32 s67, s67, 1
    s_add_u32 s66, s66, s67
    s_lshl_b32 s66, s66, 10
    s_add_u32 s86, s66, 5242880
    s_add_u32 s87, s86, 114688
    s_barrier
    s_waitcnt lgkmcnt(14)
    v_mfma_f32_16x16x32_bf16 v[128:131], v[80:83], v[16:19], v[128:131]
    ds_read_b128 v[32:35], v9 offset:32768
    v_mfma_f32_16x16x32_bf16 v[132:135], v[80:83], v[20:23], v[132:135]
    ds_read_b128 v[36:39], v9 offset:34816
    v_mfma_f32_16x16x32_bf16 v[136:139], v[80:83], v[24:27], v[136:139]
    ds_read_b128 v[40:43], v9 offset:36864
    v_mfma_f32_16x16x32_bf16 v[140:143], v[80:83], v[28:31], v[140:143]
    s_waitcnt lgkmcnt(15)
    v_mfma_f32_16x16x32_bf16 v[144:147], v[84:87], v[16:19], v[144:147]
    ds_read_b128 v[44:47], v9 offset:38912
    v_mfma_f32_16x16x32_bf16 v[148:151], v[84:87], v[20:23], v[148:151]
    ds_read_b64_tr_b16 v[80:81], v12 offset:0
    v_mfma_f32_16x16x32_bf16 v[152:155], v[84:87], v[24:27], v[152:155]
    ds_read_b64_tr_b16 v[82:83], v12 offset:1024
    v_mfma_f32_16x16x32_bf16 v[156:159], v[84:87], v[28:31], v[156:159]
    s_waitcnt lgkmcnt(15)
    v_mfma_f32_16x16x32_bf16 v[160:163], v[88:91], v[16:19], v[160:163]
    ds_read_b64_tr_b16 v[84:85], v12 offset:4096
    v_mfma_f32_16x16x32_bf16 v[164:167], v[88:91], v[20:23], v[164:167]
    ds_read_b64_tr_b16 v[86:87], v12 offset:5120
    v_mfma_f32_16x16x32_bf16 v[168:171], v[88:91], v[24:27], v[168:171]
    v_mfma_f32_16x16x32_bf16 v[172:175], v[88:91], v[28:31], v[172:175]
    s_waitcnt lgkmcnt(15)
    v_mfma_f32_16x16x32_bf16 v[176:179], v[92:95], v[16:19], v[176:179]
    ds_read_b64_tr_b16 v[88:89], v13 offset:0
    v_mfma_f32_16x16x32_bf16 v[180:183], v[92:95], v[20:23], v[180:183]
    ds_read_b64_tr_b16 v[90:91], v13 offset:1024
    v_mfma_f32_16x16x32_bf16 v[184:187], v[92:95], v[24:27], v[184:187]
    v_mfma_f32_16x16x32_bf16 v[188:191], v[92:95], v[28:31], v[188:191]
    s_waitcnt lgkmcnt(15)
    v_mfma_f32_16x16x32_bf16 v[192:195], v[96:99], v[16:19], v[192:195]
    ds_read_b64_tr_b16 v[92:93], v13 offset:4096
    v_mfma_f32_16x16x32_bf16 v[196:199], v[96:99], v[20:23], v[196:199]
    ds_read_b64_tr_b16 v[94:95], v13 offset:5120
    v_mfma_f32_16x16x32_bf16 v[200:203], v[96:99], v[24:27], v[200:203]
    v_mfma_f32_16x16x32_bf16 v[204:207], v[96:99], v[28:31], v[204:207]
    s_waitcnt lgkmcnt(15)
    v_mfma_f32_16x16x32_bf16 v[208:211], v[100:103], v[16:19], v[208:211]
    ds_read_b64_tr_b16 v[96:97], v14 offset:0
    v_mfma_f32_16x16x32_bf16 v[212:215], v[100:103], v[20:23], v[212:215]
    ds_read_b64_tr_b16 v[98:99], v14 offset:1024
    v_mfma_f32_16x16x32_bf16 v[216:219], v[100:103], v[24:27], v[216:219]
    v_mfma_f32_16x16x32_bf16 v[220:223], v[100:103], v[28:31], v[220:223]
    s_waitcnt lgkmcnt(15)
    v_mfma_f32_16x16x32_bf16 v[224:227], v[104:107], v[16:19], v[224:227]
    ds_read_b64_tr_b16 v[100:101], v14 offset:4096
    v_mfma_f32_16x16x32_bf16 v[228:231], v[104:107], v[20:23], v[228:231]
    ds_read_b64_tr_b16 v[102:103], v14 offset:5120
    v_mfma_f32_16x16x32_bf16 v[232:235], v[104:107], v[24:27], v[232:235]
    v_mfma_f32_16x16x32_bf16 v[236:239], v[104:107], v[28:31], v[236:239]
    s_waitcnt lgkmcnt(15)
    v_mfma_f32_16x16x32_bf16 v[240:243], v[108:111], v[16:19], v[240:243]
    ds_read_b64_tr_b16 v[104:105], v15 offset:0
    v_mfma_f32_16x16x32_bf16 v[244:247], v[108:111], v[20:23], v[244:247]
    ds_read_b64_tr_b16 v[106:107], v15 offset:1024
    v_mfma_f32_16x16x32_bf16 v[248:251], v[108:111], v[24:27], v[248:251]
    v_mfma_f32_16x16x32_bf16 v[252:255], v[108:111], v[28:31], v[252:255]
    ds_read_b64_tr_b16 v[108:109], v15 offset:4096
    ds_read_b64_tr_b16 v[110:111], v15 offset:5120
    s_barrier
    s_waitcnt lgkmcnt(14)
    v_mfma_f32_16x16x32_bf16 v[128:131], v[80:83], v[32:35], v[128:131]
    ds_read_b128 v[16:19], v8 offset:0
    v_mfma_f32_16x16x32_bf16 v[132:135], v[80:83], v[36:39], v[132:135]
    ds_read_b128 v[20:23], v8 offset:2048
    v_mfma_f32_16x16x32_bf16 v[136:139], v[80:83], v[40:43], v[136:139]
    ds_read_b128 v[24:27], v8 offset:4096
    v_mfma_f32_16x16x32_bf16 v[140:143], v[80:83], v[44:47], v[140:143]
    s_waitcnt lgkmcnt(15)
    v_mfma_f32_16x16x32_bf16 v[144:147], v[84:87], v[32:35], v[144:147]
    ds_read_b128 v[28:31], v8 offset:6144
    v_mfma_f32_16x16x32_bf16 v[148:151], v[84:87], v[36:39], v[148:151]
    ds_read_b64_tr_b16 v[80:81], v12 offset:16384
    v_mfma_f32_16x16x32_bf16 v[152:155], v[84:87], v[40:43], v[152:155]
    ds_read_b64_tr_b16 v[82:83], v12 offset:17408
    v_mfma_f32_16x16x32_bf16 v[156:159], v[84:87], v[44:47], v[156:159]
    s_waitcnt lgkmcnt(15)
    v_mfma_f32_16x16x32_bf16 v[160:163], v[88:91], v[32:35], v[160:163]
    ds_read_b64_tr_b16 v[84:85], v12 offset:20480
    v_mfma_f32_16x16x32_bf16 v[164:167], v[88:91], v[36:39], v[164:167]
    ds_read_b64_tr_b16 v[86:87], v12 offset:21504
    v_mfma_f32_16x16x32_bf16 v[168:171], v[88:91], v[40:43], v[168:171]
    v_mfma_f32_16x16x32_bf16 v[172:175], v[88:91], v[44:47], v[172:175]
    s_waitcnt lgkmcnt(15)
    v_mfma_f32_16x16x32_bf16 v[176:179], v[92:95], v[32:35], v[176:179]
    ds_read_b64_tr_b16 v[88:89], v13 offset:16384
    v_mfma_f32_16x16x32_bf16 v[180:183], v[92:95], v[36:39], v[180:183]
    ds_read_b64_tr_b16 v[90:91], v13 offset:17408
    v_mfma_f32_16x16x32_bf16 v[184:187], v[92:95], v[40:43], v[184:187]
    v_mfma_f32_16x16x32_bf16 v[188:191], v[92:95], v[44:47], v[188:191]
    s_waitcnt lgkmcnt(15)
    v_mfma_f32_16x16x32_bf16 v[192:195], v[96:99], v[32:35], v[192:195]
    ds_read_b64_tr_b16 v[92:93], v13 offset:20480
    v_mfma_f32_16x16x32_bf16 v[196:199], v[96:99], v[36:39], v[196:199]
    ds_read_b64_tr_b16 v[94:95], v13 offset:21504
    v_mfma_f32_16x16x32_bf16 v[200:203], v[96:99], v[40:43], v[200:203]
    v_mfma_f32_16x16x32_bf16 v[204:207], v[96:99], v[44:47], v[204:207]
    s_waitcnt lgkmcnt(15)
    v_mfma_f32_16x16x32_bf16 v[208:211], v[100:103], v[32:35], v[208:211]
    ds_read_b64_tr_b16 v[96:97], v14 offset:16384
    v_mfma_f32_16x16x32_bf16 v[212:215], v[100:103], v[36:39], v[212:215]
    ds_read_b64_tr_b16 v[98:99], v14 offset:17408
    v_mfma_f32_16x16x32_bf16 v[216:219], v[100:103], v[40:43], v[216:219]
    v_mfma_f32_16x16x32_bf16 v[220:223], v[100:103], v[44:47], v[220:223]
    s_waitcnt lgkmcnt(15)
    v_mfma_f32_16x16x32_bf16 v[224:227], v[104:107], v[32:35], v[224:227]
    ds_read_b64_tr_b16 v[100:101], v14 offset:20480
    v_mfma_f32_16x16x32_bf16 v[228:231], v[104:107], v[36:39], v[228:231]
    ds_read_b64_tr_b16 v[102:103], v14 offset:21504
    v_mfma_f32_16x16x32_bf16 v[232:235], v[104:107], v[40:43], v[232:235]
    v_mfma_f32_16x16x32_bf16 v[236:239], v[104:107], v[44:47], v[236:239]
    s_waitcnt lgkmcnt(15)
    v_mfma_f32_16x16x32_bf16 v[240:243], v[108:111], v[32:35], v[240:243]
    ds_read_b64_tr_b16 v[104:105], v15 offset:16384
    v_mfma_f32_16x16x32_bf16 v[244:247], v[108:111], v[36:39], v[244:247]
    ds_read_b64_tr_b16 v[106:107], v15 offset:17408
    v_mfma_f32_16x16x32_bf16 v[248:251], v[108:111], v[40:43], v[248:251]
    v_mfma_f32_16x16x32_bf16 v[252:255], v[108:111], v[44:47], v[252:255]
    ds_read_b64_tr_b16 v[108:109], v15 offset:20480
    ds_read_b64_tr_b16 v[110:111], v15 offset:21504
    s_barrier
    s_waitcnt lgkmcnt(14)
    v_mfma_f32_16x16x32_bf16 v[128:131], v[80:83], v[16:19], v[128:131]
    ds_read_b128 v[32:35], v9 offset:0
    v_mfma_f32_16x16x32_bf16 v[132:135], v[80:83], v[20:23], v[132:135]
    ds_read_b128 v[36:39], v9 offset:2048
    v_mfma_f32_16x16x32_bf16 v[136:139], v[80:83], v[24:27], v[136:139]
    ds_read_b128 v[40:43], v9 offset:4096
    v_mfma_f32_16x16x32_bf16 v[140:143], v[80:83], v[28:31], v[140:143]
    s_waitcnt lgkmcnt(15)
    v_mfma_f32_16x16x32_bf16 v[144:147], v[84:87], v[16:19], v[144:147]
    ds_read_b128 v[44:47], v9 offset:6144
    v_mfma_f32_16x16x32_bf16 v[148:151], v[84:87], v[20:23], v[148:151]
    ds_read_b64_tr_b16 v[80:81], v68 offset:0
    v_mfma_f32_16x16x32_bf16 v[152:155], v[84:87], v[24:27], v[152:155]
    ds_read_b64_tr_b16 v[82:83], v68 offset:1024
    v_mfma_f32_16x16x32_bf16 v[156:159], v[84:87], v[28:31], v[156:159]
    s_waitcnt lgkmcnt(15)
    v_mfma_f32_16x16x32_bf16 v[160:163], v[88:91], v[16:19], v[160:163]
    ds_read_b64_tr_b16 v[84:85], v68 offset:4096
    v_mfma_f32_16x16x32_bf16 v[164:167], v[88:91], v[20:23], v[164:167]
    ds_read_b64_tr_b16 v[86:87], v68 offset:5120
    v_mfma_f32_16x16x32_bf16 v[168:171], v[88:91], v[24:27], v[168:171]
    v_mfma_f32_16x16x32_bf16 v[172:175], v[88:91], v[28:31], v[172:175]
    s_waitcnt lgkmcnt(15)
    v_mfma_f32_16x16x32_bf16 v[176:179], v[92:95], v[16:19], v[176:179]
    ds_read_b64_tr_b16 v[88:89], v69 offset:0
    v_mfma_f32_16x16x32_bf16 v[180:183], v[92:95], v[20:23], v[180:183]
    ds_read_b64_tr_b16 v[90:91], v69 offset:1024
    v_mfma_f32_16x16x32_bf16 v[184:187], v[92:95], v[24:27], v[184:187]
    v_mfma_f32_16x16x32_bf16 v[188:191], v[92:95], v[28:31], v[188:191]
    s_waitcnt lgkmcnt(15)
    v_mfma_f32_16x16x32_bf16 v[192:195], v[96:99], v[16:19], v[192:195]
    ds_read_b64_tr_b16 v[92:93], v69 offset:4096
    v_mfma_f32_16x16x32_bf16 v[196:199], v[96:99], v[20:23], v[196:199]
    ds_read_b64_tr_b16 v[94:95], v69 offset:5120
    v_mfma_f32_16x16x32_bf16 v[200:203], v[96:99], v[24:27], v[200:203]
    v_mfma_f32_16x16x32_bf16 v[204:207], v[96:99], v[28:31], v[204:207]
    s_waitcnt lgkmcnt(15)
    v_mfma_f32_16x16x32_bf16 v[208:211], v[100:103], v[16:19], v[208:211]
    ds_read_b64_tr_b16 v[96:97], v70 offset:0
    v_mfma_f32_16x16x32_bf16 v[212:215], v[100:103], v[20:23], v[212:215]
    ds_read_b64_tr_b16 v[98:99], v70 offset:1024
    v_mfma_f32_16x16x32_bf16 v[216:219], v[100:103], v[24:27], v[216:219]
    v_mfma_f32_16x16x32_bf16 v[220:223], v[100:103], v[28:31], v[220:223]
    s_waitcnt lgkmcnt(15)
    v_mfma_f32_16x16x32_bf16 v[224:227], v[104:107], v[16:19], v[224:227]
    ds_read_b64_tr_b16 v[100:101], v70 offset:4096
    v_mfma_f32_16x16x32_bf16 v[228:231], v[104:107], v[20:23], v[228:231]
    ds_read_b64_tr_b16 v[102:103], v70 offset:5120
    v_mfma_f32_16x16x32_bf16 v[232:235], v[104:107], v[24:27], v[232:235]
    v_mfma_f32_16x16x32_bf16 v[236:239], v[104:107], v[28:31], v[236:239]
    s_waitcnt lgkmcnt(15)
    v_mfma_f32_16x16x32_bf16 v[240:243], v[108:111], v[16:19], v[240:243]
    ds_read_b64_tr_b16 v[104:105], v71 offset:0
    v_mfma_f32_16x16x32_bf16 v[244:247], v[108:111], v[20:23], v[244:247]
    ds_read_b64_tr_b16 v[106:107], v71 offset:1024
    v_mfma_f32_16x16x32_bf16 v[248:251], v[108:111], v[24:27], v[248:251]
    v_mfma_f32_16x16x32_bf16 v[252:255], v[108:111], v[28:31], v[252:255]
    ds_read_b64_tr_b16 v[108:109], v71 offset:4096
    ds_read_b64_tr_b16 v[110:111], v71 offset:5120
    s_barrier
    s_waitcnt lgkmcnt(14)
    v_mfma_f32_16x16x32_bf16 v[128:131], v[80:83], v[32:35], v[128:131]
    ds_read_b128 v[16:19], v8 offset:16384
    v_mfma_f32_16x16x32_bf16 v[132:135], v[80:83], v[36:39], v[132:135]
    ds_read_b128 v[20:23], v8 offset:18432
    v_mfma_f32_16x16x32_bf16 v[136:139], v[80:83], v[40:43], v[136:139]
    ds_read_b128 v[24:27], v8 offset:20480
    v_mfma_f32_16x16x32_bf16 v[140:143], v[80:83], v[44:47], v[140:143]
    s_waitcnt lgkmcnt(15)
    v_mfma_f32_16x16x32_bf16 v[144:147], v[84:87], v[32:35], v[144:147]
    ds_read_b128 v[28:31], v8 offset:22528
    v_mfma_f32_16x16x32_bf16 v[148:151], v[84:87], v[36:39], v[148:151]
    ds_read_b64_tr_b16 v[80:81], v68 offset:16384
    v_mfma_f32_16x16x32_bf16 v[152:155], v[84:87], v[40:43], v[152:155]
    ds_read_b64_tr_b16 v[82:83], v68 offset:17408
    v_mfma_f32_16x16x32_bf16 v[156:159], v[84:87], v[44:47], v[156:159]
    s_waitcnt lgkmcnt(15)
    v_mfma_f32_16x16x32_bf16 v[160:163], v[88:91], v[32:35], v[160:163]
    ds_read_b64_tr_b16 v[84:85], v68 offset:20480
    v_mfma_f32_16x16x32_bf16 v[164:167], v[88:91], v[36:39], v[164:167]
    ds_read_b64_tr_b16 v[86:87], v68 offset:21504
    v_mfma_f32_16x16x32_bf16 v[168:171], v[88:91], v[40:43], v[168:171]
    v_mfma_f32_16x16x32_bf16 v[172:175], v[88:91], v[44:47], v[172:175]
    s_waitcnt lgkmcnt(15)
    v_mfma_f32_16x16x32_bf16 v[176:179], v[92:95], v[32:35], v[176:179]
    ds_read_b64_tr_b16 v[88:89], v69 offset:16384
    v_mfma_f32_16x16x32_bf16 v[180:183], v[92:95], v[36:39], v[180:183]
    ds_read_b64_tr_b16 v[90:91], v69 offset:17408
    v_mfma_f32_16x16x32_bf16 v[184:187], v[92:95], v[40:43], v[184:187]
    v_mfma_f32_16x16x32_bf16 v[188:191], v[92:95], v[44:47], v[188:191]
    s_waitcnt lgkmcnt(15)
    v_mfma_f32_16x16x32_bf16 v[192:195], v[96:99], v[32:35], v[192:195]
    ds_read_b64_tr_b16 v[92:93], v69 offset:20480
    v_mfma_f32_16x16x32_bf16 v[196:199], v[96:99], v[36:39], v[196:199]
    ds_read_b64_tr_b16 v[94:95], v69 offset:21504
    v_mfma_f32_16x16x32_bf16 v[200:203], v[96:99], v[40:43], v[200:203]
    v_mfma_f32_16x16x32_bf16 v[204:207], v[96:99], v[44:47], v[204:207]
    s_waitcnt lgkmcnt(15)
    v_mfma_f32_16x16x32_bf16 v[208:211], v[100:103], v[32:35], v[208:211]
    ds_read_b64_tr_b16 v[96:97], v70 offset:16384
    v_mfma_f32_16x16x32_bf16 v[212:215], v[100:103], v[36:39], v[212:215]
    ds_read_b64_tr_b16 v[98:99], v70 offset:17408
    v_mfma_f32_16x16x32_bf16 v[216:219], v[100:103], v[40:43], v[216:219]
    v_mfma_f32_16x16x32_bf16 v[220:223], v[100:103], v[44:47], v[220:223]
    s_waitcnt lgkmcnt(15)
    v_mfma_f32_16x16x32_bf16 v[224:227], v[104:107], v[32:35], v[224:227]
    ds_read_b64_tr_b16 v[100:101], v70 offset:20480
    v_mfma_f32_16x16x32_bf16 v[228:231], v[104:107], v[36:39], v[228:231]
    ds_read_b64_tr_b16 v[102:103], v70 offset:21504
    v_mfma_f32_16x16x32_bf16 v[232:235], v[104:107], v[40:43], v[232:235]
    v_mfma_f32_16x16x32_bf16 v[236:239], v[104:107], v[44:47], v[236:239]
    s_waitcnt lgkmcnt(15)
    v_mfma_f32_16x16x32_bf16 v[240:243], v[108:111], v[32:35], v[240:243]
    ds_read_b64_tr_b16 v[104:105], v71 offset:16384
    v_mfma_f32_16x16x32_bf16 v[244:247], v[108:111], v[36:39], v[244:247]
    ds_read_b64_tr_b16 v[106:107], v71 offset:17408
    v_mfma_f32_16x16x32_bf16 v[248:251], v[108:111], v[40:43], v[248:251]
    v_mfma_f32_16x16x32_bf16 v[252:255], v[108:111], v[44:47], v[252:255]
    ds_read_b64_tr_b16 v[108:109], v71 offset:20480
    ds_read_b64_tr_b16 v[110:111], v71 offset:21504
    s_barrier
    s_waitcnt lgkmcnt(14)
    v_mfma_f32_16x16x32_bf16 v[128:131], v[80:83], v[16:19], v[128:131]
    ds_read_b128 v[32:35], v9 offset:16384
    v_mfma_f32_16x16x32_bf16 v[132:135], v[80:83], v[20:23], v[132:135]
    ds_read_b128 v[36:39], v9 offset:18432
    v_mfma_f32_16x16x32_bf16 v[136:139], v[80:83], v[24:27], v[136:139]
    ds_read_b128 v[40:43], v9 offset:20480
    v_mfma_f32_16x16x32_bf16 v[140:143], v[80:83], v[28:31], v[140:143]
    s_waitcnt lgkmcnt(15)
    v_mfma_f32_16x16x32_bf16 v[144:147], v[84:87], v[16:19], v[144:147]
    ds_read_b128 v[44:47], v9 offset:22528
    v_mfma_f32_16x16x32_bf16 v[148:151], v[84:87], v[20:23], v[148:151]
    ds_read_b64_tr_b16 v[80:81], v68 offset:32768
    v_mfma_f32_16x16x32_bf16 v[152:155], v[84:87], v[24:27], v[152:155]
    ds_read_b64_tr_b16 v[82:83], v68 offset:33792
    v_mfma_f32_16x16x32_bf16 v[156:159], v[84:87], v[28:31], v[156:159]
    s_waitcnt lgkmcnt(15)
    v_mfma_f32_16x16x32_bf16 v[160:163], v[88:91], v[16:19], v[160:163]
    ds_read_b64_tr_b16 v[84:85], v68 offset:36864
    v_mfma_f32_16x16x32_bf16 v[164:167], v[88:91], v[20:23], v[164:167]
    ds_read_b64_tr_b16 v[86:87], v68 offset:37888
    v_mfma_f32_16x16x32_bf16 v[168:171], v[88:91], v[24:27], v[168:171]
    v_mfma_f32_16x16x32_bf16 v[172:175], v[88:91], v[28:31], v[172:175]
    s_waitcnt lgkmcnt(15)
    v_mfma_f32_16x16x32_bf16 v[176:179], v[92:95], v[16:19], v[176:179]
    ds_read_b64_tr_b16 v[88:89], v69 offset:32768
    v_mfma_f32_16x16x32_bf16 v[180:183], v[92:95], v[20:23], v[180:183]
    ds_read_b64_tr_b16 v[90:91], v69 offset:33792
    v_mfma_f32_16x16x32_bf16 v[184:187], v[92:95], v[24:27], v[184:187]
    v_mfma_f32_16x16x32_bf16 v[188:191], v[92:95], v[28:31], v[188:191]
    s_waitcnt lgkmcnt(15)
    v_mfma_f32_16x16x32_bf16 v[192:195], v[96:99], v[16:19], v[192:195]
    ds_read_b64_tr_b16 v[92:93], v69 offset:36864
    v_mfma_f32_16x16x32_bf16 v[196:199], v[96:99], v[20:23], v[196:199]
    ds_read_b64_tr_b16 v[94:95], v69 offset:37888
    v_mfma_f32_16x16x32_bf16 v[200:203], v[96:99], v[24:27], v[200:203]
    v_mfma_f32_16x16x32_bf16 v[204:207], v[96:99], v[28:31], v[204:207]
    s_waitcnt lgkmcnt(15)
    v_mfma_f32_16x16x32_bf16 v[208:211], v[100:103], v[16:19], v[208:211]
    ds_read_b64_tr_b16 v[96:97], v70 offset:32768
    v_mfma_f32_16x16x32_bf16 v[212:215], v[100:103], v[20:23], v[212:215]
    ds_read_b64_tr_b16 v[98:99], v70 offset:33792
    v_mfma_f32_16x16x32_bf16 v[216:219], v[100:103], v[24:27], v[216:219]
    v_mfma_f32_16x16x32_bf16 v[220:223], v[100:103], v[28:31], v[220:223]
    s_waitcnt lgkmcnt(15)
    v_mfma_f32_16x16x32_bf16 v[224:227], v[104:107], v[16:19], v[224:227]
    ds_read_b64_tr_b16 v[100:101], v70 offset:36864
    v_mfma_f32_16x16x32_bf16 v[228:231], v[104:107], v[20:23], v[228:231]
    ds_read_b64_tr_b16 v[102:103], v70 offset:37888
    v_mfma_f32_16x16x32_bf16 v[232:235], v[104:107], v[24:27], v[232:235]
    v_mfma_f32_16x16x32_bf16 v[236:239], v[104:107], v[28:31], v[236:239]
    s_waitcnt lgkmcnt(15)
    v_mfma_f32_16x16x32_bf16 v[240:243], v[108:111], v[16:19], v[240:243]
    ds_read_b64_tr_b16 v[104:105], v71 offset:32768
    v_mfma_f32_16x16x32_bf16 v[244:247], v[108:111], v[20:23], v[244:247]
    ds_read_b64_tr_b16 v[106:107], v71 offset:33792
    v_mfma_f32_16x16x32_bf16 v[248:251], v[108:111], v[24:27], v[248:251]
    v_mfma_f32_16x16x32_bf16 v[252:255], v[108:111], v[28:31], v[252:255]
    ds_read_b64_tr_b16 v[108:109], v71 offset:36864
    ds_read_b64_tr_b16 v[110:111], v71 offset:37888
    s_barrier
    s_waitcnt lgkmcnt(14)
    v_mfma_f32_16x16x32_bf16 v[128:131], v[80:83], v[32:35], v[128:131]
    ds_read_b128 v[16:19], v8 offset:32768
    v_mfma_f32_16x16x32_bf16 v[132:135], v[80:83], v[36:39], v[132:135]
    ds_read_b128 v[20:23], v8 offset:34816
    v_mfma_f32_16x16x32_bf16 v[136:139], v[80:83], v[40:43], v[136:139]
    ds_read_b128 v[24:27], v8 offset:36864
    v_mfma_f32_16x16x32_bf16 v[140:143], v[80:83], v[44:47], v[140:143]
    s_waitcnt lgkmcnt(15)
    v_mfma_f32_16x16x32_bf16 v[144:147], v[84:87], v[32:35], v[144:147]
    ds_read_b128 v[28:31], v8 offset:38912
    v_mfma_f32_16x16x32_bf16 v[148:151], v[84:87], v[36:39], v[148:151]
    ds_read_b64_tr_b16 v[80:81], v12 offset:0
    v_mfma_f32_16x16x32_bf16 v[152:155], v[84:87], v[40:43], v[152:155]
    ds_read_b64_tr_b16 v[82:83], v12 offset:1024
    v_mfma_f32_16x16x32_bf16 v[156:159], v[84:87], v[44:47], v[156:159]
    s_waitcnt lgkmcnt(15)
    v_mfma_f32_16x16x32_bf16 v[160:163], v[88:91], v[32:35], v[160:163]
    ds_read_b64_tr_b16 v[84:85], v12 offset:4096
    v_mfma_f32_16x16x32_bf16 v[164:167], v[88:91], v[36:39], v[164:167]
    ds_read_b64_tr_b16 v[86:87], v12 offset:5120
    v_mfma_f32_16x16x32_bf16 v[168:171], v[88:91], v[40:43], v[168:171]
    v_mfma_f32_16x16x32_bf16 v[172:175], v[88:91], v[44:47], v[172:175]
    s_waitcnt lgkmcnt(15)
    v_mfma_f32_16x16x32_bf16 v[176:179], v[92:95], v[32:35], v[176:179]
    ds_read_b64_tr_b16 v[88:89], v13 offset:0
    v_mfma_f32_16x16x32_bf16 v[180:183], v[92:95], v[36:39], v[180:183]
    ds_read_b64_tr_b16 v[90:91], v13 offset:1024
    v_mfma_f32_16x16x32_bf16 v[184:187], v[92:95], v[40:43], v[184:187]
    v_mfma_f32_16x16x32_bf16 v[188:191], v[92:95], v[44:47], v[188:191]
    s_waitcnt lgkmcnt(15)
    v_mfma_f32_16x16x32_bf16 v[192:195], v[96:99], v[32:35], v[192:195]
    ds_read_b64_tr_b16 v[92:93], v13 offset:4096
    v_mfma_f32_16x16x32_bf16 v[196:199], v[96:99], v[36:39], v[196:199]
    ds_read_b64_tr_b16 v[94:95], v13 offset:5120
    v_mfma_f32_16x16x32_bf16 v[200:203], v[96:99], v[40:43], v[200:203]
    v_mfma_f32_16x16x32_bf16 v[204:207], v[96:99], v[44:47], v[204:207]
    s_waitcnt lgkmcnt(15)
    v_mfma_f32_16x16x32_bf16 v[208:211], v[100:103], v[32:35], v[208:211]
    ds_read_b64_tr_b16 v[96:97], v14 offset:0
    v_mfma_f32_16x16x32_bf16 v[212:215], v[100:103], v[36:39], v[212:215]
    ds_read_b64_tr_b16 v[98:99], v14 offset:1024
    v_mfma_f32_16x16x32_bf16 v[216:219], v[100:103], v[40:43], v[216:219]
    v_mfma_f32_16x16x32_bf16 v[220:223], v[100:103], v[44:47], v[220:223]
    s_waitcnt lgkmcnt(15)
    v_mfma_f32_16x16x32_bf16 v[224:227], v[104:107], v[32:35], v[224:227]
    ds_read_b64_tr_b16 v[100:101], v14 offset:4096
    v_mfma_f32_16x16x32_bf16 v[228:231], v[104:107], v[36:39], v[228:231]
    ds_read_b64_tr_b16 v[102:103], v14 offset:5120
    v_mfma_f32_16x16x32_bf16 v[232:235], v[104:107], v[40:43], v[232:235]
    v_mfma_f32_16x16x32_bf16 v[236:239], v[104:107], v[44:47], v[236:239]
    s_waitcnt lgkmcnt(15)
    v_mfma_f32_16x16x32_bf16 v[240:243], v[108:111], v[32:35], v[240:243]
    ds_read_b64_tr_b16 v[104:105], v15 offset:0
    v_mfma_f32_16x16x32_bf16 v[244:247], v[108:111], v[36:39], v[244:247]
    ds_read_b64_tr_b16 v[106:107], v15 offset:1024
    v_mfma_f32_16x16x32_bf16 v[248:251], v[108:111], v[40:43], v[248:251]
    v_mfma_f32_16x16x32_bf16 v[252:255], v[108:111], v[44:47], v[252:255]
    ds_read_b64_tr_b16 v[108:109], v15 offset:4096
    ds_read_b64_tr_b16 v[110:111], v15 offset:5120
    s_barrier
    s_waitcnt lgkmcnt(14)
    v_mfma_f32_16x16x32_bf16 v[128:131], v[80:83], v[16:19], v[128:131]
    ds_read_b128 v[32:35], v9 offset:32768
    v_mfma_f32_16x16x32_bf16 v[132:135], v[80:83], v[20:23], v[132:135]
    ds_read_b128 v[36:39], v9 offset:34816
    v_mfma_f32_16x16x32_bf16 v[136:139], v[80:83], v[24:27], v[136:139]
    ds_read_b128 v[40:43], v9 offset:36864
    v_mfma_f32_16x16x32_bf16 v[140:143], v[80:83], v[28:31], v[140:143]
    s_waitcnt lgkmcnt(15)
    v_mfma_f32_16x16x32_bf16 v[144:147], v[84:87], v[16:19], v[144:147]
    ds_read_b128 v[44:47], v9 offset:38912
    v_mfma_f32_16x16x32_bf16 v[148:151], v[84:87], v[20:23], v[148:151]
    ds_read_b64_tr_b16 v[80:81], v12 offset:16384
    v_mfma_f32_16x16x32_bf16 v[152:155], v[84:87], v[24:27], v[152:155]
    ds_read_b64_tr_b16 v[82:83], v12 offset:17408
    v_mfma_f32_16x16x32_bf16 v[156:159], v[84:87], v[28:31], v[156:159]
    s_waitcnt lgkmcnt(15)
    v_mfma_f32_16x16x32_bf16 v[160:163], v[88:91], v[16:19], v[160:163]
    ds_read_b64_tr_b16 v[84:85], v12 offset:20480
    v_mfma_f32_16x16x32_bf16 v[164:167], v[88:91], v[20:23], v[164:167]
    ds_read_b64_tr_b16 v[86:87], v12 offset:21504
    v_mfma_f32_16x16x32_bf16 v[168:171], v[88:91], v[24:27], v[168:171]
    v_mfma_f32_16x16x32_bf16 v[172:175], v[88:91], v[28:31], v[172:175]
    s_waitcnt lgkmcnt(15)
    v_mfma_f32_16x16x32_bf16 v[176:179], v[92:95], v[16:19], v[176:179]
    ds_read_b64_tr_b16 v[88:89], v13 offset:16384
    v_mfma_f32_16x16x32_bf16 v[180:183], v[92:95], v[20:23], v[180:183]
    ds_read_b64_tr_b16 v[90:91], v13 offset:17408
    v_mfma_f32_16x16x32_bf16 v[184:187], v[92:95], v[24:27], v[184:187]
    v_mfma_f32_16x16x32_bf16 v[188:191], v[92:95], v[28:31], v[188:191]
    s_waitcnt lgkmcnt(15)
    v_mfma_f32_16x16x32_bf16 v[192:195], v[96:99], v[16:19], v[192:195]
    ds_read_b64_tr_b16 v[92:93], v13 offset:20480
    v_mfma_f32_16x16x32_bf16 v[196:199], v[96:99], v[20:23], v[196:199]
    ds_read_b64_tr_b16 v[94:95], v13 offset:21504
    v_mfma_f32_16x16x32_bf16 v[200:203], v[96:99], v[24:27], v[200:203]
    v_mfma_f32_16x16x32_bf16 v[204:207], v[96:99], v[28:31], v[204:207]
    s_waitcnt lgkmcnt(15)
    v_mfma_f32_16x16x32_bf16 v[208:211], v[100:103], v[16:19], v[208:211]
    ds_read_b64_tr_b16 v[96:97], v14 offset:16384
    v_mfma_f32_16x16x32_bf16 v[212:215], v[100:103], v[20:23], v[212:215]
    ds_read_b64_tr_b16 v[98:99], v14 offset:17408
    v_mfma_f32_16x16x32_bf16 v[216:219], v[100:103], v[24:27], v[216:219]
    v_mfma_f32_16x16x32_bf16 v[220:223], v[100:103], v[28:31], v[220:223]
    s_waitcnt lgkmcnt(15)
    v_mfma_f32_16x16x32_bf16 v[224:227], v[104:107], v[16:19], v[224:227]
    ds_read_b64_tr_b16 v[100:101], v14 offset:20480
    v_mfma_f32_16x16x32_bf16 v[228:231], v[104:107], v[20:23], v[228:231]
    ds_read_b64_tr_b16 v[102:103], v14 offset:21504
    v_mfma_f32_16x16x32_bf16 v[232:235], v[104:107], v[24:27], v[232:235]
    v_mfma_f32_16x16x32_bf16 v[236:239], v[104:107], v[28:31], v[236:239]
    s_waitcnt lgkmcnt(15)
    v_mfma_f32_16x16x32_bf16 v[240:243], v[108:111], v[16:19], v[240:243]
    ds_read_b64_tr_b16 v[104:105], v15 offset:16384
    v_mfma_f32_16x16x32_bf16 v[244:247], v[108:111], v[20:23], v[244:247]
    ds_read_b64_tr_b16 v[106:107], v15 offset:17408
    v_mfma_f32_16x16x32_bf16 v[248:251], v[108:111], v[24:27], v[248:251]
    v_mfma_f32_16x16x32_bf16 v[252:255], v[108:111], v[28:31], v[252:255]
    ds_read_b64_tr_b16 v[108:109], v15 offset:20480
    ds_read_b64_tr_b16 v[110:111], v15 offset:21504
    s_cmp_lg_u32 s64, 0
    s_cbranch_scc1 L_nolook_25
    v_lshlrev_b32 v72, 3, v0
    s_mov_b32 s90, 262144
    buffer_load_dwordx2 v[74:75], v72, s[48:51], s90 offen sc1
    buffer_load_dwordx2 v[76:77], v72, s[48:51], s90 offen offset:512 sc1
L_nolook_25:
    s_barrier
    s_waitcnt lgkmcnt(14)
    v_mfma_f32_16x16x32_bf16 v[128:131], v[80:83], v[32:35], v[128:131]
    ds_read_b128 v[16:19], v8 offset:0
    v_mfma_f32_16x16x32_bf16 v[132:135], v[80:83], v[36:39], v[132:135]
    ds_read_b128 v[20:23], v8 offset:2048
    v_mfma_f32_16x16x32_bf16 v[136:139], v[80:83], v[40:43], v[136:139]
    ds_read_b128 v[24:27], v8 offset:4096
    v_mfma_f32_16x16x32_bf16 v[140:143], v[80:83], v[44:47], v[140:143]
    s_waitcnt lgkmcnt(15)
    v_mfma_f32_16x16x32_bf16 v[144:147], v[84:87], v[32:35], v[144:147]
    ds_read_b128 v[28:31], v8 offset:6144
    v_mfma_f32_16x16x32_bf16 v[148:151], v[84:87], v[36:39], v[148:151]
    ds_read_b64_tr_b16 v[80:81], v68 offset:0
    v_mfma_f32_16x16x32_bf16 v[152:155], v[84:87], v[40:43], v[152:155]
    ds_read_b64_tr_b16 v[82:83], v68 offset:1024
    v_mfma_f32_16x16x32_bf16 v[156:159], v[84:87], v[44:47], v[156:159]
    s_waitcnt lgkmcnt(15)
    v_mfma_f32_16x16x32_bf16 v[160:163], v[88:91], v[32:35], v[160:163]
    ds_read_b64_tr_b16 v[84:85], v68 offset:4096
    v_mfma_f32_16x16x32_bf16 v[164:167], v[88:91], v[36:39], v[164:167]
    ds_read_b64_tr_b16 v[86:87], v68 offset:5120
    v_mfma_f32_16x16x32_bf16 v[168:171], v[88:91], v[40:43], v[168:171]
    v_mfma_f32_16x16x32_bf16 v[172:175], v[88:91], v[44:47], v[172:175]
    s_waitcnt lgkmcnt(15)
    v_mfma_f32_16x16x32_bf16 v[176:179], v[92:95], v[32:35], v[176:179]
    ds_read_b64_tr_b16 v[88:89], v69 offset:0
    v_mfma_f32_16x16x32_bf16 v[180:183], v[92:95], v[36:39], v[180:183]
    ds_read_b64_tr_b16 v[90:91], v69 offset:1024
    v_mfma_f32_16x16x32_bf16 v[184:187], v[92:95], v[40:43], v[184:187]
    v_mfma_f32_16x16x32_bf16 v[188:191], v[92:95], v[44:47], v[188:191]
    s_waitcnt lgkmcnt(15)
    v_mfma_f32_16x16x32_bf16 v[192:195], v[96:99], v[32:35], v[192:195]
    ds_read_b64_tr_b16 v[92:93], v69 offset:4096
    v_mfma_f32_16x16x32_bf16 v[196:199], v[96:99], v[36:39], v[196:199]
    ds_read_b64_tr_b16 v[94:95], v69 offset:5120
    v_mfma_f32_16x16x32_bf16 v[200:203], v[96:99], v[40:43], v[200:203]
    v_mfma_f32_16x16x32_bf16 v[204:207], v[96:99], v[44:47], v[204:207]
    s_waitcnt lgkmcnt(15)
    v_mfma_f32_16x16x32_bf16 v[208:211], v[100:103], v[32:35], v[208:211]
    ds_read_b64_tr_b16 v[96:97], v70 offset:0
    v_mfma_f32_16x16x32_bf16 v[212:215], v[100:103], v[36:39], v[212:215]
    ds_read_b64_tr_b16 v[98:99], v70 offset:1024
    v_mfma_f32_16x16x32_bf16 v[216:219], v[100:103], v[40:43], v[216:219]
    v_mfma_f32_16x16x32_bf16 v[220:223], v[100:103], v[44:47], v[220:223]
    s_waitcnt lgkmcnt(15)
    v_mfma_f32_16x16x32_bf16 v[224:227], v[104:107], v[32:35], v[224:227]
    ds_read_b64_tr_b16 v[100:101], v70 offset:4096
    v_mfma_f32_16x16x32_bf16 v[228:231], v[104:107], v[36:39], v[228:231]
    ds_read_b64_tr_b16 v[102:103], v70 offset:5120
    v_mfma_f32_16x16x32_bf16 v[232:235], v[104:107], v[40:43], v[232:235]
    v_mfma_f32_16x16x32_bf16 v[236:239], v[104:107], v[44:47], v[236:239]
    s_waitcnt lgkmcnt(15)
    v_mfma_f32_16x16x32_bf16 v[240:243], v[108:111], v[32:35], v[240:243]
    ds_read_b64_tr_b16 v[104:105], v71 offset:0
    v_mfma_f32_16x16x32_bf16 v[244:247], v[108:111], v[36:39], v[244:247]
    ds_read_b64_tr_b16 v[106:107], v71 offset:1024
    v_mfma_f32_16x16x32_bf16 v[248:251], v[108:111], v[40:43], v[248:251]
    v_mfma_f32_16x16x32_bf16 v[252:255], v[108:111], v[44:47], v[252:255]
    ds_read_b64_tr_b16 v[108:109], v71 offset:4096
    ds_read_b64_tr_b16 v[110:111], v71 offset:5120
    s_barrier
    s_waitcnt lgkmcnt(14)
    v_mfma_f32_16x16x32_bf16 v[128:131], v[80:83], v[16:19], v[128:131]
    ds_read_b128 v[32:35], v9 offset:0
    v_mfma_f32_16x16x32_bf16 v[132:135], v[80:83], v[20:23], v[132:135]
    ds_read_b128 v[36:39], v9 offset:2048
    v_mfma_f32_16x16x32_bf16 v[136:139], v[80:83], v[24:27], v[136:139]
    ds_read_b128 v[40:43], v9 offset:4096
    v_mfma_f32_16x16x32_bf16 v[140:143], v[80:83], v[28:31], v[140:143]
    s_waitcnt lgkmcnt(15)
    v_mfma_f32_16x16x32_bf16 v[144:147], v[84:87], v[16:19], v[144:147]
    ds_read_b128 v[44:47], v9 offset:6144
    v_mfma_f32_16x16x32_bf16 v[148:151], v[84:87], v[20:23], v[148:151]
    ds_read_b64_tr_b16 v[80:81], v68 offset:16384
    v_mfma_f32_16x16x32_bf16 v[152:155], v[84:87], v[24:27], v[152:155]
    ds_read_b64_tr_b16 v[82:83], v68 offset:17408
    v_mfma_f32_16x16x32_bf16 v[156:159], v[84:87], v[28:31], v[156:159]
    s_waitcnt lgkmcnt(15)
    v_mfma_f32_16x16x32_bf16 v[160:163], v[88:91], v[16:19], v[160:163]
    ds_read_b64_tr_b16 v[84:85], v68 offset:20480
    v_mfma_f32_16x16x32_bf16 v[164:167], v[88:91], v[20:23], v[164:167]
    ds_read_b64_tr_b16 v[86:87], v68 offset:21504
    v_mfma_f32_16x16x32_bf16 v[168:171], v[88:91], v[24:27], v[168:171]
    v_mfma_f32_16x16x32_bf16 v[172:175], v[88:91], v[28:31], v[172:175]
    s_waitcnt lgkmcnt(15)
    v_mfma_f32_16x16x32_bf16 v[176:179], v[92:95], v[16:19], v[176:179]
    ds_read_b64_tr_b16 v[88:89], v69 offset:16384
    v_mfma_f32_16x16x32_bf16 v[180:183], v[92:95], v[20:23], v[180:183]
    ds_read_b64_tr_b16 v[90:91], v69 offset:17408
    v_mfma_f32_16x16x32_bf16 v[184:187], v[92:95], v[24:27], v[184:187]
    v_mfma_f32_16x16x32_bf16 v[188:191], v[92:95], v[28:31], v[188:191]
    s_waitcnt lgkmcnt(15)
    v_mfma_f32_16x16x32_bf16 v[192:195], v[96:99], v[16:19], v[192:195]
    ds_read_b64_tr_b16 v[92:93], v69 offset:20480
    v_mfma_f32_16x16x32_bf16 v[196:199], v[96:99], v[20:23], v[196:199]
    ds_read_b64_tr_b16 v[94:95], v69 offset:21504
    v_mfma_f32_16x16x32_bf16 v[200:203], v[96:99], v[24:27], v[200:203]
    v_mfma_f32_16x16x32_bf16 v[204:207], v[96:99], v[28:31], v[204:207]
    s_waitcnt lgkmcnt(15)
    v_mfma_f32_16x16x32_bf16 v[208:211], v[100:103], v[16:19], v[208:211]
    ds_read_b64_tr_b16 v[96:97], v70 offset:16384
    v_mfma_f32_16x16x32_bf16 v[212:215], v[100:103], v[20:23], v[212:215]
    ds_read_b64_tr_b16 v[98:99], v70 offset:17408
    v_mfma_f32_16x16x32_bf16 v[216:219], v[100:103], v[24:27], v[216:219]
    v_mfma_f32_16x16x32_bf16 v[220:223], v[100:103], v[28:31], v[220:223]
    s_waitcnt lgkmcnt(15)
    v_mfma_f32_16x16x32_bf16 v[224:227], v[104:107], v[16:19], v[224:227]
    ds_read_b64_tr_b16 v[100:101], v70 offset:20480
    v_mfma_f32_16x16x32_bf16 v[228:231], v[104:107], v[20:23], v[228:231]
    ds_read_b64_tr_b16 v[102:103], v70 offset:21504
    v_mfma_f32_16x16x32_bf16 v[232:235], v[104:107], v[24:27], v[232:235]
    v_mfma_f32_16x16x32_bf16 v[236:239], v[104:107], v[28:31], v[236:239]
    s_waitcnt lgkmcnt(15)
    v_mfma_f32_16x16x32_bf16 v[240:243], v[108:111], v[16:19], v[240:243]
    ds_read_b64_tr_b16 v[104:105], v71 offset:16384
    v_mfma_f32_16x16x32_bf16 v[244:247], v[108:111], v[20:23], v[244:247]
    ds_read_b64_tr_b16 v[106:107], v71 offset:17408
    v_mfma_f32_16x16x32_bf16 v[248:251], v[108:111], v[24:27], v[248:251]
    v_mfma_f32_16x16x32_bf16 v[252:255], v[108:111], v[28:31], v[252:255]
    ds_read_b64_tr_b16 v[108:109], v71 offset:20480
    ds_read_b64_tr_b16 v[110:111], v71 offset:21504
    s_cmp_lg_u32 s64, 0
    s_cbranch_scc1 L_nolook_26
    s_waitcnt vmcnt(0)
    v_cmp_ne_u32 vcc, s65, v74
    v_cmp_ne_u32 s[72:73], s65, v76
    s_mov_b32 s66, 0x58800000
    v_cmp_lt_u32 s[74:75], s66, v77
    v_mov_b32 v72, 0x7f800000
    s_nop 0
    v_cndmask_b32 v75, v75, v72, s[74:75]
    s_nop 1
    v_max_u32_dpp v75, v75, v75 row_shr:1
    s_nop 1
    v_max_u32_dpp v75, v75, v75 row_shr:2
    s_nop 1
    v_max_u32_dpp v75, v75, v75 row_shr:4
    s_nop 1
    v_max_u32_dpp v75, v75, v75 row_shr:8
    s_nop 1
    v_max_u32_dpp v75, v75, v75 row_bcast:15 row_mask:0xa
    s_nop 1
    v_max_u32_dpp v75, v75, v75 row_bcast:31 row_mask:0xc
    s_or_b64 vcc, vcc, s[72:73]
    s_cmp_eq_u64 vcc, 0
    s_cselect_b32 s66, 1, 0
    v_mov_b32 v76, s66
    v_mov_b32 v72, 160768
    s_mov_b32 exec_lo, 0
    s_mov_b32 exec_hi, 0x80000000
    ds_write2_b32 v72, v75, v76 offset0:0 offset1:1
    s_mov_b64 exec, -1
    s_waitcnt lgkmcnt(0)
L_nolook_26:
    s_barrier
    s_waitcnt lgkmcnt(14)
    v_mfma_f32_16x16x32_bf16 v[128:131], v[80:83], v[32:35], v[128:131]
    ds_read_b128 v[16:19], v8 offset:16384
    v_mfma_f32_16x16x32_bf16 v[132:135], v[80:83], v[36:39], v[132:135]
    ds_read_b128 v[20:23], v8 offset:18432
    v_mfma_f32_16x16x32_bf16 v[136:139], v[80:83], v[40:43], v[136:139]
    ds_read_b128 v[24:27], v8 offset:20480
    v_mfma_f32_16x16x32_bf16 v[140:143], v[80:83], v[44:47], v[140:143]
    s_waitcnt lgkmcnt(15)
    v_mfma_f32_16x16x32_bf16 v[144:147], v[84:87], v[32:35], v[144:147]
    ds_read_b128 v[28:31], v8 offset:22528
    v_mfma_f32_16x16x32_bf16 v[148:151], v[84:87], v[36:39], v[148:151]
    ds_read_b64_tr_b16 v[80:81], v68 offset:32768
    v_mfma_f32_16x16x32_bf16 v[152:155], v[84:87], v[40:43], v[152:155]
    ds_read_b64_tr_b16 v[82:83], v68 offset:33792
    v_mfma_f32_16x16x32_bf16 v[156:159], v[84:87], v[44:47], v[156:159]
    s_waitcnt lgkmcnt(15)
    v_mfma_f32_16x16x32_bf16 v[160:163], v[88:91], v[32:35], v[160:163]
    ds_read_b64_tr_b16 v[84:85], v68 offset:36864
    v_mfma_f32_16x16x32_bf16 v[164:167], v[88:91], v[36:39], v[164:167]
    ds_read_b64_tr_b16 v[86:87], v68 offset:37888
    v_mfma_f32_16x16x32_bf16 v[168:171], v[88:91], v[40:43], v[168:171]
    v_mfma_f32_16x16x32_bf16 v[172:175], v[88:91], v[44:47], v[172:175]
    s_waitcnt lgkmcnt(15)
    v_mfma_f32_16x16x32_bf16 v[176:179], v[92:95], v[32:35], v[176:179]
    ds_read_b64_tr_b16 v[88:89], v69 offset:32768
    v_mfma_f32_16x16x32_bf16 v[180:183], v[92:95], v[36:39], v[180:183]
    ds_read_b64_tr_b16 v[90:91], v69 offset:33792
    v_mfma_f32_16x16x32_bf16 v[184:187], v[92:95], v[40:43], v[184:187]
    v_mfma_f32_16x16x32_bf16 v[188:191], v[92:95], v[44:47], v[188:191]
    s_waitcnt lgkmcnt(15)
    v_mfma_f32_16x16x32_bf16 v[192:195], v[96:99], v[32:35], v[192:195]
    ds_read_b64_tr_b16 v[92:93], v69 offset:36864
    v_mfma_f32_16x16x32_bf16 v[196:199], v[96:99], v[36:39], v[196:199]
    ds_read_b64_tr_b16 v[94:95], v69 offset:37888
    v_mfma_f32_16x16x32_bf16 v[200:203], v[96:99], v[40:43], v[200:203]
    v_mfma_f32_16x16x32_bf16 v[204:207], v[96:99], v[44:47], v[204:207]
    s_waitcnt lgkmcnt(15)
    v_mfma_f32_16x16x32_bf16 v[208:211], v[100:103], v[32:35], v[208:211]
    ds_read_b64_tr_b16 v[96:97], v70 offset:32768
    v_mfma_f32_16x16x32_bf16 v[212:215], v[100:103], v[36:39], v[212:215]
    ds_read_b64_tr_b16 v[98:99], v70 offset:33792
    v_mfma_f32_16x16x32_bf16 v[216:219], v[100:103], v[40:43], v[216:219]
    v_mfma_f32_16x16x32_bf16 v[220:223], v[100:103], v[44:47], v[220:223]
    s_waitcnt lgkmcnt(15)
    v_mfma_f32_16x16x32_bf16 v[224:227], v[104:107], v[32:35], v[224:227]
    ds_read_b64_tr_b16 v[100:101], v70 offset:36864
    v_mfma_f32_16x16x32_bf16 v[228:231], v[104:107], v[36:39], v[228:231]
    ds_read_b64_tr_b16 v[102:103], v70 offset:37888
    v_mfma_f32_16x16x32_bf16 v[232:235], v[104:107], v[40:43], v[232:235]
    v_mfma_f32_16x16x32_bf16 v[236:239], v[104:107], v[44:47], v[236:239]
    s_waitcnt lgkmcnt(15)
    v_mfma_f32_16x16x32_bf16 v[240:243], v[108:111], v[32:35], v[240:243]
    ds_read_b64_tr_b16 v[104:105], v71 offset:32768
    v_mfma_f32_16x16x32_bf16 v[244:247], v[108:111], v[36:39], v[244:247]
    ds_read_b64_tr_b16 v[106:107], v71 offset:33792
    v_mfma_f32_16x16x32_bf16 v[248:251], v[108:111], v[40:43], v[248:251]
    v_mfma_f32_16x16x32_bf16 v[252:255], v[108:111], v[44:47], v[252:255]
    ds_read_b64_tr_b16 v[108:109], v71 offset:36864
    ds_read_b64_tr_b16 v[110:111], v71 offset:37888
    s_waitcnt lgkmcnt(14)
    v_mfma_f32_16x16x32_bf16 v[128:131], v[80:83], v[16:19], v[128:131]
    ds_read_b128 v[32:35], v9 offset:16384
    v_mfma_f32_16x16x32_bf16 v[132:135], v[80:83], v[20:23], v[132:135]
    ds_read_b128 v[36:39], v9 offset:18432
    v_mfma_f32_16x16x32_bf16 v[136:139], v[80:83], v[24:27], v[136:139]
    ds_read_b128 v[40:43], v9 offset:20480
    v_mfma_f32_16x16x32_bf16 v[140:143], v[80:83], v[28:31], v[140:143]
    s_waitcnt lgkmcnt(15)
    v_mfma_f32_16x16x32_bf16 v[144:147], v[84:87], v[16:19], v[144:147]
    ds_read_b128 v[44:47], v9 offset:22528
    v_mfma_f32_16x16x32_bf16 v[148:151], v[84:87], v[20:23], v[148:151]
    ds_read_b64_tr_b16 v[80:81], v12 offset:0
    v_mfma_f32_16x16x32_bf16 v[152:155], v[84:87], v[24:27], v[152:155]
    ds_read_b64_tr_b16 v[82:83], v12 offset:1024
    v_mfma_f32_16x16x32_bf16 v[156:159], v[84:87], v[28:31], v[156:159]
    s_waitcnt lgkmcnt(15)
    v_mfma_f32_16x16x32_bf16 v[160:163], v[88:91], v[16:19], v[160:163]
    ds_read_b64_tr_b16 v[84:85], v12 offset:4096
    v_mfma_f32_16x16x32_bf16 v[164:167], v[88:91], v[20:23], v[164:167]
    ds_read_b64_tr_b16 v[86:87], v12 offset:5120
    v_mfma_f32_16x16x32_bf16 v[168:171], v[88:91], v[24:27], v[168:171]
    v_mfma_f32_16x16x32_bf16 v[172:175], v[88:91], v[28:31], v[172:175]
    s_waitcnt lgkmcnt(15)
    v_mfma_f32_16x16x32_bf16 v[176:179], v[92:95], v[16:19], v[176:179]
    ds_read_b64_tr_b16 v[88:89], v13 offset:0
    v_mfma_f32_16x16x32_bf16 v[180:183], v[92:95], v[20:23], v[180:183]
    ds_read_b64_tr_b16 v[90:91], v13 offset:1024
    v_mfma_f32_16x16x32_bf16 v[184:187], v[92:95], v[24:27], v[184:187]
    v_mfma_f32_16x16x32_bf16 v[188:191], v[92:95], v[28:31], v[188:191]
    s_waitcnt lgkmcnt(15)
    v_mfma_f32_16x16x32_bf16 v[192:195], v[96:99], v[16:19], v[192:195]
    ds_read_b64_tr_b16 v[92:93], v13 offset:4096
    v_mfma_f32_16x16x32_bf16 v[196:199], v[96:99], v[20:23], v[196:199]
    ds_read_b64_tr_b16 v[94:95], v13 offset:5120
    v_mfma_f32_16x16x32_bf16 v[200:203], v[96:99], v[24:27], v[200:203]
    v_mfma_f32_16x16x32_bf16 v[204:207], v[96:99], v[28:31], v[204:207]
    s_waitcnt lgkmcnt(15)
    v_mfma_f32_16x16x32_bf16 v[208:211], v[100:103], v[16:19], v[208:211]
    ds_read_b64_tr_b16 v[96:97], v14 offset:0
    v_mfma_f32_16x16x32_bf16 v[212:215], v[100:103], v[20:23], v[212:215]
    ds_read_b64_tr_b16 v[98:99], v14 offset:1024
    v_mfma_f32_16x16x32_bf16 v[216:219], v[100:103], v[24:27], v[216:219]
    v_mfma_f32_16x16x32_bf16 v[220:223], v[100:103], v[28:31], v[220:223]
    s_waitcnt lgkmcnt(15)
    v_mfma_f32_16x16x32_bf16 v[224:227], v[104:107], v[16:19], v[224:227]
    ds_read_b64_tr_b16 v[100:101], v14 offset:4096
    v_mfma_f32_16x16x32_bf16 v[228:231], v[104:107], v[20:23], v[228:231]
    ds_read_b64_tr_b16 v[102:103], v14 offset:5120
    v_mfma_f32_16x16x32_bf16 v[232:235], v[104:107], v[24:27], v[232:235]
    v_mfma_f32_16x16x32_bf16 v[236:239], v[104:107], v[28:31], v[236:239]
    s_waitcnt lgkmcnt(15)
    v_mfma_f32_16x16x32_bf16 v[240:243], v[108:111], v[16:19], v[240:243]
    ds_read_b64_tr_b16 v[104:105], v15 offset:0
    v_mfma_f32_16x16x32_bf16 v[244:247], v[108:111], v[20:23], v[244:247]
    ds_read_b64_tr_b16 v[106:107], v15 offset:1024
    v_mfma_f32_16x16x32_bf16 v[248:251], v[108:111], v[24:27], v[248:251]
    v_mfma_f32_16x16x32_bf16 v[252:255], v[108:111], v[28:31], v[252:255]
    ds_read_b64_tr_b16 v[108:109], v15 offset:4096
    ds_read_b64_tr_b16 v[110:111], v15 offset:5120
    v_mov_b32 v6, 160872
    v_mov_b32 v7, 1
    s_mov_b64 exec, 1
    ds_add_u32 v6, v7
    s_mov_b64 exec, -1
    s_waitcnt lgkmcnt(15)
    v_mfma_f32_16x16x32_bf16 v[128:131], v[80:83], v[32:35], v[128:131]
    v_mfma_f32_16x16x32_bf16 v[132:135], v[80:83], v[36:39], v[132:135]
    v_mfma_f32_16x16x32_bf16 v[136:139], v[80:83], v[40:43], v[136:139]
    v_mfma_f32_16x16x32_bf16 v[140:143], v[80:83], v[44:47], v[140:143]
    s_waitcnt lgkmcnt(13)
    v_mfma_f32_16x16x32_bf16 v[144:147], v[84:87], v[32:35], v[144:147]
    v_mfma_f32_16x16x32_bf16 v[148:151], v[84:87], v[36:39], v[148:151]
    v_mfma_f32_16x16x32_bf16 v[152:155], v[84:87], v[40:43], v[152:155]
    v_mfma_f32_16x16x32_bf16 v[156:159], v[84:87], v[44:47], v[156:159]
    s_waitcnt lgkmcnt(11)
    v_mfma_f32_16x16x32_bf16 v[160:163], v[88:91], v[32:35], v[160:163]
    v_mfma_f32_16x16x32_bf16 v[164:167], v[88:91], v[36:39], v[164:167]
    v_mfma_f32_16x16x32_bf16 v[168:171], v[88:91], v[40:43], v[168:171]
    v_mfma_f32_16x16x32_bf16 v[172:175], v[88:91], v[44:47], v[172:175]
    s_waitcnt lgkmcnt(9)
    v_mfma_f32_16x16x32_bf16 v[176:179], v[92:95], v[32:35], v[176:179]
    v_mfma_f32_16x16x32_bf16 v[180:183], v[92:95], v[36:39], v[180:183]
    v_mfma_f32_16x16x32_bf16 v[184:187], v[92:95], v[40:43], v[184:187]
    v_mfma_f32_16x16x32_bf16 v[188:191], v[92:95], v[44:47], v[188:191]
    s_waitcnt lgkmcnt(7)
    v_mfma_f32_16x16x32_bf16 v[192:195], v[96:99], v[32:35], v[192:195]
    v_mfma_f32_16x16x32_bf16 v[196:199], v[96:99], v[36:39], v[196:199]
    v_mfma_f32_16x16x32_bf16 v[200:203], v[96:99], v[40:43], v[200:203]
    v_mfma_f32_16x16x32_bf16 v[204:207], v[96:99], v[44:47], v[204:207]
    s_waitcnt lgkmcnt(5)
    v_mfma_f32_16x16x32_bf16 v[208:211], v[100:103], v[32:35], v[208:211]
    v_mfma_f32_16x16x32_bf16 v[212:215], v[100:103], v[36:39], v[212:215]
    v_mfma_f32_16x16x32_bf16 v[216:219], v[100:103], v[40:43], v[216:219]
    v_mfma_f32_16x16x32_bf16 v[220:223], v[100:103], v[44:47], v[220:223]
    s_waitcnt lgkmcnt(3)
    v_mfma_f32_16x16x32_bf16 v[224:227], v[104:107], v[32:35], v[224:227]
    v_mfma_f32_16x16x32_bf16 v[228:231], v[104:107], v[36:39], v[228:231]
    v_mfma_f32_16x16x32_bf16 v[232:235], v[104:107], v[40:43], v[232:235]
    v_mfma_f32_16x16x32_bf16 v[236:239], v[104:107], v[44:47], v[236:239]
    s_waitcnt lgkmcnt(1)
    v_mfma_f32_16x16x32_bf16 v[240:243], v[108:111], v[32:35], v[240:243]
    v_mfma_f32_16x16x32_bf16 v[244:247], v[108:111], v[36:39], v[244:247]
    v_mfma_f32_16x16x32_bf16 v[248:251], v[108:111], v[40:43], v[248:251]
    v_mfma_f32_16x16x32_bf16 v[252:255], v[108:111], v[44:47], v[252:255]
    s_setprio 2
    s_nop 7
    v_pk_mul_f32 v[16:17], v[128:129], v[128:129]
    v_pk_mul_f32 v[18:19], v[130:131], v[130:131]
    v_pk_mul_f32 v[20:21], v[132:133], v[132:133]
    v_pk_mul_f32 v[22:23], v[134:135], v[134:135]
    v_pk_mul_f32 v[24:25], v[136:137], v[136:137]
    v_pk_mul_f32 v[26:27], v[138:139], v[138:139]
    v_pk_mul_f32 v[28:29], v[140:141], v[140:141]
    v_pk_mul_f32 v[30:31], v[142:143], v[142:143]
    v_pk_fma_f32 v[16:17], v[16:17], s[92:93], v[4:5]
    v_pk_fma_f32 v[18:19], v[18:19], s[92:93], v[4:5]
    v_pk_fma_f32 v[20:21], v[20:21], s[92:93], v[4:5]
    v_pk_fma_f32 v[22:23], v[22:23], s[92:93], v[4:5]
    v_pk_fma_f32 v[24:25], v[24:25], s[92:93], v[4:5]
    v_pk_fma_f32 v[26:27], v[26:27], s[92:93], v[4:5]
    v_pk_fma_f32 v[28:29], v[28:29], s[92:93], v[4:5]
    v_pk_fma_f32 v[30:31], v[30:31], s[92:93], v[4:5]
    v_pk_mul_f32 v[16:17], v[16:17], v[128:129]
    v_pk_mul_f32 v[18:19], v[18:19], v[130:131]
    v_pk_mul_f32 v[20:21], v[20:21], v[132:133]
    v_pk_mul_f32 v[22:23], v[22:23], v[134:135]
    v_pk_mul_f32 v[24:25], v[24:25], v[136:137]
    v_pk_mul_f32 v[26:27], v[26:27], v[138:139]
    v_pk_mul_f32 v[28:29], v[28:29], v[140:141]
    v_pk_mul_f32 v[30:31], v[30:31], v[142:143]
    v_exp_f32 v16, v16
    v_exp_f32 v17, v17
    v_exp_f32 v18, v18
    v_exp_f32 v19, v19
    v_exp_f32 v20, v20
    v_exp_f32 v21, v21
    v_exp_f32 v22, v22
    v_exp_f32 v23, v23
    v_exp_f32 v24, v24
    v_exp_f32 v25, v25
    v_exp_f32 v26, v26
    v_exp_f32 v27, v27
    v_exp_f32 v28, v28
    v_exp_f32 v29, v29
    v_exp_f32 v30, v30
    v_exp_f32 v31, v31
    v_pk_mul_f32 v[128:129], v[128:129], v[144:145]
    v_pk_mul_f32 v[130:131], v[130:131], v[146:147]
    v_pk_mul_f32 v[132:133], v[132:133], v[148:149]
    v_pk_mul_f32 v[134:135], v[134:135], v[150:151]
    v_pk_mul_f32 v[136:137], v[136:137], v[152:153]
    v_pk_mul_f32 v[138:139], v[138:139], v[154:155]
    v_pk_mul_f32 v[140:141], v[140:141], v[156:157]
    v_pk_mul_f32 v[142:143], v[142:143], v[158:159]
    v_pk_add_f32 v[16:17], v[16:17], 1.0 op_sel_hi:[1,0]
    v_pk_add_f32 v[18:19], v[18:19], 1.0 op_sel_hi:[1,0]
    v_pk_add_f32 v[20:21], v[20:21], 1.0 op_sel_hi:[1,0]
    v_pk_add_f32 v[22:23], v[22:23], 1.0 op_sel_hi:[1,0]
    v_pk_add_f32 v[24:25], v[24:25], 1.0 op_sel_hi:[1,0]
    v_pk_add_f32 v[26:27], v[26:27], 1.0 op_sel_hi:[1,0]
    v_pk_add_f32 v[28:29], v[28:29], 1.0 op_sel_hi:[1,0]
    v_pk_add_f32 v[30:31], v[30:31], 1.0 op_sel_hi:[1,0]
    v_rcp_f32 v16, v16
    v_rcp_f32 v17, v17
    v_rcp_f32 v18, v18
    v_rcp_f32 v19, v19
    v_rcp_f32 v20, v20
    v_rcp_f32 v21, v21
    v_rcp_f32 v22, v22
    v_rcp_f32 v23, v23
    v_rcp_f32 v24, v24
    v_rcp_f32 v25, v25
    v_rcp_f32 v26, v26
    v_rcp_f32 v27, v27
    v_rcp_f32 v28, v28
    v_rcp_f32 v29, v29
    v_rcp_f32 v30, v30
    v_rcp_f32 v31, v31
    s_nop 0
    v_pk_mul_f32 v[128:129], v[128:129], v[16:17]
    v_pk_mul_f32 v[130:131], v[130:131], v[18:19]
    v_pk_mul_f32 v[132:133], v[132:133], v[20:21]
    v_pk_mul_f32 v[134:135], v[134:135], v[22:23]
    v_pk_mul_f32 v[136:137], v[136:137], v[24:25]
    v_pk_mul_f32 v[138:139], v[138:139], v[26:27]
    v_pk_mul_f32 v[140:141], v[140:141], v[28:29]
    v_pk_mul_f32 v[142:143], v[142:143], v[30:31]
    v_cvt_pk_bf16_f32 v144, v128, v129
    v_cvt_pk_bf16_f32 v145, v130, v131
    v_cvt_pk_bf16_f32 v146, v132, v133
    v_cvt_pk_bf16_f32 v147, v134, v135
    v_cvt_pk_bf16_f32 v148, v136, v137
    v_cvt_pk_bf16_f32 v149, v138, v139
    v_cvt_pk_bf16_f32 v150, v140, v141
    v_cvt_pk_bf16_f32 v151, v142, v143
    s_nop 0
    v_permlane16_swap_b32 v144, v146
    v_permlane16_swap_b32 v145, v147
    buffer_store_dwordx4 v[144:147], v2, s[48:51], s86 offen offset:0 sc1
    v_permlane16_swap_b32 v148, v150
    v_permlane16_swap_b32 v149, v151
    buffer_store_dwordx4 v[148:151], v2, s[48:51], s87 offen offset:0 sc1
    v_pk_mul_f32 v[32:33], v[160:161], v[160:161]
    v_pk_mul_f32 v[34:35], v[162:163], v[162:163]
    v_pk_mul_f32 v[36:37], v[164:165], v[164:165]
    v_pk_mul_f32 v[38:39], v[166:167], v[166:167]
    v_pk_mul_f32 v[40:41], v[168:169], v[168:169]
    v_pk_mul_f32 v[42:43], v[170:171], v[170:171]
    v_pk_mul_f32 v[44:45], v[172:173], v[172:173]
    v_pk_mul_f32 v[46:47], v[174:175], v[174:175]
    v_pk_fma_f32 v[32:33], v[32:33], s[92:93], v[4:5]
    v_pk_fma_f32 v[34:35], v[34:35], s[92:93], v[4:5]
    v_pk_fma_f32 v[36:37], v[36:37], s[92:93], v[4:5]
    v_pk_fma_f32 v[38:39], v[38:39], s[92:93], v[4:5]
    v_pk_fma_f32 v[40:41], v[40:41], s[92:93], v[4:5]
    v_pk_fma_f32 v[42:43], v[42:43], s[92:93], v[4:5]
    v_pk_fma_f32 v[44:45], v[44:45], s[92:93], v[4:5]
    v_pk_fma_f32 v[46:47], v[46:47], s[92:93], v[4:5]
    v_pk_mul_f32 v[32:33], v[32:33], v[160:161]
    v_pk_mul_f32 v[34:35], v[34:35], v[162:163]
    v_pk_mul_f32 v[36:37], v[36:37], v[164:165]
    v_pk_mul_f32 v[38:39], v[38:39], v[166:167]
    v_pk_mul_f32 v[40:41], v[40:41], v[168:169]
    v_pk_mul_f32 v[42:43], v[42:43], v[170:171]
    v_pk_mul_f32 v[44:45], v[44:45], v[172:173]
    v_pk_mul_f32 v[46:47], v[46:47], v[174:175]
    v_exp_f32 v32, v32
    v_exp_f32 v33, v33
    v_exp_f32 v34, v34
    v_exp_f32 v35, v35
    v_exp_f32 v36, v36
    v_exp_f32 v37, v37
    v_exp_f32 v38, v38
    v_exp_f32 v39, v39
    v_exp_f32 v40, v40
    v_exp_f32 v41, v41
    v_exp_f32 v42, v42
    v_exp_f32 v43, v43
    v_exp_f32 v44, v44
    v_exp_f32 v45, v45
    v_exp_f32 v46, v46
    v_exp_f32 v47, v47
    v_pk_mul_f32 v[160:161], v[160:161], v[176:177]
    v_pk_mul_f32 v[162:163], v[162:163], v[178:179]
    v_pk_mul_f32 v[164:165], v[164:165], v[180:181]
    v_pk_mul_f32 v[166:167], v[166:167], v[182:183]
    v_pk_mul_f32 v[168:169], v[168:169], v[184:185]
    v_pk_mul_f32 v[170:171], v[170:171], v[186:187]
    v_pk_mul_f32 v[172:173], v[172:173], v[188:189]
    v_pk_mul_f32 v[174:175], v[174:175], v[190:191]
    v_pk_add_f32 v[32:33], v[32:33], 1.0 op_sel_hi:[1,0]
    v_pk_add_f32 v[34:35], v[34:35], 1.0 op_sel_hi:[1,0]
    v_pk_add_f32 v[36:37], v[36:37], 1.0 op_sel_hi:[1,0]
    v_pk_add_f32 v[38:39], v[38:39], 1.0 op_sel_hi:[1,0]
    v_pk_add_f32 v[40:41], v[40:41], 1.0 op_sel_hi:[1,0]
    v_pk_add_f32 v[42:43], v[42:43], 1.0 op_sel_hi:[1,0]
    v_pk_add_f32 v[44:45], v[44:45], 1.0 op_sel_hi:[1,0]
    v_pk_add_f32 v[46:47], v[46:47], 1.0 op_sel_hi:[1,0]
    v_rcp_f32 v32, v32
    v_rcp_f32 v33, v33
    v_rcp_f32 v34, v34
    v_rcp_f32 v35, v35
    v_rcp_f32 v36, v36
    v_rcp_f32 v37, v37
    v_rcp_f32 v38, v38
    v_rcp_f32 v39, v39
    v_rcp_f32 v40, v40
    v_rcp_f32 v41, v41
    v_rcp_f32 v42, v42
    v_rcp_f32 v43, v43
    v_rcp_f32 v44, v44
    v_rcp_f32 v45, v45
    v_rcp_f32 v46, v46
    v_rcp_f32 v47, v47
    s_nop 0
    v_pk_mul_f32 v[160:161], v[160:161], v[32:33]
    v_pk_mul_f32 v[162:163], v[162:163], v[34:35]
    v_pk_mul_f32 v[164:165], v[164:165], v[36:37]
    v_pk_mul_f32 v[166:167], v[166:167], v[38:39]
    v_pk_mul_f32 v[168:169], v[168:169], v[40:41]
    v_pk_mul_f32 v[170:171], v[170:171], v[42:43]
    v_pk_mul_f32 v[172:173], v[172:173], v[44:45]
    v_pk_mul_f32 v[174:175], v[174:175], v[46:47]
    v_cvt_pk_bf16_f32 v176, v160, v161
    v_cvt_pk_bf16_f32 v177, v162, v163
    v_cvt_pk_bf16_f32 v178, v164, v165
    v_cvt_pk_bf16_f32 v179, v166, v167
    v_cvt_pk_bf16_f32 v180, v168, v169
    v_cvt_pk_bf16_f32 v181, v170, v171
    v_cvt_pk_bf16_f32 v182, v172, v173
    v_cvt_pk_bf16_f32 v183, v174, v175
    s_nop 0
    v_permlane16_swap_b32 v176, v178
    v_permlane16_swap_b32 v177, v179
    buffer_store_dwordx4 v[176:179], v2, s[48:51], s86 offen offset:1024 sc1
    v_permlane16_swap_b32 v180, v182
    v_permlane16_swap_b32 v181, v183
    buffer_store_dwordx4 v[180:183], v2, s[48:51], s87 offen offset:1024 sc1
    v_pk_mul_f32 v[16:17], v[192:193], v[192:193]
    v_pk_mul_f32 v[18:19], v[194:195], v[194:195]
    v_pk_mul_f32 v[20:21], v[196:197], v[196:197]
    v_pk_mul_f32 v[22:23], v[198:199], v[198:199]
    v_pk_mul_f32 v[24:25], v[200:201], v[200:201]
    v_pk_mul_f32 v[26:27], v[202:203], v[202:203]
    v_pk_mul_f32 v[28:29], v[204:205], v[204:205]
    v_pk_mul_f32 v[30:31], v[206:207], v[206:207]
    v_pk_fma_f32 v[16:17], v[16:17], s[92:93], v[4:5]
    v_pk_fma_f32 v[18:19], v[18:19], s[92:93], v[4:5]
    v_pk_fma_f32 v[20:21], v[20:21], s[92:93], v[4:5]
    v_pk_fma_f32 v[22:23], v[22:23], s[92:93], v[4:5]
    v_pk_fma_f32 v[24:25], v[24:25], s[92:93], v[4:5]
    v_pk_fma_f32 v[26:27], v[26:27], s[92:93], v[4:5]
    v_pk_fma_f32 v[28:29], v[28:29], s[92:93], v[4:5]
    v_pk_fma_f32 v[30:31], v[30:31], s[92:93], v[4:5]
    v_pk_mul_f32 v[16:17], v[16:17], v[192:193]
    v_pk_mul_f32 v[18:19], v[18:19], v[194:195]
    v_pk_mul_f32 v[20:21], v[20:21], v[196:197]
    v_pk_mul_f32 v[22:23], v[22:23], v[198:199]
    v_pk_mul_f32 v[24:25], v[24:25], v[200:201]
    v_pk_mul_f32 v[26:27], v[26:27], v[202:203]
    v_pk_mul_f32 v[28:29], v[28:29], v[204:205]
    v_pk_mul_f32 v[30:31], v[30:31], v[206:207]
    v_exp_f32 v16, v16
    v_exp_f32 v17, v17
    v_exp_f32 v18, v18
    v_exp_f32 v19, v19
    v_exp_f32 v20, v20
    v_exp_f32 v21, v21
    v_exp_f32 v22, v22
    v_exp_f32 v23, v23
    v_exp_f32 v24, v24
    v_exp_f32 v25, v25
    v_exp_f32 v26, v26
    v_exp_f32 v27, v27
    v_exp_f32 v28, v28
    v_exp_f32 v29, v29
    v_exp_f32 v30, v30
    v_exp_f32 v31, v31
    v_pk_mul_f32 v[192:193], v[192:193], v[208:209]
    v_pk_mul_f32 v[194:195], v[194:195], v[210:211]
    v_pk_mul_f32 v[196:197], v[196:197], v[212:213]
    v_pk_mul_f32 v[198:199], v[198:199], v[214:215]
    v_pk_mul_f32 v[200:201], v[200:201], v[216:217]
    v_pk_mul_f32 v[202:203], v[202:203], v[218:219]
    v_pk_mul_f32 v[204:205], v[204:205], v[220:221]
    v_pk_mul_f32 v[206:207], v[206:207], v[222:223]
    v_pk_add_f32 v[16:17], v[16:17], 1.0 op_sel_hi:[1,0]
    v_pk_add_f32 v[18:19], v[18:19], 1.0 op_sel_hi:[1,0]
    v_pk_add_f32 v[20:21], v[20:21], 1.0 op_sel_hi:[1,0]
    v_pk_add_f32 v[22:23], v[22:23], 1.0 op_sel_hi:[1,0]
    v_pk_add_f32 v[24:25], v[24:25], 1.0 op_sel_hi:[1,0]
    v_pk_add_f32 v[26:27], v[26:27], 1.0 op_sel_hi:[1,0]
    v_pk_add_f32 v[28:29], v[28:29], 1.0 op_sel_hi:[1,0]
    v_pk_add_f32 v[30:31], v[30:31], 1.0 op_sel_hi:[1,0]
    v_rcp_f32 v16, v16
    v_rcp_f32 v17, v17
    v_rcp_f32 v18, v18
    v_rcp_f32 v19, v19
    v_rcp_f32 v20, v20
    v_rcp_f32 v21, v21
    v_rcp_f32 v22, v22
    v_rcp_f32 v23, v23
    v_rcp_f32 v24, v24
    v_rcp_f32 v25, v25
    v_rcp_f32 v26, v26
    v_rcp_f32 v27, v27
    v_rcp_f32 v28, v28
    v_rcp_f32 v29, v29
    v_rcp_f32 v30, v30
    v_rcp_f32 v31, v31
    s_nop 0
    v_pk_mul_f32 v[192:193], v[192:193], v[16:17]
    v_pk_mul_f32 v[194:195], v[194:195], v[18:19]
    v_pk_mul_f32 v[196:197], v[196:197], v[20:21]
    v_pk_mul_f32 v[198:199], v[198:199], v[22:23]
    v_pk_mul_f32 v[200:201], v[200:201], v[24:25]
    v_pk_mul_f32 v[202:203], v[202:203], v[26:27]
    v_pk_mul_f32 v[204:205], v[204:205], v[28:29]
    v_pk_mul_f32 v[206:207], v[206:207], v[30:31]
    v_cvt_pk_bf16_f32 v208, v192, v193
    v_cvt_pk_bf16_f32 v209, v194, v195
    v_cvt_pk_bf16_f32 v210, v196, v197
    v_cvt_pk_bf16_f32 v211, v198, v199
    v_cvt_pk_bf16_f32 v212, v200, v201
    v_cvt_pk_bf16_f32 v213, v202, v203
    v_cvt_pk_bf16_f32 v214, v204, v205
    v_cvt_pk_bf16_f32 v215, v206, v207
    s_nop 0
    v_permlane16_swap_b32 v208, v210
    v_permlane16_swap_b32 v209, v211
    buffer_store_dwordx4 v[208:211], v2, s[48:51], s86 offen offset:2048 sc1
    v_permlane16_swap_b32 v212, v214
    v_permlane16_swap_b32 v213, v215
    buffer_store_dwordx4 v[212:215], v2, s[48:51], s87 offen offset:2048 sc1
    v_pk_mul_f32 v[32:33], v[224:225], v[224:225]
    v_pk_mul_f32 v[34:35], v[226:227], v[226:227]
    v_pk_mul_f32 v[36:37], v[228:229], v[228:229]
    v_pk_mul_f32 v[38:39], v[230:231], v[230:231]
    v_pk_mul_f32 v[40:41], v[232:233], v[232:233]
    v_pk_mul_f32 v[42:43], v[234:235], v[234:235]
    v_pk_mul_f32 v[44:45], v[236:237], v[236:237]
    v_pk_mul_f32 v[46:47], v[238:239], v[238:239]
    v_pk_fma_f32 v[32:33], v[32:33], s[92:93], v[4:5]
    v_pk_fma_f32 v[34:35], v[34:35], s[92:93], v[4:5]
    v_pk_fma_f32 v[36:37], v[36:37], s[92:93], v[4:5]
    v_pk_fma_f32 v[38:39], v[38:39], s[92:93], v[4:5]
    v_pk_fma_f32 v[40:41], v[40:41], s[92:93], v[4:5]
    v_pk_fma_f32 v[42:43], v[42:43], s[92:93], v[4:5]
    v_pk_fma_f32 v[44:45], v[44:45], s[92:93], v[4:5]
    v_pk_fma_f32 v[46:47], v[46:47], s[92:93], v[4:5]
    v_pk_mul_f32 v[32:33], v[32:33], v[224:225]
    v_pk_mul_f32 v[34:35], v[34:35], v[226:227]
    v_pk_mul_f32 v[36:37], v[36:37], v[228:229]
    v_pk_mul_f32 v[38:39], v[38:39], v[230:231]
    v_pk_mul_f32 v[40:41], v[40:41], v[232:233]
    v_pk_mul_f32 v[42:43], v[42:43], v[234:235]
    v_pk_mul_f32 v[44:45], v[44:45], v[236:237]
    v_pk_mul_f32 v[46:47], v[46:47], v[238:239]
    v_exp_f32 v32, v32
    v_exp_f32 v33, v33
    v_exp_f32 v34, v34
    v_exp_f32 v35, v35
    v_exp_f32 v36, v36
    v_exp_f32 v37, v37
    v_exp_f32 v38, v38
    v_exp_f32 v39, v39
    v_exp_f32 v40, v40
    v_exp_f32 v41, v41
    v_exp_f32 v42, v42
    v_exp_f32 v43, v43
    v_exp_f32 v44, v44
    v_exp_f32 v45, v45
    v_exp_f32 v46, v46
    v_exp_f32 v47, v47
    v_pk_mul_f32 v[224:225], v[224:225], v[240:241]
    v_pk_mul_f32 v[226:227], v[226:227], v[242:243]
    v_pk_mul_f32 v[228:229], v[228:229], v[244:245]
    v_pk_mul_f32 v[230:231], v[230:231], v[246:247]
    v_pk_mul_f32 v[232:233], v[232:233], v[248:249]
    v_pk_mul_f32 v[234:235], v[234:235], v[250:251]
    v_pk_mul_f32 v[236:237], v[236:237], v[252:253]
    v_pk_mul_f32 v[238:239], v[238:239], v[254:255]
    v_pk_add_f32 v[32:33], v[32:33], 1.0 op_sel_hi:[1,0]
    v_pk_add_f32 v[34:35], v[34:35], 1.0 op_sel_hi:[1,0]
    v_pk_add_f32 v[36:37], v[36:37], 1.0 op_sel_hi:[1,0]
    v_pk_add_f32 v[38:39], v[38:39], 1.0 op_sel_hi:[1,0]
    v_pk_add_f32 v[40:41], v[40:41], 1.0 op_sel_hi:[1,0]
    v_pk_add_f32 v[42:43], v[42:43], 1.0 op_sel_hi:[1,0]
    v_pk_add_f32 v[44:45], v[44:45], 1.0 op_sel_hi:[1,0]
    v_pk_add_f32 v[46:47], v[46:47], 1.0 op_sel_hi:[1,0]
    v_rcp_f32 v32, v32
    v_rcp_f32 v33, v33
    v_rcp_f32 v34, v34
    v_rcp_f32 v35, v35
    v_rcp_f32 v36, v36
    v_rcp_f32 v37, v37
    v_rcp_f32 v38, v38
    v_rcp_f32 v39, v39
    v_rcp_f32 v40, v40
    v_rcp_f32 v41, v41
    v_rcp_f32 v42, v42
    v_rcp_f32 v43, v43
    v_rcp_f32 v44, v44
    v_rcp_f32 v45, v45
    v_rcp_f32 v46, v46
    v_rcp_f32 v47, v47
    s_nop 0
    v_pk_mul_f32 v[224:225], v[224:225], v[32:33]
    v_pk_mul_f32 v[226:227], v[226:227], v[34:35]
    v_pk_mul_f32 v[228:229], v[228:229], v[36:37]
    v_pk_mul_f32 v[230:231], v[230:231], v[38:39]
    v_pk_mul_f32 v[232:233], v[232:233], v[40:41]
    v_pk_mul_f32 v[234:235], v[234:235], v[42:43]
    v_pk_mul_f32 v[236:237], v[236:237], v[44:45]
    v_pk_mul_f32 v[238:239], v[238:239], v[46:47]
    v_cvt_pk_bf16_f32 v240, v224, v225
    v_cvt_pk_bf16_f32 v241, v226, v227
    v_cvt_pk_bf16_f32 v242, v228, v229
    v_cvt_pk_bf16_f32 v243, v230, v231
    v_cvt_pk_bf16_f32 v244, v232, v233
    v_cvt_pk_bf16_f32 v245, v234, v235
    v_cvt_pk_bf16_f32 v246, v236, v237
    v_cvt_pk_bf16_f32 v247, v238, v239
    s_nop 0
    v_permlane16_swap_b32 v240, v242
    v_permlane16_swap_b32 v241, v243
    buffer_store_dwordx4 v[240:243], v2, s[48:51], s86 offen offset:3072 sc1
    v_permlane16_swap_b32 v244, v246
    v_permlane16_swap_b32 v245, v247
    buffer_store_dwordx4 v[244:247], v2, s[48:51], s87 offen offset:3072 sc1
    v_mov_b64 v[76:77], -1
    v_mov_b64 v[78:79], -1
    buffer_store_dwordx4 v[76:79], v66, s[48:51], s88 offen offset:0 sc1
    buffer_store_dwordx4 v[76:79], v66, s[48:51], s88 offen offset:256 sc1
    s_lshl_b32 s66, s82, 11
    s_lshl_b32 s67, s83, 7
    s_add_u32 s66, s66, s67
    s_add_u32 s66, s66, 524288
    s_waitcnt vmcnt(0)
    v_mov_b32 v6, 160844
    v_mov_b32 v7, 1
    s_mov_b64 exec, 1
    ds_add_u32 v6, v7
    s_mov_b64 exec, -1
L_ls_27:
    ds_read_b32 v7, v6
    s_waitcnt lgkmcnt(0)
    v_readfirstlane_b32 s76, v7
    s_cmp_lt_u32 s76, 4
    s_cbranch_scc1 L_ls_27
    v_mov_b32 v6, 160872
L_ringdead_28:
    ds_read_b32 v7, v6
    s_waitcnt lgkmcnt(0)
    v_readfirstlane_b32 s76, v7
    s_cmp_lt_u32 s76, 8
    s_cbranch_scc1 L_ringdead_28
    s_cmp_lg_u32 s64, 0
    s_cbranch_scc1 L_s1end_24
    s_mov_b64 exec, 1
    buffer_store_dword v64, v65, s[48:51], s66 offen sc1
    s_mov_b64 exec, -1
    s_branch L_s1end_24
L_Fidle_23:
    s_lshl_b32 s66, s64, 12
    v_and_b32 v5, 31, v0
    v_lshrrev_b32 v6, 5, v0
    v_bfe_u32 v7, v0, 1, 3
    v_xor_b32 v7, v7, v6
    v_lshlrev_b32 v5, 7, v5
    v_add_u32 v5, s66, v5
    v_xor_b32 v8, 0, v7
    v_lshl_add_u32 v8, v8, 4, v5
    v_xor_b32 v9, 2, v7
    v_lshl_add_u32 v9, v9, 4, v5
    v_xor_b32 v10, 4, v7
    v_lshl_add_u32 v10, v10, 4, v5
    v_xor_b32 v11, 6, v7
    v_lshl_add_u32 v11, v11, 4, v5
    v_bfe_u32 v5, v0, 2, 2
    v_lshl_add_u32 v5, v6, 3, v5
    v_and_b32 v7, 3, v0
    v_lshlrev_b32 v7, 3, v7
    v_lshl_add_u32 v12, v5, 5, v7
    v_add_u32 v12, 81920, v12
    v_lshlrev_b32 v13, 4, v6
    v_add_u32 v13, 98304, v13
    v_lshlrev_b32 v4, 4, v0
    s_lshl_b32 s87, s82, 2
    s_add_u32 s87, s87, s64
    s_waitcnt lgkmcnt(0)
    s_load_dword s65, s[40:41], 0
    s_mov_b32 s44, s16
    s_mov_b32 s45, s17
    s_mov_b32 s46, 0x200000
    s_mov_b32 s47, 0x20000
    s_mov_b32 s48, s40
    s_mov_b32 s49, s41
    s_mov_b32 s50, 0x10000000
    s_mov_b32 s51, 0x20000
    s_lshl_b32 s68, s2, 5
    s_lshl_b32 s69, s64, 2
    s_add_u32 s68, s68, s69
    s_add_u32 s68, s68, 24592
    v_mov_b32 v65, 0
    s_waitcnt lgkmcnt(0)
    s_mul_i32 s65, s65, 0x9E3779B1
    s_add_u32 s65, s65, 0x7F4A7C15
    v_mov_b32 v64, s65
    s_mov_b64 exec, 1
    buffer_store_dword v64, v65, s[48:51], s68 offen sc1
    s_mov_b64 exec, -1
    v_mov_b64 v[76:77], -1
    v_mov_b64 v[78:79], -1
    buffer_store_dwordx4 v[76:79], v66, s[48:51], s88 offen offset:0 sc1
    buffer_store_dwordx4 v[76:79], v66, s[48:51], s88 offen offset:256 sc1
    s_cmp_eq_u32 s83, 15
    s_cbranch_scc1 L_FV_29
    s_barrier
    ds_read_b128 v[16:19], v8 offset:0
    ds_read_b64_tr_b16 v[24:25], v12 offset:0
    ds_read_b64_tr_b16 v[26:27], v12 offset:128
    ds_read_b128 v[88:91], v13 offset:0
    ds_read_b128 v[20:23], v9 offset:0
    ds_read_b64_tr_b16 v[28:29], v12 offset:512
    ds_read_b64_tr_b16 v[30:31], v12 offset:640
    ds_read_b128 v[92:95], v13 offset:32
    s_waitcnt lgkmcnt(4)
    v_mfma_f32_32x32x16_bf16 v[32:47], v[24:27], v[16:19], 0
    v_mfma_f32_32x32x16_bf16 v[48:63], v[88:91], v[16:19], 0
    ds_read_b128 v[16:19], v10 offset:0
    ds_read_b64_tr_b16 v[24:25], v12 offset:1024
    ds_read_b64_tr_b16 v[26:27], v12 offset:1152
    ds_read_b128 v[88:91], v13 offset:64
    s_waitcnt lgkmcnt(4)
    v_mfma_f32_32x32x16_bf16 v[32:47], v[28:31], v[20:23], v[32:47]
    v_mfma_f32_32x32x16_bf16 v[48:63], v[92:95], v[20:23], v[48:63]
    ds_read_b128 v[20:23], v11 offset:0
    ds_read_b64_tr_b16 v[28:29], v12 offset:1536
    ds_read_b64_tr_b16 v[30:31], v12 offset:1664
    ds_read_b128 v[92:95], v13 offset:96
    s_waitcnt lgkmcnt(4)
    v_mfma_f32_32x32x16_bf16 v[32:47], v[24:27], v[16:19], v[32:47]
    v_mfma_f32_32x32x16_bf16 v[48:63], v[88:91], v[16:19], v[48:63]
    s_waitcnt lgkmcnt(0)
    v_mfma_f32_32x32x16_bf16 v[32:47], v[28:31], v[20:23], v[32:47]
    v_mfma_f32_32x32x16_bf16 v[48:63], v[92:95], v[20:23], v[48:63]
    s_barrier
    ds_read_b128 v[16:19], v8 offset:16384
    ds_read_b64_tr_b16 v[24:25], v12 offset:2048
    ds_read_b64_tr_b16 v[26:27], v12 offset:2176
    ds_read_b128 v[88:91], v13 offset:128
    ds_read_b128 v[20:23], v9 offset:16384
    ds_read_b64_tr_b16 v[28:29], v12 offset:2560
    ds_read_b64_tr_b16 v[30:31], v12 offset:2688
    ds_read_b128 v[92:95], v13 offset:160
    s_waitcnt lgkmcnt(4)
    v_mfma_f32_32x32x16_bf16 v[32:47], v[24:27], v[16:19], v[32:47]
    v_mfma_f32_32x32x16_bf16 v[48:63], v[88:91], v[16:19], v[48:63]
    ds_read_b128 v[16:19], v10 offset:16384
    ds_read_b64_tr_b16 v[24:25], v12 offset:3072
    ds_read_b64_tr_b16 v[26:27], v12 offset:3200
    ds_read_b128 v[88:91], v13 offset:192
    s_waitcnt lgkmcnt(4)
    v_mfma_f32_32x32x16_bf16 v[32:47], v[28:31], v[20:23], v[32:47]
    v_mfma_f32_32x32x16_bf16 v[48:63], v[92:95], v[20:23], v[48:63]
    ds_read_b128 v[20:23], v11 offset:16384
    ds_read_b64_tr_b16 v[28:29], v12 offset:3584
    ds_read_b64_tr_b16 v[30:31], v12 offset:3712
    ds_read_b128 v[92:95], v13 offset:224
    s_waitcnt lgkmcnt(4)
    v_mfma_f32_32x32x16_bf16 v[32:47], v[24:27], v[16:19], v[32:47]
    v_mfma_f32_32x32x16_bf16 v[48:63], v[88:91], v[16:19], v[48:63]
    s_waitcnt lgkmcnt(0)
    v_mfma_f32_32x32x16_bf16 v[32:47], v[28:31], v[20:23], v[32:47]
    v_mfma_f32_32x32x16_bf16 v[48:63], v[92:95], v[20:23], v[48:63]
    s_barrier
    ds_read_b128 v[16:19], v8 offset:32768
    ds_read_b64_tr_b16 v[24:25], v12 offset:4096
    ds_read_b64_tr_b16 v[26:27], v12 offset:4224
    ds_read_b128 v[88:91], v13 offset:256
    ds_read_b128 v[20:23], v9 offset:32768
    ds_read_b64_tr_b16 v[28:29], v12 offset:4608
    ds_read_b64_tr_b16 v[30:31], v12 offset:4736
    ds_read_b128 v[92:95], v13 offset:288
    s_waitcnt lgkmcnt(4)
    v_mfma_f32_32x32x16_bf16 v[32:47], v[24:27], v[16:19], v[32:47]
    v_mfma_f32_32x32x16_bf16 v[48:63], v[88:91], v[16:19], v[48:63]
    ds_read_b128 v[16:19], v10 offset:32768
    ds_read_b64_tr_b16 v[24:25], v12 offset:5120
    ds_read_b64_tr_b16 v[26:27], v12 offset:5248
    ds_read_b128 v[88:91], v13 offset:320
    s_waitcnt lgkmcnt(4)
    v_mfma_f32_32x32x16_bf16 v[32:47], v[28:31], v[20:23], v[32:47]
    v_mfma_f32_32x32x16_bf16 v[48:63], v[92:95], v[20:23], v[48:63]
    ds_read_b128 v[20:23], v11 offset:32768
    ds_read_b64_tr_b16 v[28:29], v12 offset:5632
    ds_read_b64_tr_b16 v[30:31], v12 offset:5760
    ds_read_b128 v[92:95], v13 offset:352
    s_waitcnt lgkmcnt(4)
    v_mfma_f32_32x32x16_bf16 v[32:47], v[24:27], v[16:19], v[32:47]
    v_mfma_f32_32x32x16_bf16 v[48:63], v[88:91], v[16:19], v[48:63]
    s_waitcnt lgkmcnt(0)
    v_mfma_f32_32x32x16_bf16 v[32:47], v[28:31], v[20:23], v[32:47]
    v_mfma_f32_32x32x16_bf16 v[48:63], v[92:95], v[20:23], v[48:63]
    s_barrier
    ds_read_b128 v[16:19], v8 offset:49152
    ds_read_b64_tr_b16 v[24:25], v12 offset:6144
    ds_read_b64_tr_b16 v[26:27], v12 offset:6272
    ds_read_b128 v[88:91], v13 offset:384
    ds_read_b128 v[20:23], v9 offset:49152
    ds_read_b64_tr_b16 v[28:29], v12 offset:6656
    ds_read_b64_tr_b16 v[30:31], v12 offset:6784
    ds_read_b128 v[92:95], v13 offset:416
    s_waitcnt lgkmcnt(4)
    v_mfma_f32_32x32x16_bf16 v[32:47], v[24:27], v[16:19], v[32:47]
    v_mfma_f32_32x32x16_bf16 v[48:63], v[88:91], v[16:19], v[48:63]
    ds_read_b128 v[16:19], v10 offset:49152
    ds_read_b64_tr_b16 v[24:25], v12 offset:7168
    ds_read_b64_tr_b16 v[26:27], v12 offset:7296
    ds_read_b128 v[88:91], v13 offset:448
    s_waitcnt lgkmcnt(4)
    v_mfma_f32_32x32x16_bf16 v[32:47], v[28:31], v[20:23], v[32:47]
    v_mfma_f32_32x32x16_bf16 v[48:63], v[92:95], v[20:23], v[48:63]
    ds_read_b128 v[20:23], v11 offset:49152
    ds_read_b64_tr_b16 v[28:29], v12 offset:7680
    ds_read_b64_tr_b16 v[30:31], v12 offset:7808
    ds_read_b128 v[92:95], v13 offset:480
    s_waitcnt lgkmcnt(4)
    v_mfma_f32_32x32x16_bf16 v[32:47], v[24:27], v[16:19], v[32:47]
    v_mfma_f32_32x32x16_bf16 v[48:63], v[88:91], v[16:19], v[48:63]
    s_waitcnt lgkmcnt(0)
    v_mfma_f32_32x32x16_bf16 v[32:47], v[28:31], v[20:23], v[32:47]
    v_mfma_f32_32x32x16_bf16 v[48:63], v[92:95], v[20:23], v[48:63]
    s_barrier
    ds_read_b128 v[16:19], v8 offset:0
    ds_read_b64_tr_b16 v[24:25], v12 offset:8192
    ds_read_b64_tr_b16 v[26:27], v12 offset:8320
    ds_read_b128 v[88:91], v13 offset:512
    ds_read_b128 v[20:23], v9 offset:0
    ds_read_b64_tr_b16 v[28:29], v12 offset:8704
    ds_read_b64_tr_b16 v[30:31], v12 offset:8832
    ds_read_b128 v[92:95], v13 offset:544
    s_waitcnt lgkmcnt(4)
    v_mfma_f32_32x32x16_bf16 v[32:47], v[24:27], v[16:19], v[32:47]
    v_mfma_f32_32x32x16_bf16 v[48:63], v[88:91], v[16:19], v[48:63]
    ds_read_b128 v[16:19], v10 offset:0
    ds_read_b64_tr_b16 v[24:25], v12 offset:9216
    ds_read_b64_tr_b16 v[26:27], v12 offset:9344
    ds_read_b128 v[88:91], v13 offset:576
    s_waitcnt lgkmcnt(4)
    v_mfma_f32_32x32x16_bf16 v[32:47], v[28:31], v[20:23], v[32:47]
    v_mfma_f32_32x32x16_bf16 v[48:63], v[92:95], v[20:23], v[48:63]
    ds_read_b128 v[20:23], v11 offset:0
    ds_read_b64_tr_b16 v[28:29], v12 offset:9728
    ds_read_b64_tr_b16 v[30:31], v12 offset:9856
    ds_read_b128 v[92:95], v13 offset:608
    s_waitcnt lgkmcnt(4)
    v_mfma_f32_32x32x16_bf16 v[32:47], v[24:27], v[16:19], v[32:47]
    v_mfma_f32_32x32x16_bf16 v[48:63], v[88:91], v[16:19], v[48:63]
    s_waitcnt lgkmcnt(0)
    v_mfma_f32_32x32x16_bf16 v[32:47], v[28:31], v[20:23], v[32:47]
    v_mfma_f32_32x32x16_bf16 v[48:63], v[92:95], v[20:23], v[48:63]
    s_barrier
    ds_read_b128 v[16:19], v8 offset:16384
    ds_read_b64_tr_b16 v[24:25], v12 offset:10240
    ds_read_b64_tr_b16 v[26:27], v12 offset:10368
    ds_read_b128 v[88:91], v13 offset:640
    ds_read_b128 v[20:23], v9 offset:16384
    ds_read_b64_tr_b16 v[28:29], v12 offset:10752
    ds_read_b64_tr_b16 v[30:31], v12 offset:10880
    ds_read_b128 v[92:95], v13 offset:672
    s_waitcnt lgkmcnt(4)
    v_mfma_f32_32x32x16_bf16 v[32:47], v[24:27], v[16:19], v[32:47]
    v_mfma_f32_32x32x16_bf16 v[48:63], v[88:91], v[16:19], v[48:63]
    ds_read_b128 v[16:19], v10 offset:16384
    ds_read_b64_tr_b16 v[24:25], v12 offset:11264
    ds_read_b64_tr_b16 v[26:27], v12 offset:11392
    ds_read_b128 v[88:91], v13 offset:704
    s_waitcnt lgkmcnt(4)
    v_mfma_f32_32x32x16_bf16 v[32:47], v[28:31], v[20:23], v[32:47]
    v_mfma_f32_32x32x16_bf16 v[48:63], v[92:95], v[20:23], v[48:63]
    ds_read_b128 v[20:23], v11 offset:16384
    ds_read_b64_tr_b16 v[28:29], v12 offset:11776
    ds_read_b64_tr_b16 v[30:31], v12 offset:11904
    ds_read_b128 v[92:95], v13 offset:736
    s_waitcnt lgkmcnt(4)
    v_mfma_f32_32x32x16_bf16 v[32:47], v[24:27], v[16:19], v[32:47]
    v_mfma_f32_32x32x16_bf16 v[48:63], v[88:91], v[16:19], v[48:63]
    s_waitcnt lgkmcnt(0)
    v_mfma_f32_32x32x16_bf16 v[32:47], v[28:31], v[20:23], v[32:47]
    v_mfma_f32_32x32x16_bf16 v[48:63], v[92:95], v[20:23], v[48:63]
    s_barrier
    ds_read_b128 v[16:19], v8 offset:32768
    ds_read_b64_tr_b16 v[24:25], v12 offset:12288
    ds_read_b64_tr_b16 v[26:27], v12 offset:12416
    ds_read_b128 v[88:91], v13 offset:768
    ds_read_b128 v[20:23], v9 offset:32768
    ds_read_b64_tr_b16 v[28:29], v12 offset:12800
    ds_read_b64_tr_b16 v[30:31], v12 offset:12928
    ds_read_b128 v[92:95], v13 offset:800
    s_waitcnt lgkmcnt(4)
    v_mfma_f32_32x32x16_bf16 v[32:47], v[24:27], v[16:19], v[32:47]
    v_mfma_f32_32x32x16_bf16 v[48:63], v[88:91], v[16:19], v[48:63]
    ds_read_b128 v[16:19], v10 offset:32768
    ds_read_b64_tr_b16 v[24:25], v12 offset:13312
    ds_read_b64_tr_b16 v[26:27], v12 offset:13440
    ds_read_b128 v[88:91], v13 offset:832
    s_waitcnt lgkmcnt(4)
    v_mfma_f32_32x32x16_bf16 v[32:47], v[28:31], v[20:23], v[32:47]
    v_mfma_f32_32x32x16_bf16 v[48:63], v[92:95], v[20:23], v[48:63]
    ds_read_b128 v[20:23], v11 offset:32768
    ds_read_b64_tr_b16 v[28:29], v12 offset:13824
    ds_read_b64_tr_b16 v[30:31], v12 offset:13952
    ds_read_b128 v[92:95], v13 offset:864
    s_waitcnt lgkmcnt(4)
    v_mfma_f32_32x32x16_bf16 v[32:47], v[24:27], v[16:19], v[32:47]
    v_mfma_f32_32x32x16_bf16 v[48:63], v[88:91], v[16:19], v[48:63]
    s_waitcnt lgkmcnt(0)
    v_mfma_f32_32x32x16_bf16 v[32:47], v[28:31], v[20:23], v[32:47]
    v_mfma_f32_32x32x16_bf16 v[48:63], v[92:95], v[20:23], v[48:63]
    s_barrier
    ds_read_b128 v[16:19], v8 offset:49152
    ds_read_b64_tr_b16 v[24:25], v12 offset:14336
    ds_read_b64_tr_b16 v[26:27], v12 offset:14464
    ds_read_b128 v[88:91], v13 offset:896
    ds_read_b128 v[20:23], v9 offset:49152
    ds_read_b64_tr_b16 v[28:29], v12 offset:14848
    ds_read_b64_tr_b16 v[30:31], v12 offset:14976
    ds_read_b128 v[92:95], v13 offset:928
    s_waitcnt lgkmcnt(4)
    v_mfma_f32_32x32x16_bf16 v[32:47], v[24:27], v[16:19], v[32:47]
    v_mfma_f32_32x32x16_bf16 v[48:63], v[88:91], v[16:19], v[48:63]
    ds_read_b128 v[16:19], v10 offset:49152
    ds_read_b64_tr_b16 v[24:25], v12 offset:15360
    ds_read_b64_tr_b16 v[26:27], v12 offset:15488
    ds_read_b128 v[88:91], v13 offset:960
    s_waitcnt lgkmcnt(4)
    v_mfma_f32_32x32x16_bf16 v[32:47], v[28:31], v[20:23], v[32:47]
    v_mfma_f32_32x32x16_bf16 v[48:63], v[92:95], v[20:23], v[48:63]
    ds_read_b128 v[20:23], v11 offset:49152
    ds_read_b64_tr_b16 v[28:29], v12 offset:15872
    ds_read_b64_tr_b16 v[30:31], v12 offset:16000
    ds_read_b128 v[92:95], v13 offset:992
    s_waitcnt lgkmcnt(4)
    v_mfma_f32_32x32x16_bf16 v[32:47], v[24:27], v[16:19], v[32:47]
    v_mfma_f32_32x32x16_bf16 v[48:63], v[88:91], v[16:19], v[48:63]
    s_waitcnt lgkmcnt(0)
    v_mfma_f32_32x32x16_bf16 v[32:47], v[28:31], v[20:23], v[32:47]
    v_mfma_f32_32x32x16_bf16 v[48:63], v[92:95], v[20:23], v[48:63]
    s_nop 15
    v_mul_f32 v32, 0x3eb8aa3b, v32
    v_mul_f32 v33, 0x3eb8aa3b, v33
    v_mul_f32 v34, 0x3eb8aa3b, v34
    v_mul_f32 v35, 0x3eb8aa3b, v35
    v_mul_f32 v36, 0x3eb8aa3b, v36
    v_mul_f32 v37, 0x3eb8aa3b, v37
    v_mul_f32 v38, 0x3eb8aa3b, v38
    v_mul_f32 v39, 0x3eb8aa3b, v39
    v_cvt_pk_bf16_f32 v80, v32, v33
    v_cvt_pk_bf16_f32 v81, v34, v35
    v_cvt_pk_bf16_f32 v82, v36, v37
    v_cvt_pk_bf16_f32 v83, v38, v39
    v_and_b32 v6, 0x33, v0
    v_bfe_u32 v7, v0, 2, 1
    v_lshl_or_b32 v6, v7, 3, v6
    v_bfe_u32 v7, v0, 3, 1
    v_lshl_or_b32 v6, v7, 2, v6
    v_lshlrev_b32 v6, 4, v6
    s_lshl_b32 s66, s87, 10
    s_add_u32 s66, s66, 65536
    buffer_store_dwordx4 v[80:83], v6, s[48:51], s66 offen sc1
    v_mul_f32 v20, 0xbfb8aa3b, v48
    v_exp_f32 v20, v20
    v_and_b32 v21, 31, v0
    v_add_f32 v20, 1.0, v20
    v_rcp_f32 v20, v20
    v_lshlrev_b32 v21, 2, v21
    s_lshl_b32 s66, s87, 7
    s_add_u32 s66, s66, 196608
    buffer_store_dword v20, v21, s[48:51], s66 offen sc1
    v_mul_f32 v5, v32, v32
    v_fmac_f32 v5, v33, v33
    v_fmac_f32 v5, v34, v34
    v_fmac_f32 v5, v35, v35
    v_fmac_f32 v5, v36, v36
    v_fmac_f32 v5, v37, v37
    v_fmac_f32 v5, v38, v38
    v_fmac_f32 v5, v39, v39
    v_mov_b32 v67, v5
    s_nop 1
    v_permlane32_swap_b32 v5, v67
    v_add_f32 v67, v5, v67
    s_nop 1
    v_max_u32_dpp v67, v67, v67 row_shr:1
    s_nop 1
    v_max_u32_dpp v67, v67, v67 row_shr:2
    s_nop 1
    v_max_u32_dpp v67, v67, v67 row_shr:4
    s_nop 1
    v_max_u32_dpp v67, v67, v67 row_shr:8
    s_nop 1
    v_max_u32_dpp v67, v67, v67 row_bcast:15 row_mask:0xa
    s_nop 1
    v_max_u32_dpp v67, v67, v67 row_bcast:31 row_mask:0xc
    s_mov_b32 s67, 262144
    s_branch L_Fpub_30
L_FV_29:
    s_barrier
    ds_read_b128 v[16:19], v8 offset:0
    ds_read_b64_tr_b16 v[24:25], v12 offset:0
    ds_read_b64_tr_b16 v[26:27], v12 offset:128
    ds_read_b128 v[20:23], v9 offset:0
    ds_read_b64_tr_b16 v[28:29], v12 offset:512
    ds_read_b64_tr_b16 v[30:31], v12 offset:640
    s_waitcnt lgkmcnt(3)
    v_mfma_f32_32x32x16_bf16 v[32:47], v[16:19], v[24:27], 0
    ds_read_b128 v[16:19], v10 offset:0
    ds_read_b64_tr_b16 v[24:25], v12 offset:1024
    ds_read_b64_tr_b16 v[26:27], v12 offset:1152
    s_waitcnt lgkmcnt(3)
    v_mfma_f32_32x32x16_bf16 v[32:47], v[20:23], v[28:31], v[32:47]
    ds_read_b128 v[20:23], v11 offset:0
    ds_read_b64_tr_b16 v[28:29], v12 offset:1536
    ds_read_b64_tr_b16 v[30:31], v12 offset:1664
    s_waitcnt lgkmcnt(3)
    v_mfma_f32_32x32x16_bf16 v[32:47], v[16:19], v[24:27], v[32:47]
    s_waitcnt lgkmcnt(0)
    v_mfma_f32_32x32x16_bf16 v[32:47], v[20:23], v[28:31], v[32:47]
    s_barrier
    ds_read_b128 v[16:19], v8 offset:16384
    ds_read_b64_tr_b16 v[24:25], v12 offset:2048
    ds_read_b64_tr_b16 v[26:27], v12 offset:2176
    ds_read_b128 v[20:23], v9 offset:16384
    ds_read_b64_tr_b16 v[28:29], v12 offset:2560
    ds_read_b64_tr_b16 v[30:31], v12 offset:2688
    s_waitcnt lgkmcnt(3)
    v_mfma_f32_32x32x16_bf16 v[32:47], v[16:19], v[24:27], v[32:47]
    ds_read_b128 v[16:19], v10 offset:16384
    ds_read_b64_tr_b16 v[24:25], v12 offset:3072
    ds_read_b64_tr_b16 v[26:27], v12 offset:3200
    s_waitcnt lgkmcnt(3)
    v_mfma_f32_32x32x16_bf16 v[32:47], v[20:23], v[28:31], v[32:47]
    ds_read_b128 v[20:23], v11 offset:16384
    ds_read_b64_tr_b16 v[28:29], v12 offset:3584
    ds_read_b64_tr_b16 v[30:31], v12 offset:3712
    s_waitcnt lgkmcnt(3)
    v_mfma_f32_32x32x16_bf16 v[32:47], v[16:19], v[24:27], v[32:47]
    s_waitcnt lgkmcnt(0)
    v_mfma_f32_32x32x16_bf16 v[32:47], v[20:23], v[28:31], v[32:47]
    s_barrier
    ds_read_b128 v[16:19], v8 offset:32768
    ds_read_b64_tr_b16 v[24:25], v12 offset:4096
    ds_read_b64_tr_b16 v[26:27], v12 offset:4224
    ds_read_b128 v[20:23], v9 offset:32768
    ds_read_b64_tr_b16 v[28:29], v12 offset:4608
    ds_read_b64_tr_b16 v[30:31], v12 offset:4736
    s_waitcnt lgkmcnt(3)
    v_mfma_f32_32x32x16_bf16 v[32:47], v[16:19], v[24:27], v[32:47]
    ds_read_b128 v[16:19], v10 offset:32768
    ds_read_b64_tr_b16 v[24:25], v12 offset:5120
    ds_read_b64_tr_b16 v[26:27], v12 offset:5248
    s_waitcnt lgkmcnt(3)
    v_mfma_f32_32x32x16_bf16 v[32:47], v[20:23], v[28:31], v[32:47]
    ds_read_b128 v[20:23], v11 offset:32768
    ds_read_b64_tr_b16 v[28:29], v12 offset:5632
    ds_read_b64_tr_b16 v[30:31], v12 offset:5760
    s_waitcnt lgkmcnt(3)
    v_mfma_f32_32x32x16_bf16 v[32:47], v[16:19], v[24:27], v[32:47]
    s_waitcnt lgkmcnt(0)
    v_mfma_f32_32x32x16_bf16 v[32:47], v[20:23], v[28:31], v[32:47]
    s_barrier
    ds_read_b128 v[16:19], v8 offset:49152
    ds_read_b64_tr_b16 v[24:25], v12 offset:6144
    ds_read_b64_tr_b16 v[26:27], v12 offset:6272
    ds_read_b128 v[20:23], v9 offset:49152
    ds_read_b64_tr_b16 v[28:29], v12 offset:6656
    ds_read_b64_tr_b16 v[30:31], v12 offset:6784
    s_waitcnt lgkmcnt(3)
    v_mfma_f32_32x32x16_bf16 v[32:47], v[16:19], v[24:27], v[32:47]
    ds_read_b128 v[16:19], v10 offset:49152
    ds_read_b64_tr_b16 v[24:25], v12 offset:7168
    ds_read_b64_tr_b16 v[26:27], v12 offset:7296
    s_waitcnt lgkmcnt(3)
    v_mfma_f32_32x32x16_bf16 v[32:47], v[20:23], v[28:31], v[32:47]
    ds_read_b128 v[20:23], v11 offset:49152
    ds_read_b64_tr_b16 v[28:29], v12 offset:7680
    ds_read_b64_tr_b16 v[30:31], v12 offset:7808
    s_waitcnt lgkmcnt(3)
    v_mfma_f32_32x32x16_bf16 v[32:47], v[16:19], v[24:27], v[32:47]
    s_waitcnt lgkmcnt(0)
    v_mfma_f32_32x32x16_bf16 v[32:47], v[20:23], v[28:31], v[32:47]
    s_barrier
    ds_read_b128 v[16:19], v8 offset:0
    ds_read_b64_tr_b16 v[24:25], v12 offset:8192
    ds_read_b64_tr_b16 v[26:27], v12 offset:8320
    ds_read_b128 v[20:23], v9 offset:0
    ds_read_b64_tr_b16 v[28:29], v12 offset:8704
    ds_read_b64_tr_b16 v[30:31], v12 offset:8832
    s_waitcnt lgkmcnt(3)
    v_mfma_f32_32x32x16_bf16 v[32:47], v[16:19], v[24:27], v[32:47]
    ds_read_b128 v[16:19], v10 offset:0
    ds_read_b64_tr_b16 v[24:25], v12 offset:9216
    ds_read_b64_tr_b16 v[26:27], v12 offset:9344
    s_waitcnt lgkmcnt(3)
    v_mfma_f32_32x32x16_bf16 v[32:47], v[20:23], v[28:31], v[32:47]
    ds_read_b128 v[20:23], v11 offset:0
    ds_read_b64_tr_b16 v[28:29], v12 offset:9728
    ds_read_b64_tr_b16 v[30:31], v12 offset:9856
    s_waitcnt lgkmcnt(3)
    v_mfma_f32_32x32x16_bf16 v[32:47], v[16:19], v[24:27], v[32:47]
    s_waitcnt lgkmcnt(0)
    v_mfma_f32_32x32x16_bf16 v[32:47], v[20:23], v[28:31], v[32:47]
    s_barrier
    ds_read_b128 v[16:19], v8 offset:16384
    ds_read_b64_tr_b16 v[24:25], v12 offset:10240
    ds_read_b64_tr_b16 v[26:27], v12 offset:10368
    ds_read_b128 v[20:23], v9 offset:16384
    ds_read_b64_tr_b16 v[28:29], v12 offset:10752
    ds_read_b64_tr_b16 v[30:31], v12 offset:10880
    s_waitcnt lgkmcnt(3)
    v_mfma_f32_32x32x16_bf16 v[32:47], v[16:19], v[24:27], v[32:47]
    ds_read_b128 v[16:19], v10 offset:16384
    ds_read_b64_tr_b16 v[24:25], v12 offset:11264
    ds_read_b64_tr_b16 v[26:27], v12 offset:11392
    s_waitcnt lgkmcnt(3)
    v_mfma_f32_32x32x16_bf16 v[32:47], v[20:23], v[28:31], v[32:47]
    ds_read_b128 v[20:23], v11 offset:16384
    ds_read_b64_tr_b16 v[28:29], v12 offset:11776
    ds_read_b64_tr_b16 v[30:31], v12 offset:11904
    s_waitcnt lgkmcnt(3)
    v_mfma_f32_32x32x16_bf16 v[32:47], v[16:19], v[24:27], v[32:47]
    s_waitcnt lgkmcnt(0)
    v_mfma_f32_32x32x16_bf16 v[32:47], v[20:23], v[28:31], v[32:47]
    s_barrier
    ds_read_b128 v[16:19], v8 offset:32768
    ds_read_b64_tr_b16 v[24:25], v12 offset:12288
    ds_read_b64_tr_b16 v[26:27], v12 offset:12416
    ds_read_b128 v[20:23], v9 offset:32768
    ds_read_b64_tr_b16 v[28:29], v12 offset:12800
    ds_read_b64_tr_b16 v[30:31], v12 offset:12928
    s_waitcnt lgkmcnt(3)
    v_mfma_f32_32x32x16_bf16 v[32:47], v[16:19], v[24:27], v[32:47]
    ds_read_b128 v[16:19], v10 offset:32768
    ds_read_b64_tr_b16 v[24:25], v12 offset:13312
    ds_read_b64_tr_b16 v[26:27], v12 offset:13440
    s_waitcnt lgkmcnt(3)
    v_mfma_f32_32x32x16_bf16 v[32:47], v[20:23], v[28:31], v[32:47]
    ds_read_b128 v[20:23], v11 offset:32768
    ds_read_b64_tr_b16 v[28:29], v12 offset:13824
    ds_read_b64_tr_b16 v[30:31], v12 offset:13952
    s_waitcnt lgkmcnt(3)
    v_mfma_f32_32x32x16_bf16 v[32:47], v[16:19], v[24:27], v[32:47]
    s_waitcnt lgkmcnt(0)
    v_mfma_f32_32x32x16_bf16 v[32:47], v[20:23], v[28:31], v[32:47]
    s_barrier
    ds_read_b128 v[16:19], v8 offset:49152
    ds_read_b64_tr_b16 v[24:25], v12 offset:14336
    ds_read_b64_tr_b16 v[26:27], v12 offset:14464
    ds_read_b128 v[20:23], v9 offset:49152
    ds_read_b64_tr_b16 v[28:29], v12 offset:14848
    ds_read_b64_tr_b16 v[30:31], v12 offset:14976
    s_waitcnt lgkmcnt(3)
    v_mfma_f32_32x32x16_bf16 v[32:47], v[16:19], v[24:27], v[32:47]
    ds_read_b128 v[16:19], v10 offset:49152
    ds_read_b64_tr_b16 v[24:25], v12 offset:15360
    ds_read_b64_tr_b16 v[26:27], v12 offset:15488
    s_waitcnt lgkmcnt(3)
    v_mfma_f32_32x32x16_bf16 v[32:47], v[20:23], v[28:31], v[32:47]
    ds_read_b128 v[20:23], v11 offset:49152
    ds_read_b64_tr_b16 v[28:29], v12 offset:15872
    ds_read_b64_tr_b16 v[30:31], v12 offset:16000
    s_waitcnt lgkmcnt(3)
    v_mfma_f32_32x32x16_bf16 v[32:47], v[16:19], v[24:27], v[32:47]
    s_waitcnt lgkmcnt(0)
    v_mfma_f32_32x32x16_bf16 v[32:47], v[20:23], v[28:31], v[32:47]
    s_nop 15
    v_cvt_pk_bf16_f32 v80, v32, v33
    v_cvt_pk_bf16_f32 v81, v34, v35
    v_cvt_pk_bf16_f32 v82, v36, v37
    v_cvt_pk_bf16_f32 v83, v38, v39
    v_cvt_pk_bf16_f32 v84, v40, v41
    v_cvt_pk_bf16_f32 v85, v42, v43
    v_cvt_pk_bf16_f32 v86, v44, v45
    v_cvt_pk_bf16_f32 v87, v46, v47
    v_and_b32 v6, 16, v0
    v_cmp_ne_u32 vcc, 0, v6
    s_lshl_b32 s66, s87, 10
    s_add_u32 s66, s66, 131072
    v_cndmask_b32 v80, v80, v84, vcc
    v_cndmask_b32 v81, v81, v85, vcc
    v_cndmask_b32 v82, v82, v86, vcc
    v_cndmask_b32 v83, v83, v87, vcc
    buffer_store_dwordx4 v[80:83], v4, s[48:51], s66 offen sc1
    v_max3_f32 v67, abs(v32), abs(v33), abs(v34)
    v_max3_f32 v67, v67, abs(v35), abs(v36)
    v_max3_f32 v67, v67, abs(v37), abs(v38)
    v_max3_f32 v67, v67, abs(v39), abs(v40)
    v_max3_f32 v67, v67, abs(v41), abs(v42)
    v_max3_f32 v67, v67, abs(v43), abs(v44)
    v_max3_f32 v67, v67, abs(v45), abs(v46)
    v_max3_f32 v67, v67, abs(v47), abs(v47)
    s_nop 1
    v_max_u32_dpp v67, v67, v67 row_shr:1
    s_nop 1
    v_max_u32_dpp v67, v67, v67 row_shr:2
    s_nop 1
    v_max_u32_dpp v67, v67, v67 row_shr:4
    s_nop 1
    v_max_u32_dpp v67, v67, v67 row_shr:8
    s_nop 1
    v_max_u32_dpp v67, v67, v67 row_bcast:15 row_mask:0xa
    s_nop 1
    v_max_u32_dpp v67, v67, v67 row_bcast:31 row_mask:0xc
    s_mov_b32 s67, 262656
L_Fpub_30:
    s_lshl_b32 s66, s87, 3
    s_add_u32 s67, s67, s66
    v_mov_b32 v66, s65
    s_mov_b32 exec_lo, 0
    s_mov_b32 exec_hi, 0x80000000
    s_waitcnt vmcnt(0)
    buffer_store_dwordx2 v[66:67], v65, s[48:51], s67 offen sc1
    s_mov_b64 exec, 1
    v_mov_b32 v6, 160844
    v_mov_b32 v7, 1
    ds_add_u32 v6, v7
    s_mov_b64 exec, -1
    s_barrier
    s_cmp_lg_u32 s80, 224
    s_cbranch_scc1 L_noepoch_31
    s_cmp_lg_u32 s64, 1
    s_cbranch_scc1 L_noepoch_31
    v_lshlrev_b32 v2, 4, v0
    s_mov_b32 s72, 24576
    s_mov_b32 s73, 28672
    s_mov_b32 s76, 0x40000
L_poll_32:
    buffer_load_dwordx4 v[16:19], v2, s[48:51], s72 offen offset:0 sc1
    buffer_load_dwordx4 v[20:23], v2, s[48:51], s72 offen offset:1024 sc1
    buffer_load_dwordx4 v[24:27], v2, s[48:51], s72 offen offset:2048 sc1
    buffer_load_dwordx4 v[28:31], v2, s[48:51], s72 offen offset:3072 sc1
    buffer_load_dwordx4 v[32:35], v2, s[48:51], s73 offen offset:0 sc1
    buffer_load_dwordx4 v[36:39], v2, s[48:51], s73 offen offset:1024 sc1
    buffer_load_dwordx4 v[40:43], v2, s[48:51], s73 offen offset:2048 sc1
    buffer_load_dwordx4 v[44:47], v2, s[48:51], s73 offen offset:3072 sc1
    s_waitcnt vmcnt(0)
    v_cmp_ne_u32 vcc, s65, v16
    v_cmp_ne_u32 s[78:79], s65, v17
    s_or_b64 vcc, vcc, s[78:79]
    v_cmp_ne_u32 s[78:79], s65, v18
    s_or_b64 vcc, vcc, s[78:79]
    v_cmp_ne_u32 s[78:79], s65, v19
    s_or_b64 vcc, vcc, s[78:79]
    v_cmp_ne_u32 s[78:79], s65, v20
    s_or_b64 vcc, vcc, s[78:79]
    v_cmp_ne_u32 s[78:79], s65, v21
    s_or_b64 vcc, vcc, s[78:79]
    v_cmp_ne_u32 s[78:79], s65, v22
    s_or_b64 vcc, vcc, s[78:79]
    v_cmp_ne_u32 s[78:79], s65, v23
    s_or_b64 vcc, vcc, s[78:79]
    v_cmp_ne_u32 s[78:79], s65, v24
    s_or_b64 vcc, vcc, s[78:79]
    v_cmp_ne_u32 s[78:79], s65, v25
    s_or_b64 vcc, vcc, s[78:79]
    v_cmp_ne_u32 s[78:79], s65, v26
    s_or_b64 vcc, vcc, s[78:79]
    v_cmp_ne_u32 s[78:79], s65, v27
    s_or_b64 vcc, vcc, s[78:79]
    v_cmp_ne_u32 s[78:79], s65, v28
    s_or_b64 vcc, vcc, s[78:79]
    v_cmp_ne_u32 s[78:79], s65, v29
    s_or_b64 vcc, vcc, s[78:79]
    v_cmp_ne_u32 s[78:79], s65, v30
    s_or_b64 vcc, vcc, s[78:79]
    v_cmp_ne_u32 s[78:79], s65, v31
    s_or_b64 vcc, vcc, s[78:79]
    v_cmp_ne_u32 s[78:79], s65, v32
    s_or_b64 vcc, vcc, s[78:79]
    v_cmp_ne_u32 s[78:79], s65, v33
    s_or_b64 vcc, vcc, s[78:79]
    v_cmp_ne_u32 s[78:79], s65, v34
    s_or_b64 vcc, vcc, s[78:79]
    v_cmp_ne_u32 s[78:79], s65, v35
    s_or_b64 vcc, vcc, s[78:79]
    v_cmp_ne_u32 s[78:79], s65, v36
    s_or_b64 vcc, vcc, s[78:79]
    v_cmp_ne_u32 s[78:79], s65, v37
    s_or_b64 vcc, vcc, s[78:79]
    v_cmp_ne_u32 s[78:79], s65, v38
    s_or_b64 vcc, vcc, s[78:79]
    v_cmp_ne_u32 s[78:79], s65, v39
    s_or_b64 vcc, vcc, s[78:79]
    v_cmp_ne_u32 s[78:79], s65, v40
    s_or_b64 vcc, vcc, s[78:79]
    v_cmp_ne_u32 s[78:79], s65, v41
    s_or_b64 vcc, vcc, s[78:79]
    v_cmp_ne_u32 s[78:79], s65, v42
    s_or_b64 vcc, vcc, s[78:79]
    v_cmp_ne_u32 s[78:79], s65, v43
    s_or_b64 vcc, vcc, s[78:79]
    v_cmp_ne_u32 s[78:79], s65, v44
    s_or_b64 vcc, vcc, s[78:79]
    v_cmp_ne_u32 s[78:79], s65, v45
    s_or_b64 vcc, vcc, s[78:79]
    v_cmp_ne_u32 s[78:79], s65, v46
    s_or_b64 vcc, vcc, s[78:79]
    v_cmp_ne_u32 s[78:79], s65, v47
    s_or_b64 vcc, vcc, s[78:79]
    s_cbranch_vccz L_polled_33
    s_sleep 64
    s_sub_u32 s76, s76, 1
    s_cmp_lg_u32 s76, 0
    s_cbranch_scc1 L_poll_32
L_polled_33:
    s_mov_b64 exec, 1
    buffer_store_dword v64, v65, s[48:51], 0 offen offset:0 sc1
    s_mov_b64 exec, -1
L_noepoch_31:
L_s1end_24:
    s_and_b32 s66, s80, 1
    s_lshl_b32 s66, s66, 4
    s_and_b32 s67, s80, 2
    s_lshl_b32 s67, s67, 2
    s_add_u32 s66, s66, s67
    s_bfe_u32 s67, s80, 0x30003
    s_add_u32 s82, s66, s67
    s_and_b32 s66, s80, 4
    s_lshr_b32 s67, s80, 6
    s_add_u32 s83, s66, s67
    s_mov_b32 s52, s32
    s_mov_b32 s53, s33
    s_mov_b32 s54, 0x1c0000
    s_mov_b32 s55, 0x20000
    s_mov_b32 s56, s24
    s_mov_b32 s57, s25
    s_mov_b32 s58, 0x80000
    s_mov_b32 s59, 0x20000
    s_mov_b32 s60, s36
    s_mov_b32 s61, s37
    s_mov_b32 s62, 0x200000
    s_mov_b32 s63, 0x20000
    v_lshrrev_b32 v8, 3, v0
    v_and_b32 v9, 7, v0
    v_bfe_u32 v10, v0, 4, 1
    v_lshlrev_b32 v10, 2, v10
    v_xor_b32 v2, v10, v9
    v_lshlrev_b32 v2, 4, v2
    v_lshl_add_u32 v2, v8, 10, v2
    v_lshlrev_b32 v3, 4, v0
    v_lshrrev_b32 v9, 5, v0
    v_bfe_u32 v8, v0, 2, 2
    v_lshl_add_u32 v8, v9, 2, v8
    v_and_b32 v10, 3, v0
    v_lshlrev_b32 v10, 3, v10
    v_lshl_add_u32 v4, v8, 7, v10
    v_bfe_u32 v8, v0, 4, 1
    v_bfe_u32 v10, v0, 3, 1
    v_lshl_or_b32 v8, v10, 1, v8
    v_xor_b32 v10, 2, v8
    v_lshl_add_u32 v5, v10, 5, v4
    v_lshl_add_u32 v4, v8, 5, v4
    s_mul_i32 s81, s64, 20480
    v_add_u32 v4, s81, v4
    v_add_u32 v5, s81, v5
    v_lshlrev_b32 v9, 9, v9
    v_add_u32 v14, v4, v9
    v_add_u32 v15, v5, v9
    s_lshl_b32 s66, s83, 7
    s_lshl_b32 s84, s64, 14
    s_add_u32 s84, s84, s66
    s_mul_i32 s85, s82, 229376
    s_lshl_b32 s66, s64, 10
    s_add_u32 s85, s85, s66
    s_add_u32 s85, s85, 5242880
    s_add_u32 s86, s85, 114688
    s_lshl_b32 s66, s83, 1
    s_add_u32 s66, s66, s82
    s_and_b32 s66, s66, 7
    s_mul_i32 s66, s66, 7
    s_lshr_b32 s66, s66, 1
    s_lshl_b32 s92, s66, 16
    s_lshl_b32 s93, s66, 12
    s_lshl_b32 s88, s64, 17
    s_lshl_b32 s66, s83, 7
    s_add_u32 s88, s88, s66
    s_add_u32 s67, s84, s92
    s_add_u32 m0, s81, 0
    s_add_u32 s66, s67, 0
    buffer_load_dwordx4 v2, s[52:55], s66 offen lds
    s_add_u32 m0, s81, 1024
    s_add_u32 s66, s67, 8192
    buffer_load_dwordx4 v2, s[52:55], s66 offen lds
    s_add_u32 s92, s92, 65536
    s_cmp_eq_u32 s92, 1835008
    s_cselect_b32 s92, 0, s92
    s_add_u32 s67, s84, s92
    s_add_u32 m0, s81, 2048
    s_add_u32 s66, s67, 0
    buffer_load_dwordx4 v2, s[52:55], s66 offen lds
    s_add_u32 m0, s81, 3072
    s_add_u32 s66, s67, 8192
    buffer_load_dwordx4 v2, s[52:55], s66 offen lds
    s_add_u32 s92, s92, 65536
    s_cmp_eq_u32 s92, 1835008
    s_cselect_b32 s92, 0, s92
    s_cmp_lg_u32 s64, 0
    s_cbranch_scc1 L_nopoll_34
    s_lshr_b32 s70, s82, 1
    s_lshl_b32 s70, s70, 11
    s_add_u32 s70, s70, 524288
    s_lshl_b32 s71, s82, 4
    s_add_u32 s71, s71, 262144
    v_lshlrev_b32 v11, 7, v0
    v_add_u32 v11, s70, v11
    v_and_b32 v12, 1, v0
    v_lshlrev_b32 v12, 3, v12
    v_add_u32 v12, s71, v12
    v_and_b32 v13, 32, v0
    v_lshl_add_u32 v12, v13, 4, v12
    v_cmp_gt_u32 vcc, 14, v0
    s_nop 1
    v_cndmask_b32 v11, v12, v11, vcc
    s_mov_b32 s76, 0x40000
L_poll_35:
    buffer_load_dword v13, v11, s[48:51], 0 offen sc1
    s_waitcnt vmcnt(0)
    v_cmp_ne_u32 vcc, s65, v13
    s_cbranch_vccz L_polled_36
    s_mov_b64 exec, vcc
    s_sleep 12
    s_sub_u32 s76, s76, 1
    s_cmp_lg_u32 s76, 0
    s_cbranch_scc1 L_poll_35
L_polled_36:
    s_mov_b64 exec, -1
L_nopoll_34:
    s_waitcnt vmcnt(0)
    v_mov_b32 v11, 160848
    v_mov_b32 v12, 1
    s_mov_b64 exec, 1
    ds_add_u32 v11, v12
    s_mov_b64 exec, -1
L_ls_37:
    ds_read_b32 v12, v11
    s_waitcnt lgkmcnt(0)
    v_readfirstlane_b32 s76, v12
    s_cmp_lt_u32 s76, 4
    s_cbranch_scc1 L_ls_37
    s_setprio 0
    s_add_u32 s66, s85, s93
    s_add_u32 s67, s86, s93
    s_add_u32 s93, s93, 4096
    s_cmp_eq_u32 s93, 114688
    s_cselect_b32 s93, 0, s93
    buffer_load_dwordx4 v[128:131], v3, s[48:51], s66 offen sc1
    buffer_load_dwordx4 v[132:135], v3, s[48:51], s67 offen sc1
    s_add_u32 s66, s85, s93
    s_add_u32 s67, s86, s93
    s_add_u32 s93, s93, 4096
    s_cmp_eq_u32 s93, 114688
    s_cselect_b32 s93, 0, s93
    buffer_load_dwordx4 v[136:139], v3, s[48:51], s66 offen sc1
    buffer_load_dwordx4 v[140:143], v3, s[48:51], s67 offen sc1
    s_add_u32 s67, s84, s92
    s_add_u32 m0, s81, 4096
    s_add_u32 s66, s67, 0
    buffer_load_dwordx4 v2, s[52:55], s66 offen lds
    s_add_u32 m0, s81, 5120
    s_add_u32 s66, s67, 8192
    buffer_load_dwordx4 v2, s[52:55], s66 offen lds
    s_add_u32 s92, s92, 65536
    s_cmp_eq_u32 s92, 1835008
    s_cselect_b32 s92, 0, s92
    s_add_u32 s66, s85, s93
    s_add_u32 s67, s86, s93
    s_add_u32 s93, s93, 4096
    s_cmp_eq_u32 s93, 114688
    s_cselect_b32 s93, 0, s93
    buffer_load_dwordx4 v[144:147], v3, s[48:51], s66 offen sc1
    buffer_load_dwordx4 v[148:151], v3, s[48:51], s67 offen sc1
    s_add_u32 s67, s84, s92
    s_add_u32 m0, s81, 6144
    s_add_u32 s66, s67, 0
    buffer_load_dwordx4 v2, s[52:55], s66 offen lds
    s_add_u32 m0, s81, 7168
    s_add_u32 s66, s67, 8192
    buffer_load_dwordx4 v2, s[52:55], s66 offen lds
    s_add_u32 s92, s92, 65536
    s_cmp_eq_u32 s92, 1835008
    s_cselect_b32 s92, 0, s92
    s_add_u32 s66, s85, s93
    s_add_u32 s67, s86, s93
    s_add_u32 s93, s93, 4096
    s_cmp_eq_u32 s93, 114688
    s_cselect_b32 s93, 0, s93
    buffer_load_dwordx4 v[152:155], v3, s[48:51], s66 offen sc1
    buffer_load_dwordx4 v[156:159], v3, s[48:51], s67 offen sc1
    s_add_u32 s67, s84, s92
    s_add_u32 m0, s81, 8192
    s_add_u32 s66, s67, 0
    buffer_load_dwordx4 v2, s[52:55], s66 offen lds
    s_add_u32 m0, s81, 9216
    s_add_u32 s66, s67, 8192
    buffer_load_dwordx4 v2, s[52:55], s66 offen lds
    s_add_u32 s92, s92, 65536
    s_cmp_eq_u32 s92, 1835008
    s_cselect_b32 s92, 0, s92
    s_add_u32 s66, s85, s93
    s_add_u32 s67, s86, s93
    s_add_u32 s93, s93, 4096
    s_cmp_eq_u32 s93, 114688
    s_cselect_b32 s93, 0, s93
    buffer_load_dwordx4 v[160:163], v3, s[48:51], s66 offen sc1
    buffer_load_dwordx4 v[164:167], v3, s[48:51], s67 offen sc1
    s_add_u32 s67, s84, s92
    s_add_u32 m0, s81, 10240
    s_add_u32 s66, s67, 0
    buffer_load_dwordx4 v2, s[52:55], s66 offen lds
    s_add_u32 m0, s81, 11264
    s_add_u32 s66, s67, 8192
    buffer_load_dwordx4 v2, s[52:55], s66 offen lds
    s_add_u32 s92, s92, 65536
    s_cmp_eq_u32 s92, 1835008
    s_cselect_b32 s92, 0, s92
    s_add_u32 s66, s85, s93
    s_add_u32 s67, s86, s93
    s_add_u32 s93, s93, 4096
    s_cmp_eq_u32 s93, 114688
    s_cselect_b32 s93, 0, s93
    buffer_load_dwordx4 v[168:171], v3, s[48:51], s66 offen sc1
    buffer_load_dwordx4 v[172:175], v3, s[48:51], s67 offen sc1
    s_add_u32 s67, s84, s92
    s_add_u32 m0, s81, 12288
    s_add_u32 s66, s67, 0
    buffer_load_dwordx4 v2, s[52:55], s66 offen lds
    s_add_u32 m0, s81, 13312
    s_add_u32 s66, s67, 8192
    buffer_load_dwordx4 v2, s[52:55], s66 offen lds
    s_add_u32 s92, s92, 65536
    s_cmp_eq_u32 s92, 1835008
    s_cselect_b32 s92, 0, s92
    s_add_u32 s66, s85, s93
    s_add_u32 s67, s86, s93
    s_add_u32 s93, s93, 4096
    s_cmp_eq_u32 s93, 114688
    s_cselect_b32 s93, 0, s93
    buffer_load_dwordx4 v[176:179], v3, s[48:51], s66 offen sc1
    buffer_load_dwordx4 v[180:183], v3, s[48:51], s67 offen sc1
    s_add_u32 s67, s84, s92
    s_add_u32 m0, s81, 14336
    s_add_u32 s66, s67, 0
    buffer_load_dwordx4 v2, s[52:55], s66 offen lds
    s_add_u32 m0, s81, 15360
    s_add_u32 s66, s67, 8192
    buffer_load_dwordx4 v2, s[52:55], s66 offen lds
    s_add_u32 s92, s92, 65536
    s_cmp_eq_u32 s92, 1835008
    s_cselect_b32 s92, 0, s92
    s_add_u32 s66, s85, s93
    s_add_u32 s67, s86, s93
    s_add_u32 s93, s93, 4096
    s_cmp_eq_u32 s93, 114688
    s_cselect_b32 s93, 0, s93
    buffer_load_dwordx4 v[184:187], v3, s[48:51], s66 offen sc1
    buffer_load_dwordx4 v[188:191], v3, s[48:51], s67 offen sc1
    s_lshl_b32 s66, s82, 8
    s_add_u32 s66, s66, 196608
    v_and_b32 v8, 31, v0
    v_lshlrev_b32 v8, 2, v8
    buffer_load_dword v6, v8, s[48:51], s66 offen offset:0 sc1
    buffer_load_dword v7, v8, s[48:51], s66 offen offset:128 sc1
    s_waitcnt vmcnt(30)
    ds_read_b64_tr_b16 v[16:17], v14 offset:0
    ds_read_b64_tr_b16 v[18:19], v14 offset:512
    ds_read_b64_tr_b16 v[20:21], v15 offset:0
    ds_read_b64_tr_b16 v[22:23], v15 offset:512
    s_lshl_b32 s87, s82, 16
    s_lshl_b32 s66, s64, 13
    s_add_u32 s87, s87, s66
    s_add_u32 s87, s87, 3145728
    v_and_b32 v11, 3, v0
    v_lshlrev_b32 v11, 11, v11
    v_and_b32 v12, 4, v0
    v_lshl_add_u32 v11, v12, 13, v11
    v_lshl_add_u32 v8, v0, 4, s81
    v_lshlrev_b32 v9, 4, v0
    s_lshl_b32 s66, s64, 12
    v_add_u32 v9, s66, v9
    v_and_b32 v10, 31, v0
    v_lshlrev_b32 v10, 10, v10
    v_and_b32 v12, 32, v0
    v_lshrrev_b32 v12, 1, v12
    v_add_u32 v10, v10, v12
    s_lshl_b32 s90, s82, 16
    s_lshl_b32 s67, s83, 7
    s_add_u32 s90, s90, s67
    s_and_b32 s67, s64, 1
    s_lshl_b32 s67, s67, 15
    s_add_u32 s90, s90, s67
    s_and_b32 s67, s64, 2
    s_lshl_b32 s67, s67, 5
    s_add_u32 s90, s90, s67
    s_waitcnt vmcnt(28)
    s_waitcnt lgkmcnt(0)
    v_mfma_f32_32x32x16_bf16 v[64:79], v[16:19], v[128:131], 0
    ds_read_b64_tr_b16 v[24:25], v14 offset:2048
    ds_read_b64_tr_b16 v[26:27], v14 offset:2560
    v_mfma_f32_32x32x16_bf16 v[80:95], v[16:19], v[132:135], 0
    ds_read_b64_tr_b16 v[28:29], v15 offset:2048
    ds_read_b64_tr_b16 v[30:31], v15 offset:2560
    v_mfma_f32_32x32x16_bf16 v[96:111], v[20:23], v[128:131], 0
    s_add_u32 s67, s84, s92
    s_add_u32 m0, s81, 0
    s_add_u32 s66, s67, 0
    buffer_load_dwordx4 v2, s[52:55], s66 offen lds
    s_add_u32 m0, s81, 1024
    s_add_u32 s66, s67, 8192
    buffer_load_dwordx4 v2, s[52:55], s66 offen lds
    s_add_u32 s92, s92, 65536
    s_cmp_eq_u32 s92, 1835008
    s_cselect_b32 s92, 0, s92
    v_mfma_f32_32x32x16_bf16 v[112:127], v[20:23], v[132:135], 0
    s_add_u32 s66, s85, s93
    s_add_u32 s67, s86, s93
    s_add_u32 s93, s93, 4096
    s_cmp_eq_u32 s93, 114688
    s_cselect_b32 s93, 0, s93
    buffer_load_dwordx4 v[128:131], v3, s[48:51], s66 offen sc1
    buffer_load_dwordx4 v[132:135], v3, s[48:51], s67 offen sc1
    s_waitcnt vmcnt(28)
    s_waitcnt lgkmcnt(0)
    v_mfma_f32_32x32x16_bf16 v[64:79], v[24:27], v[136:139], v[64:79]
    ds_read_b64_tr_b16 v[16:17], v14 offset:4096
    ds_read_b64_tr_b16 v[18:19], v14 offset:4608
    v_mfma_f32_32x32x16_bf16 v[80:95], v[24:27], v[140:143], v[80:95]
    ds_read_b64_tr_b16 v[20:21], v15 offset:4096
    ds_read_b64_tr_b16 v[22:23], v15 offset:4608
    v_mfma_f32_32x32x16_bf16 v[96:111], v[28:31], v[136:139], v[96:111]
    s_add_u32 s67, s84, s92
    s_add_u32 m0, s81, 2048
    s_add_u32 s66, s67, 0
    buffer_load_dwordx4 v2, s[52:55], s66 offen lds
    s_add_u32 m0, s81, 3072
    s_add_u32 s66, s67, 8192
    buffer_load_dwordx4 v2, s[52:55], s66 offen lds
    s_add_u32 s92, s92, 65536
    s_cmp_eq_u32 s92, 1835008
    s_cselect_b32 s92, 0, s92
    v_mfma_f32_32x32x16_bf16 v[112:127], v[28:31], v[140:143], v[112:127]
    s_add_u32 s66, s85, s93
    s_add_u32 s67, s86, s93
    s_add_u32 s93, s93, 4096
    s_cmp_eq_u32 s93, 114688
    s_cselect_b32 s93, 0, s93
    buffer_load_dwordx4 v[136:139], v3, s[48:51], s66 offen sc1
    buffer_load_dwordx4 v[140:143], v3, s[48:51], s67 offen sc1
    s_waitcnt vmcnt(28)
    s_waitcnt lgkmcnt(0)
    v_mfma_f32_32x32x16_bf16 v[64:79], v[16:19], v[144:147], v[64:79]
    ds_read_b64_tr_b16 v[24:25], v14 offset:6144
    ds_read_b64_tr_b16 v[26:27], v14 offset:6656
    v_mfma_f32_32x32x16_bf16 v[80:95], v[16:19], v[148:151], v[80:95]
    ds_read_b64_tr_b16 v[28:29], v15 offset:6144
    ds_read_b64_tr_b16 v[30:31], v15 offset:6656
    v_mfma_f32_32x32x16_bf16 v[96:111], v[20:23], v[144:147], v[96:111]
    s_add_u32 s67, s84, s92
    s_add_u32 m0, s81, 4096
    s_add_u32 s66, s67, 0
    buffer_load_dwordx4 v2, s[52:55], s66 offen lds
    s_add_u32 m0, s81, 5120
    s_add_u32 s66, s67, 8192
    buffer_load_dwordx4 v2, s[52:55], s66 offen lds
    s_add_u32 s92, s92, 65536
    s_cmp_eq_u32 s92, 1835008
    s_cselect_b32 s92, 0, s92
    v_mfma_f32_32x32x16_bf16 v[112:127], v[20:23], v[148:151], v[112:127]
    s_add_u32 s66, s85, s93
    s_add_u32 s67, s86, s93
    s_add_u32 s93, s93, 4096
    s_cmp_eq_u32 s93, 114688
    s_cselect_b32 s93, 0, s93
    buffer_load_dwordx4 v[144:147], v3, s[48:51], s66 offen sc1
    buffer_load_dwordx4 v[148:151], v3, s[48:51], s67 offen sc1
    s_waitcnt vmcnt(28)
    s_waitcnt lgkmcnt(0)
    v_mfma_f32_32x32x16_bf16 v[64:79], v[24:27], v[152:155], v[64:79]
    ds_read_b64_tr_b16 v[16:17], v14 offset:8192
    ds_read_b64_tr_b16 v[18:19], v14 offset:8704
    v_mfma_f32_32x32x16_bf16 v[80:95], v[24:27], v[156:159], v[80:95]
    ds_read_b64_tr_b16 v[20:21], v15 offset:8192
    ds_read_b64_tr_b16 v[22:23], v15 offset:8704
    v_mfma_f32_32x32x16_bf16 v[96:111], v[28:31], v[152:155], v[96:111]
    s_add_u32 s67, s84, s92
    s_add_u32 m0, s81, 6144
    s_add_u32 s66, s67, 0
    buffer_load_dwordx4 v2, s[52:55], s66 offen lds
    s_add_u32 m0, s81, 7168
    s_add_u32 s66, s67, 8192
    buffer_load_dwordx4 v2, s[52:55], s66 offen lds
    s_add_u32 s92, s92, 65536
    s_cmp_eq_u32 s92, 1835008
    s_cselect_b32 s92, 0, s92
    v_mfma_f32_32x32x16_bf16 v[112:127], v[28:31], v[156:159], v[112:127]
    s_add_u32 s66, s85, s93
    s_add_u32 s67, s86, s93
    s_add_u32 s93, s93, 4096
    s_cmp_eq_u32 s93, 114688
    s_cselect_b32 s93, 0, s93
    buffer_load_dwordx4 v[152:155], v3, s[48:51], s66 offen sc1
    buffer_load_dwordx4 v[156:159], v3, s[48:51], s67 offen sc1
    s_waitcnt vmcnt(28)
    s_waitcnt lgkmcnt(0)
    v_mfma_f32_32x32x16_bf16 v[64:79], v[16:19], v[160:163], v[64:79]
    ds_read_b64_tr_b16 v[24:25], v14 offset:10240
    ds_read_b64_tr_b16 v[26:27], v14 offset:10752
    v_mfma_f32_32x32x16_bf16 v[80:95], v[16:19], v[164:167], v[80:95]
    ds_read_b64_tr_b16 v[28:29], v15 offset:10240
    ds_read_b64_tr_b16 v[30:31], v15 offset:10752
    v_mfma_f32_32x32x16_bf16 v[96:111], v[20:23], v[160:163], v[96:111]
    s_add_u32 s67, s84, s92
    s_add_u32 m0, s81, 8192
    s_add_u32 s66, s67, 0
    buffer_load_dwordx4 v2, s[52:55], s66 offen lds
    s_add_u32 m0, s81, 9216
    s_add_u32 s66, s67, 8192
    buffer_load_dwordx4 v2, s[52:55], s66 offen lds
    s_add_u32 s92, s92, 65536
    s_cmp_eq_u32 s92, 1835008
    s_cselect_b32 s92, 0, s92
    v_mfma_f32_32x32x16_bf16 v[112:127], v[20:23], v[164:167], v[112:127]
    s_add_u32 s66, s85, s93
    s_add_u32 s67, s86, s93
    s_add_u32 s93, s93, 4096
    s_cmp_eq_u32 s93, 114688
    s_cselect_b32 s93, 0, s93
    buffer_load_dwordx4 v[160:163], v3, s[48:51], s66 offen sc1
    buffer_load_dwordx4 v[164:167], v3, s[48:51], s67 offen sc1
    s_waitcnt vmcnt(28)
    s_waitcnt lgkmcnt(0)
    v_mfma_f32_32x32x16_bf16 v[64:79], v[24:27], v[168:171], v[64:79]
    ds_read_b64_tr_b16 v[16:17], v14 offset:12288
    ds_read_b64_tr_b16 v[18:19], v14 offset:12800
    v_mfma_f32_32x32x16_bf16 v[80:95], v[24:27], v[172:175], v[80:95]
    ds_read_b64_tr_b16 v[20:21], v15 offset:12288
    ds_read_b64_tr_b16 v[22:23], v15 offset:12800
    v_mfma_f32_32x32x16_bf16 v[96:111], v[28:31], v[168:171], v[96:111]
    s_add_u32 s67, s84, s92
    s_add_u32 m0, s81, 10240
    s_add_u32 s66, s67, 0
    buffer_load_dwordx4 v2, s[52:55], s66 offen lds
    s_add_u32 m0, s81, 11264
    s_add_u32 s66, s67, 8192
    buffer_load_dwordx4 v2, s[52:55], s66 offen lds
    s_add_u32 s92, s92, 65536
    s_cmp_eq_u32 s92, 1835008
    s_cselect_b32 s92, 0, s92
    v_mfma_f32_32x32x16_bf16 v[112:127], v[28:31], v[172:175], v[112:127]
    s_add_u32 s66, s85, s93
    s_add_u32 s67, s86, s93
    s_add_u32 s93, s93, 4096
    s_cmp_eq_u32 s93, 114688
    s_cselect_b32 s93, 0, s93
    buffer_load_dwordx4 v[168:171], v3, s[48:51], s66 offen sc1
    buffer_load_dwordx4 v[172:175], v3, s[48:51], s67 offen sc1
    s_waitcnt vmcnt(28)
    s_waitcnt lgkmcnt(0)
    v_mfma_f32_32x32x16_bf16 v[64:79], v[16:19], v[176:179], v[64:79]
    ds_read_b64_tr_b16 v[24:25], v14 offset:14336
    ds_read_b64_tr_b16 v[26:27], v14 offset:14848
    v_mfma_f32_32x32x16_bf16 v[80:95], v[16:19], v[180:183], v[80:95]
    ds_read_b64_tr_b16 v[28:29], v15 offset:14336
    ds_read_b64_tr_b16 v[30:31], v15 offset:14848
    v_mfma_f32_32x32x16_bf16 v[96:111], v[20:23], v[176:179], v[96:111]
    s_add_u32 s67, s84, s92
    s_add_u32 m0, s81, 12288
    s_add_u32 s66, s67, 0
    buffer_load_dwordx4 v2, s[52:55], s66 offen lds
    s_add_u32 m0, s81, 13312
    s_add_u32 s66, s67, 8192
    buffer_load_dwordx4 v2, s[52:55], s66 offen lds
    s_add_u32 s92, s92, 65536
    s_cmp_eq_u32 s92, 1835008
    s_cselect_b32 s92, 0, s92
    v_mfma_f32_32x32x16_bf16 v[112:127], v[20:23], v[180:183], v[112:127]
    s_add_u32 s66, s85, s93
    s_add_u32 s67, s86, s93
    s_add_u32 s93, s93, 4096
    s_cmp_eq_u32 s93, 114688
    s_cselect_b32 s93, 0, s93
    buffer_load_dwordx4 v[176:179], v3, s[48:51], s66 offen sc1
    buffer_load_dwordx4 v[180:183], v3, s[48:51], s67 offen sc1
    s_waitcnt vmcnt(26)
    s_waitcnt lgkmcnt(0)
    v_mfma_f32_32x32x16_bf16 v[64:79], v[24:27], v[184:187], v[64:79]
    ds_read_b64_tr_b16 v[16:17], v14 offset:0
    ds_read_b64_tr_b16 v[18:19], v14 offset:512
    v_mfma_f32_32x32x16_bf16 v[80:95], v[24:27], v[188:191], v[80:95]
    ds_read_b64_tr_b16 v[20:21], v15 offset:0
    ds_read_b64_tr_b16 v[22:23], v15 offset:512
    v_mfma_f32_32x32x16_bf16 v[96:111], v[28:31], v[184:187], v[96:111]
    s_add_u32 s67, s84, s92
    s_add_u32 m0, s81, 14336
    s_add_u32 s66, s67, 0
    buffer_load_dwordx4 v2, s[52:55], s66 offen lds
    s_add_u32 m0, s81, 15360
    s_add_u32 s66, s67, 8192
    buffer_load_dwordx4 v2, s[52:55], s66 offen lds
    s_add_u32 s92, s92, 65536
    s_cmp_eq_u32 s92, 1835008
    s_cselect_b32 s92, 0, s92
    v_mfma_f32_32x32x16_bf16 v[112:127], v[28:31], v[188:191], v[112:127]
    s_add_u32 s66, s85, s93
    s_add_u32 s67, s86, s93
    s_add_u32 s93, s93, 4096
    s_cmp_eq_u32 s93, 114688
    s_cselect_b32 s93, 0, s93
    buffer_load_dwordx4 v[184:187], v3, s[48:51], s66 offen sc1
    buffer_load_dwordx4 v[188:191], v3, s[48:51], s67 offen sc1
    s_waitcnt vmcnt(26)
    s_waitcnt lgkmcnt(0)
    v_mfma_f32_32x32x16_bf16 v[64:79], v[16:19], v[128:131], v[64:79]
    ds_read_b64_tr_b16 v[24:25], v14 offset:2048
    ds_read_b64_tr_b16 v[26:27], v14 offset:2560
    v_mfma_f32_32x32x16_bf16 v[80:95], v[16:19], v[132:135], v[80:95]
    ds_read_b64_tr_b16 v[28:29], v15 offset:2048
    ds_read_b64_tr_b16 v[30:31], v15 offset:2560
    v_mfma_f32_32x32x16_bf16 v[96:111], v[20:23], v[128:131], v[96:111]
    s_add_u32 s67, s84, s92
    s_add_u32 m0, s81, 0
    s_add_u32 s66, s67, 0
    buffer_load_dwordx4 v2, s[52:55], s66 offen lds
    s_add_u32 m0, s81, 1024
    s_add_u32 s66, s67, 8192
    buffer_load_dwordx4 v2, s[52:55], s66 offen lds
    s_add_u32 s92, s92, 65536
    s_cmp_eq_u32 s92, 1835008
    s_cselect_b32 s92, 0, s92
    v_mfma_f32_32x32x16_bf16 v[112:127], v[20:23], v[132:135], v[112:127]
    s_add_u32 s66, s85, s93
    s_add_u32 s67, s86, s93
    s_add_u32 s93, s93, 4096
    s_cmp_eq_u32 s93, 114688
    s_cselect_b32 s93, 0, s93
    buffer_load_dwordx4 v[128:131], v3, s[48:51], s66 offen sc1
    buffer_load_dwordx4 v[132:135], v3, s[48:51], s67 offen sc1
    s_waitcnt vmcnt(26)
    s_waitcnt lgkmcnt(0)
    v_mfma_f32_32x32x16_bf16 v[64:79], v[24:27], v[136:139], v[64:79]
    ds_read_b64_tr_b16 v[16:17], v14 offset:4096
    ds_read_b64_tr_b16 v[18:19], v14 offset:4608
    v_mfma_f32_32x32x16_bf16 v[80:95], v[24:27], v[140:143], v[80:95]
    ds_read_b64_tr_b16 v[20:21], v15 offset:4096
    ds_read_b64_tr_b16 v[22:23], v15 offset:4608
    v_mfma_f32_32x32x16_bf16 v[96:111], v[28:31], v[136:139], v[96:111]
    s_add_u32 s67, s84, s92
    s_add_u32 m0, s81, 2048
    s_add_u32 s66, s67, 0
    buffer_load_dwordx4 v2, s[52:55], s66 offen lds
    s_add_u32 m0, s81, 3072
    s_add_u32 s66, s67, 8192
    buffer_load_dwordx4 v2, s[52:55], s66 offen lds
    s_add_u32 s92, s92, 65536
    s_cmp_eq_u32 s92, 1835008
    s_cselect_b32 s92, 0, s92
    v_mfma_f32_32x32x16_bf16 v[112:127], v[28:31], v[140:143], v[112:127]
    s_add_u32 s66, s85, s93
    s_add_u32 s67, s86, s93
    s_add_u32 s93, s93, 4096
    s_cmp_eq_u32 s93, 114688
    s_cselect_b32 s93, 0, s93
    buffer_load_dwordx4 v[136:139], v3, s[48:51], s66 offen sc1
    buffer_load_dwordx4 v[140:143], v3, s[48:51], s67 offen sc1
    s_waitcnt vmcnt(26)
    s_waitcnt lgkmcnt(0)
    v_mfma_f32_32x32x16_bf16 v[64:79], v[16:19], v[144:147], v[64:79]
    ds_read_b64_tr_b16 v[24:25], v14 offset:6144
    ds_read_b64_tr_b16 v[26:27], v14 offset:6656
    v_mfma_f32_32x32x16_bf16 v[80:95], v[16:19], v[148:151], v[80:95]
    ds_read_b64_tr_b16 v[28:29], v15 offset:6144
    ds_read_b64_tr_b16 v[30:31], v15 offset:6656
    v_mfma_f32_32x32x16_bf16 v[96:111], v[20:23], v[144:147], v[96:111]
    s_add_u32 s67, s84, s92
    s_add_u32 m0, s81, 4096
    s_add_u32 s66, s67, 0
    buffer_load_dwordx4 v2, s[52:55], s66 offen lds
    s_add_u32 m0, s81, 5120
    s_add_u32 s66, s67, 8192
    buffer_load_dwordx4 v2, s[52:55], s66 offen lds
    s_add_u32 s92, s92, 65536
    s_cmp_eq_u32 s92, 1835008
    s_cselect_b32 s92, 0, s92
    v_mfma_f32_32x32x16_bf16 v[112:127], v[20:23], v[148:151], v[112:127]
    s_add_u32 s66, s85, s93
    s_add_u32 s67, s86, s93
    s_add_u32 s93, s93, 4096
    s_cmp_eq_u32 s93, 114688
    s_cselect_b32 s93, 0, s93
    buffer_load_dwordx4 v[144:147], v3, s[48:51], s66 offen sc1
    buffer_load_dwordx4 v[148:151], v3, s[48:51], s67 offen sc1
    s_waitcnt vmcnt(26)
    s_waitcnt lgkmcnt(0)
    v_mfma_f32_32x32x16_bf16 v[64:79], v[24:27], v[152:155], v[64:79]
    ds_read_b64_tr_b16 v[16:17], v14 offset:8192
    ds_read_b64_tr_b16 v[18:19], v14 offset:8704
    v_mfma_f32_32x32x16_bf16 v[80:95], v[24:27], v[156:159], v[80:95]
    ds_read_b64_tr_b16 v[20:21], v15 offset:8192
    ds_read_b64_tr_b16 v[22:23], v15 offset:8704
    v_mfma_f32_32x32x16_bf16 v[96:111], v[28:31], v[152:155], v[96:111]
    s_add_u32 s67, s84, s92
    s_add_u32 m0, s81, 6144
    s_add_u32 s66, s67, 0
    buffer_load_dwordx4 v2, s[52:55], s66 offen lds
    s_add_u32 m0, s81, 7168
    s_add_u32 s66, s67, 8192
    buffer_load_dwordx4 v2, s[52:55], s66 offen lds
    s_add_u32 s92, s92, 65536
    s_cmp_eq_u32 s92, 1835008
    s_cselect_b32 s92, 0, s92
    v_mfma_f32_32x32x16_bf16 v[112:127], v[28:31], v[156:159], v[112:127]
    s_add_u32 s66, s85, s93
    s_add_u32 s67, s86, s93
    s_add_u32 s93, s93, 4096
    s_cmp_eq_u32 s93, 114688
    s_cselect_b32 s93, 0, s93
    buffer_load_dwordx4 v[152:155], v3, s[48:51], s66 offen sc1
    buffer_load_dwordx4 v[156:159], v3, s[48:51], s67 offen sc1
    s_waitcnt vmcnt(26)
    s_waitcnt lgkmcnt(0)
    v_mfma_f32_32x32x16_bf16 v[64:79], v[16:19], v[160:163], v[64:79]
    ds_read_b64_tr_b16 v[24:25], v14 offset:10240
    ds_read_b64_tr_b16 v[26:27], v14 offset:10752
    v_mfma_f32_32x32x16_bf16 v[80:95], v[16:19], v[164:167], v[80:95]
    ds_read_b64_tr_b16 v[28:29], v15 offset:10240
    ds_read_b64_tr_b16 v[30:31], v15 offset:10752
    v_mfma_f32_32x32x16_bf16 v[96:111], v[20:23], v[160:163], v[96:111]
    s_add_u32 s67, s84, s92
    s_add_u32 m0, s81, 8192
    s_add_u32 s66, s67, 0
    buffer_load_dwordx4 v2, s[52:55], s66 offen lds
    s_add_u32 m0, s81, 9216
    s_add_u32 s66, s67, 8192
    buffer_load_dwordx4 v2, s[52:55], s66 offen lds
    s_add_u32 s92, s92, 65536
    s_cmp_eq_u32 s92, 1835008
    s_cselect_b32 s92, 0, s92
    v_mfma_f32_32x32x16_bf16 v[112:127], v[20:23], v[164:167], v[112:127]
    s_add_u32 s66, s85, s93
    s_add_u32 s67, s86, s93
    s_add_u32 s93, s93, 4096
    s_cmp_eq_u32 s93, 114688
    s_cselect_b32 s93, 0, s93
    buffer_load_dwordx4 v[160:163], v3, s[48:51], s66 offen sc1
    buffer_load_dwordx4 v[164:167], v3, s[48:51], s67 offen sc1
    s_waitcnt vmcnt(26)
    s_waitcnt lgkmcnt(0)
    v_mfma_f32_32x32x16_bf16 v[64:79], v[24:27], v[168:171], v[64:79]
    v_mfma_f32_32x32x16_bf16 v[80:95], v[24:27], v[172:175], v[80:95]
    v_mfma_f32_32x32x16_bf16 v[96:111], v[28:31], v[168:171], v[96:111]
    s_add_u32 s67, s84, s92
    s_add_u32 m0, s81, 10240
    s_add_u32 s66, s67, 0
    buffer_load_dwordx4 v2, s[52:55], s66 offen lds
    s_add_u32 m0, s81, 11264
    s_add_u32 s66, s67, 8192
    buffer_load_dwordx4 v2, s[52:55], s66 offen lds
    s_add_u32 s92, s92, 65536
    s_cmp_eq_u32 s92, 1835008
    s_cselect_b32 s92, 0, s92
    v_mfma_f32_32x32x16_bf16 v[112:127], v[28:31], v[172:175], v[112:127]
    s_add_u32 s66, s85, s93
    s_add_u32 s67, s86, s93
    s_add_u32 s93, s93, 4096
    s_cmp_eq_u32 s93, 114688
    s_cselect_b32 s93, 0, s93
    buffer_load_dwordx4 v[168:171], v3, s[48:51], s66 offen sc1
    buffer_load_dwordx4 v[172:175], v3, s[48:51], s67 offen sc1
    s_waitcnt vmcnt(0)
    ds_read_b64_tr_b16 v[192:193], v14 offset:12288
    ds_read_b64_tr_b16 v[194:195], v14 offset:12800
    ds_read_b64_tr_b16 v[196:197], v15 offset:12288
    ds_read_b64_tr_b16 v[198:199], v15 offset:12800
    ds_read_b64_tr_b16 v[200:201], v14 offset:14336
    ds_read_b64_tr_b16 v[202:203], v14 offset:14848
    ds_read_b64_tr_b16 v[204:205], v15 offset:14336
    ds_read_b64_tr_b16 v[206:207], v15 offset:14848
    ds_read_b64_tr_b16 v[208:209], v14 offset:0
    ds_read_b64_tr_b16 v[210:211], v14 offset:512
    ds_read_b64_tr_b16 v[212:213], v15 offset:0
    ds_read_b64_tr_b16 v[214:215], v15 offset:512
    s_waitcnt lgkmcnt(4)
    ds_read_b64_tr_b16 v[216:217], v14 offset:2048
    ds_read_b64_tr_b16 v[218:219], v14 offset:2560
    ds_read_b64_tr_b16 v[220:221], v15 offset:2048
    ds_read_b64_tr_b16 v[222:223], v15 offset:2560
    ds_read_b64_tr_b16 v[224:225], v14 offset:4096
    ds_read_b64_tr_b16 v[226:227], v14 offset:4608
    ds_read_b64_tr_b16 v[228:229], v15 offset:4096
    ds_read_b64_tr_b16 v[230:231], v15 offset:4608
    ds_read_b64_tr_b16 v[232:233], v14 offset:6144
    ds_read_b64_tr_b16 v[234:235], v14 offset:6656
    ds_read_b64_tr_b16 v[236:237], v15 offset:6144
    ds_read_b64_tr_b16 v[238:239], v15 offset:6656
    s_waitcnt lgkmcnt(4)
    ds_read_b64_tr_b16 v[240:241], v14 offset:8192
    ds_read_b64_tr_b16 v[242:243], v14 offset:8704
    ds_read_b64_tr_b16 v[244:245], v15 offset:8192
    ds_read_b64_tr_b16 v[246:247], v15 offset:8704
    ds_read_b64_tr_b16 v[248:249], v14 offset:10240
    ds_read_b64_tr_b16 v[250:251], v14 offset:10752
    ds_read_b64_tr_b16 v[252:253], v15 offset:10240
    ds_read_b64_tr_b16 v[254:255], v15 offset:10752
    s_waitcnt lgkmcnt(0)
    s_add_u32 s67, s84, s92
    s_add_u32 m0, s81, 0
    s_add_u32 s66, s67, 0
    buffer_load_dwordx4 v2, s[52:55], s66 offen lds
    s_add_u32 m0, s81, 1024
    s_add_u32 s66, s67, 8192
    buffer_load_dwordx4 v2, s[52:55], s66 offen lds
    s_add_u32 s92, s92, 65536
    s_cmp_eq_u32 s92, 1835008
    s_cselect_b32 s92, 0, s92
    s_add_u32 s66, s85, s93
    s_add_u32 s67, s86, s93
    s_add_u32 s93, s93, 4096
    s_cmp_eq_u32 s93, 114688
    s_cselect_b32 s93, 0, s93
    buffer_load_dwordx4 v[32:35], v3, s[48:51], s66 offen sc1
    buffer_load_dwordx4 v[36:39], v3, s[48:51], s67 offen sc1
    s_add_u32 s67, s84, s92
    s_add_u32 m0, s81, 2048
    s_add_u32 s66, s67, 0
    buffer_load_dwordx4 v2, s[52:55], s66 offen lds
    s_add_u32 m0, s81, 3072
    s_add_u32 s66, s67, 8192
    buffer_load_dwordx4 v2, s[52:55], s66 offen lds
    s_add_u32 s92, s92, 65536
    s_cmp_eq_u32 s92, 1835008
    s_cselect_b32 s92, 0, s92
    s_add_u32 s66, s85, s93
    s_add_u32 s67, s86, s93
    s_add_u32 s93, s93, 4096
    s_cmp_eq_u32 s93, 114688
    s_cselect_b32 s93, 0, s93
    buffer_load_dwordx4 v[40:43], v3, s[48:51], s66 offen sc1
    buffer_load_dwordx4 v[44:47], v3, s[48:51], s67 offen sc1
    s_add_u32 s67, s84, s92
    s_add_u32 m0, s81, 4096
    s_add_u32 s66, s67, 0
    buffer_load_dwordx4 v2, s[52:55], s66 offen lds
    s_add_u32 m0, s81, 5120
    s_add_u32 s66, s67, 8192
    buffer_load_dwordx4 v2, s[52:55], s66 offen lds
    s_add_u32 s92, s92, 65536
    s_cmp_eq_u32 s92, 1835008
    s_cselect_b32 s92, 0, s92
    s_add_u32 s66, s85, s93
    s_add_u32 s67, s86, s93
    s_add_u32 s93, s93, 4096
    s_cmp_eq_u32 s93, 114688
    s_cselect_b32 s93, 0, s93
    buffer_load_dwordx4 v[48:51], v3, s[48:51], s66 offen sc1
    buffer_load_dwordx4 v[52:55], v3, s[48:51], s67 offen sc1
    s_add_u32 s67, s84, s92
    s_add_u32 m0, s81, 6144
    s_add_u32 s66, s67, 0
    buffer_load_dwordx4 v2, s[52:55], s66 offen lds
    s_add_u32 m0, s81, 7168
    s_add_u32 s66, s67, 8192
    buffer_load_dwordx4 v2, s[52:55], s66 offen lds
    s_add_u32 s92, s92, 65536
    s_cmp_eq_u32 s92, 1835008
    s_cselect_b32 s92, 0, s92
    s_add_u32 s66, s85, s93
    s_add_u32 s67, s86, s93
    s_add_u32 s93, s93, 4096
    s_cmp_eq_u32 s93, 114688
    s_cselect_b32 s93, 0, s93
    buffer_load_dwordx4 v[56:59], v3, s[48:51], s66 offen sc1
    buffer_load_dwordx4 v[60:63], v3, s[48:51], s67 offen sc1
    s_add_u32 s67, s84, s92
    s_add_u32 m0, s81, 8192
    s_add_u32 s66, s67, 0
    buffer_load_dwordx4 v2, s[52:55], s66 offen lds
    s_add_u32 m0, s81, 9216
    s_add_u32 s66, s67, 8192
    buffer_load_dwordx4 v2, s[52:55], s66 offen lds
    s_add_u32 s92, s92, 65536
    s_cmp_eq_u32 s92, 1835008
    s_cselect_b32 s92, 0, s92
    s_add_u32 s67, s84, s92
    s_add_u32 m0, s81, 10240
    s_add_u32 s66, s67, 0
    buffer_load_dwordx4 v2, s[52:55], s66 offen lds
    s_add_u32 m0, s81, 11264
    s_add_u32 s66, s67, 8192
    buffer_load_dwordx4 v2, s[52:55], s66 offen lds
    s_add_u32 s92, s92, 65536
    s_cmp_eq_u32 s92, 1835008
    s_cselect_b32 s92, 0, s92
    s_add_u32 m0, s81, 12288
    s_add_u32 s66, s88, 0
    buffer_load_dwordx4 v2, s[56:59], s66 offen lds
    s_add_u32 m0, s81, 13312
    s_add_u32 s66, s88, 8192
    buffer_load_dwordx4 v2, s[56:59], s66 offen lds
    s_add_u32 m0, s81, 14336
    s_add_u32 s66, s88, 16384
    buffer_load_dwordx4 v2, s[56:59], s66 offen lds
    s_add_u32 m0, s81, 15360
    s_add_u32 s66, s88, 24576
    buffer_load_dwordx4 v2, s[56:59], s66 offen lds
    s_add_u32 m0, s81, 16384
    s_add_u32 s66, s88, 32768
    buffer_load_dwordx4 v2, s[56:59], s66 offen lds
    s_add_u32 m0, s81, 17408
    s_add_u32 s66, s88, 40960
    buffer_load_dwordx4 v2, s[56:59], s66 offen lds
    s_add_u32 m0, s81, 18432
    s_add_u32 s66, s88, 49152
    buffer_load_dwordx4 v2, s[56:59], s66 offen lds
    s_add_u32 m0, s81, 19456
    s_add_u32 s66, s88, 57344
    buffer_load_dwordx4 v2, s[56:59], s66 offen lds
    s_waitcnt vmcnt(0)
    ds_read_b64_tr_b16 v[16:17], v14 offset:0
    ds_read_b64_tr_b16 v[18:19], v14 offset:512
    ds_read_b64_tr_b16 v[20:21], v15 offset:0
    ds_read_b64_tr_b16 v[22:23], v15 offset:512
    v_mov_b32 v12, 160836
L_hold_38:
    s_sleep 2
    ds_read_b32 v13, v12
    s_waitcnt lgkmcnt(0)
    v_readfirstlane_b32 s76, v13
    s_cmp_lt_u32 s76, 1
    s_cbranch_scc1 L_hold_38
    s_setprio 2
    s_waitcnt lgkmcnt(0)
    v_mfma_f32_32x32x16_bf16 v[64:79], v[16:19], v[32:35], v[64:79]
    ds_read_b64_tr_b16 v[24:25], v14 offset:2048
    ds_read_b64_tr_b16 v[26:27], v14 offset:2560
    v_mfma_f32_32x32x16_bf16 v[80:95], v[16:19], v[36:39], v[80:95]
    ds_read_b64_tr_b16 v[28:29], v15 offset:2048
    ds_read_b64_tr_b16 v[30:31], v15 offset:2560
    v_mfma_f32_32x32x16_bf16 v[96:111], v[20:23], v[32:35], v[96:111]
    v_mfma_f32_32x32x16_bf16 v[112:127], v[20:23], v[36:39], v[112:127]
    s_add_u32 s66, s85, s93
    s_add_u32 s67, s86, s93
    s_add_u32 s93, s93, 4096
    s_cmp_eq_u32 s93, 114688
    s_cselect_b32 s93, 0, s93
    buffer_load_dwordx4 v[32:35], v3, s[48:51], s66 offen sc1
    buffer_load_dwordx4 v[36:39], v3, s[48:51], s67 offen sc1
    s_waitcnt lgkmcnt(0)
    v_mfma_f32_32x32x16_bf16 v[64:79], v[24:27], v[40:43], v[64:79]
    ds_read_b64_tr_b16 v[16:17], v14 offset:4096
    ds_read_b64_tr_b16 v[18:19], v14 offset:4608
    v_mfma_f32_32x32x16_bf16 v[80:95], v[24:27], v[44:47], v[80:95]
    ds_read_b64_tr_b16 v[20:21], v15 offset:4096
    ds_read_b64_tr_b16 v[22:23], v15 offset:4608
    v_mfma_f32_32x32x16_bf16 v[96:111], v[28:31], v[40:43], v[96:111]
    v_mfma_f32_32x32x16_bf16 v[112:127], v[28:31], v[44:47], v[112:127]
    s_add_u32 s66, s85, s93
    s_add_u32 s67, s86, s93
    s_add_u32 s93, s93, 4096
    s_cmp_eq_u32 s93, 114688
    s_cselect_b32 s93, 0, s93
    buffer_load_dwordx4 v[40:43], v3, s[48:51], s66 offen sc1
    buffer_load_dwordx4 v[44:47], v3, s[48:51], s67 offen sc1
    s_waitcnt lgkmcnt(0)
    v_mfma_f32_32x32x16_bf16 v[64:79], v[16:19], v[48:51], v[64:79]
    ds_read_b64_tr_b16 v[24:25], v14 offset:6144
    ds_read_b64_tr_b16 v[26:27], v14 offset:6656
    v_mfma_f32_32x32x16_bf16 v[80:95], v[16:19], v[52:55], v[80:95]
    ds_read_b64_tr_b16 v[28:29], v15 offset:6144
    ds_read_b64_tr_b16 v[30:31], v15 offset:6656
    v_mfma_f32_32x32x16_bf16 v[96:111], v[20:23], v[48:51], v[96:111]
    v_mfma_f32_32x32x16_bf16 v[112:127], v[20:23], v[52:55], v[112:127]
    s_waitcnt lgkmcnt(0)
    v_mfma_f32_32x32x16_bf16 v[64:79], v[24:27], v[56:59], v[64:79]
    ds_read_b64_tr_b16 v[16:17], v14 offset:8192
    ds_read_b64_tr_b16 v[18:19], v14 offset:8704
    v_mfma_f32_32x32x16_bf16 v[80:95], v[24:27], v[60:63], v[80:95]
    ds_read_b64_tr_b16 v[20:21], v15 offset:8192
    ds_read_b64_tr_b16 v[22:23], v15 offset:8704
    v_mfma_f32_32x32x16_bf16 v[96:111], v[28:31], v[56:59], v[96:111]
    v_mfma_f32_32x32x16_bf16 v[112:127], v[28:31], v[60:63], v[112:127]
    v_mfma_f32_32x32x16_bf16 v[64:79], v[192:195], v[176:179], v[64:79]
    v_mfma_f32_32x32x16_bf16 v[80:95], v[192:195], v[180:183], v[80:95]
    v_mfma_f32_32x32x16_bf16 v[96:111], v[196:199], v[176:179], v[96:111]
    s_add_u32 m0, s81, 0
    s_add_u32 s66, s88, 65536
    buffer_load_dwordx4 v2, s[56:59], s66 offen lds
    s_add_u32 m0, s81, 1024
    s_add_u32 s66, s88, 73728
    buffer_load_dwordx4 v2, s[56:59], s66 offen lds
    v_mfma_f32_32x32x16_bf16 v[112:127], v[196:199], v[180:183], v[112:127]
    v_mfma_f32_32x32x16_bf16 v[64:79], v[200:203], v[184:187], v[64:79]
    v_mfma_f32_32x32x16_bf16 v[80:95], v[200:203], v[188:191], v[80:95]
    v_mfma_f32_32x32x16_bf16 v[96:111], v[204:207], v[184:187], v[96:111]
    s_add_u32 m0, s81, 2048
    s_add_u32 s66, s88, 81920
    buffer_load_dwordx4 v2, s[56:59], s66 offen lds
    s_add_u32 m0, s81, 3072
    s_add_u32 s66, s88, 90112
    buffer_load_dwordx4 v2, s[56:59], s66 offen lds
    v_mfma_f32_32x32x16_bf16 v[112:127], v[204:207], v[188:191], v[112:127]
    v_mfma_f32_32x32x16_bf16 v[64:79], v[208:211], v[128:131], v[64:79]
    v_mfma_f32_32x32x16_bf16 v[80:95], v[208:211], v[132:135], v[80:95]
    v_mfma_f32_32x32x16_bf16 v[96:111], v[212:215], v[128:131], v[96:111]
    s_add_u32 m0, s81, 4096
    s_add_u32 s66, s88, 98304
    buffer_load_dwordx4 v2, s[56:59], s66 offen lds
    s_add_u32 m0, s81, 5120
    s_add_u32 s66, s88, 106496
    buffer_load_dwordx4 v2, s[56:59], s66 offen lds
    v_mfma_f32_32x32x16_bf16 v[112:127], v[212:215], v[132:135], v[112:127]
    v_mfma_f32_32x32x16_bf16 v[64:79], v[216:219], v[136:139], v[64:79]
    v_mfma_f32_32x32x16_bf16 v[80:95], v[216:219], v[140:143], v[80:95]
    v_mfma_f32_32x32x16_bf16 v[96:111], v[220:223], v[136:139], v[96:111]
    s_add_u32 m0, s81, 6144
    s_add_u32 s66, s88, 114688
    buffer_load_dwordx4 v2, s[56:59], s66 offen lds
    s_add_u32 m0, s81, 7168
    s_add_u32 s66, s88, 122880
    buffer_load_dwordx4 v2, s[56:59], s66 offen lds
    v_mfma_f32_32x32x16_bf16 v[112:127], v[220:223], v[140:143], v[112:127]
    v_mfma_f32_32x32x16_bf16 v[64:79], v[224:227], v[144:147], v[64:79]
    v_mfma_f32_32x32x16_bf16 v[80:95], v[224:227], v[148:151], v[80:95]
    v_mfma_f32_32x32x16_bf16 v[96:111], v[228:231], v[144:147], v[96:111]
    v_mfma_f32_32x32x16_bf16 v[112:127], v[228:231], v[148:151], v[112:127]
    v_mfma_f32_32x32x16_bf16 v[64:79], v[232:235], v[152:155], v[64:79]
    v_mfma_f32_32x32x16_bf16 v[80:95], v[232:235], v[156:159], v[80:95]
    v_mfma_f32_32x32x16_bf16 v[96:111], v[236:239], v[152:155], v[96:111]
    v_mfma_f32_32x32x16_bf16 v[112:127], v[236:239], v[156:159], v[112:127]
    v_mfma_f32_32x32x16_bf16 v[64:79], v[240:243], v[160:163], v[64:79]
    v_mfma_f32_32x32x16_bf16 v[80:95], v[240:243], v[164:167], v[80:95]
    v_mfma_f32_32x32x16_bf16 v[96:111], v[244:247], v[160:163], v[96:111]
    v_mfma_f32_32x32x16_bf16 v[112:127], v[244:247], v[164:167], v[112:127]
    v_mfma_f32_32x32x16_bf16 v[64:79], v[248:251], v[168:171], v[64:79]
    v_mfma_f32_32x32x16_bf16 v[80:95], v[248:251], v[172:175], v[80:95]
    v_mfma_f32_32x32x16_bf16 v[96:111], v[252:255], v[168:171], v[96:111]
    v_mfma_f32_32x32x16_bf16 v[112:127], v[252:255], v[172:175], v[112:127]
    s_waitcnt vmcnt(10)
    s_waitcnt lgkmcnt(0)
    v_mfma_f32_32x32x16_bf16 v[64:79], v[16:19], v[32:35], v[64:79]
    ds_read_b64_tr_b16 v[24:25], v14 offset:10240
    ds_read_b64_tr_b16 v[26:27], v14 offset:10752
    v_mfma_f32_32x32x16_bf16 v[80:95], v[16:19], v[36:39], v[80:95]
    ds_read_b64_tr_b16 v[28:29], v15 offset:10240
    ds_read_b64_tr_b16 v[30:31], v15 offset:10752
    v_mfma_f32_32x32x16_bf16 v[96:111], v[20:23], v[32:35], v[96:111]
    v_mfma_f32_32x32x16_bf16 v[112:127], v[20:23], v[36:39], v[112:127]
    s_waitcnt vmcnt(8)
    s_waitcnt lgkmcnt(0)
    v_mfma_f32_32x32x16_bf16 v[64:79], v[24:27], v[40:43], v[64:79]
    ds_read_b64_tr_b16 v[16:17], v4 offset:12288
    ds_read_b64_tr_b16 v[18:19], v4 offset:13312
    v_mfma_f32_32x32x16_bf16 v[80:95], v[24:27], v[44:47], v[80:95]
    ds_read_b64_tr_b16 v[20:21], v5 offset:12288
    ds_read_b64_tr_b16 v[22:23], v5 offset:13312
    v_mfma_f32_32x32x16_bf16 v[96:111], v[28:31], v[40:43], v[96:111]
    v_mfma_f32_32x32x16_bf16 v[112:127], v[28:31], v[44:47], v[112:127]
    v_sub_f32 v6, 1.0, v6
    v_sub_f32 v7, 1.0, v7
    s_add_u32 s85, s87, 4096
    s_add_u32 s86, s87, 32768
    s_add_u32 s84, s86, 4096
    s_nop 7
    v_pk_mul_f32 v[64:65], v[64:65], v[6:7] op_sel:[0,0] op_sel_hi:[1,0]
    v_pk_mul_f32 v[66:67], v[66:67], v[6:7] op_sel:[0,0] op_sel_hi:[1,0]
    v_pk_mul_f32 v[68:69], v[68:69], v[6:7] op_sel:[0,0] op_sel_hi:[1,0]
    v_pk_mul_f32 v[70:71], v[70:71], v[6:7] op_sel:[0,0] op_sel_hi:[1,0]
    v_pk_mul_f32 v[72:73], v[72:73], v[6:7] op_sel:[0,0] op_sel_hi:[1,0]
    v_pk_mul_f32 v[74:75], v[74:75], v[6:7] op_sel:[0,0] op_sel_hi:[1,0]
    v_pk_mul_f32 v[76:77], v[76:77], v[6:7] op_sel:[0,0] op_sel_hi:[1,0]
    v_pk_mul_f32 v[78:79], v[78:79], v[6:7] op_sel:[0,0] op_sel_hi:[1,0]
    v_pk_mul_f32 v[80:81], v[80:81], v[6:7] op_sel:[0,1] op_sel_hi:[1,1]
    v_pk_mul_f32 v[82:83], v[82:83], v[6:7] op_sel:[0,1] op_sel_hi:[1,1]
    v_pk_mul_f32 v[84:85], v[84:85], v[6:7] op_sel:[0,1] op_sel_hi:[1,1]
    v_pk_mul_f32 v[86:87], v[86:87], v[6:7] op_sel:[0,1] op_sel_hi:[1,1]
    v_pk_mul_f32 v[88:89], v[88:89], v[6:7] op_sel:[0,1] op_sel_hi:[1,1]
    v_pk_mul_f32 v[90:91], v[90:91], v[6:7] op_sel:[0,1] op_sel_hi:[1,1]
    v_pk_mul_f32 v[92:93], v[92:93], v[6:7] op_sel:[0,1] op_sel_hi:[1,1]
    v_pk_mul_f32 v[94:95], v[94:95], v[6:7] op_sel:[0,1] op_sel_hi:[1,1]
    v_pk_mul_f32 v[96:97], v[96:97], v[6:7] op_sel:[0,0] op_sel_hi:[1,0]
    v_pk_mul_f32 v[98:99], v[98:99], v[6:7] op_sel:[0,0] op_sel_hi:[1,0]
    v_pk_mul_f32 v[100:101], v[100:101], v[6:7] op_sel:[0,0] op_sel_hi:[1,0]
    v_pk_mul_f32 v[102:103], v[102:103], v[6:7] op_sel:[0,0] op_sel_hi:[1,0]
    v_pk_mul_f32 v[104:105], v[104:105], v[6:7] op_sel:[0,0] op_sel_hi:[1,0]
    v_pk_mul_f32 v[106:107], v[106:107], v[6:7] op_sel:[0,0] op_sel_hi:[1,0]
    v_pk_mul_f32 v[108:109], v[108:109], v[6:7] op_sel:[0,0] op_sel_hi:[1,0]
    v_pk_mul_f32 v[110:111], v[110:111], v[6:7] op_sel:[0,0] op_sel_hi:[1,0]
    v_pk_mul_f32 v[112:113], v[112:113], v[6:7] op_sel:[0,1] op_sel_hi:[1,1]
    v_pk_mul_f32 v[114:115], v[114:115], v[6:7] op_sel:[0,1] op_sel_hi:[1,1]
    v_pk_mul_f32 v[116:117], v[116:117], v[6:7] op_sel:[0,1] op_sel_hi:[1,1]
    v_pk_mul_f32 v[118:119], v[118:119], v[6:7] op_sel:[0,1] op_sel_hi:[1,1]
    v_pk_mul_f32 v[120:121], v[120:121], v[6:7] op_sel:[0,1] op_sel_hi:[1,1]
    v_pk_mul_f32 v[122:123], v[122:123], v[6:7] op_sel:[0,1] op_sel_hi:[1,1]
    v_pk_mul_f32 v[124:125], v[124:125], v[6:7] op_sel:[0,1] op_sel_hi:[1,1]
    v_pk_mul_f32 v[126:127], v[126:127], v[6:7] op_sel:[0,1] op_sel_hi:[1,1]
    s_mov_b32 s76, 0x40000
L_oagain_39:
    buffer_load_dword v13, v11, s[48:51], s87 offen offset:2044 sc1
    s_sub_u32 s76, s76, 1
    s_waitcnt vmcnt(0)
    v_cmp_eq_u32 vcc, -1, v13
    s_cbranch_vccz L_ook_40
    s_mov_b64 exec, vcc
    s_sleep 1
    s_cmp_gt_i32 s76, 0
    s_cbranch_scc1 L_oagain_39
L_ook_40:
    s_mov_b64 exec, -1
    buffer_load_dwordx4 v[128:131], v3, s[48:51], s87 offen offset:0 sc1
    buffer_load_dwordx4 v[132:135], v3, s[48:51], s86 offen offset:0 sc1
    buffer_load_dwordx4 v[136:139], v3, s[48:51], s87 offen offset:1024 sc1
    buffer_load_dwordx4 v[140:143], v3, s[48:51], s86 offen offset:1024 sc1
    buffer_load_dwordx4 v[144:147], v3, s[48:51], s87 offen offset:2048 sc1
    buffer_load_dwordx4 v[148:151], v3, s[48:51], s86 offen offset:2048 sc1
    buffer_load_dwordx4 v[152:155], v3, s[48:51], s87 offen offset:3072 sc1
    buffer_load_dwordx4 v[156:159], v3, s[48:51], s86 offen offset:3072 sc1
    buffer_load_dwordx4 v[160:163], v3, s[48:51], s85 offen offset:0 sc1
    buffer_load_dwordx4 v[164:167], v3, s[48:51], s84 offen offset:0 sc1
    buffer_load_dwordx4 v[168:171], v3, s[48:51], s85 offen offset:1024 sc1
    buffer_load_dwordx4 v[172:175], v3, s[48:51], s84 offen offset:1024 sc1
    buffer_load_dwordx4 v[176:179], v3, s[48:51], s85 offen offset:2048 sc1
    buffer_load_dwordx4 v[180:183], v3, s[48:51], s84 offen offset:2048 sc1
    buffer_load_dwordx4 v[184:187], v3, s[48:51], s85 offen offset:3072 sc1
    buffer_load_dwordx4 v[188:191], v3, s[48:51], s84 offen offset:3072 sc1
    v_mov_b32 v12, 0
    s_waitcnt vmcnt(14) lgkmcnt(0)
    v_mfma_f32_32x32x16_bf16 v[192:207], v[16:19], v[128:131], v[64:79]
    ds_read_b64_tr_b16 v[24:25], v4 offset:14336
    v_max3_u32 v12, v12, v128, v129
    v_mfma_f32_32x32x16_bf16 v[208:223], v[16:19], v[132:135], v[80:95]
    ds_read_b64_tr_b16 v[26:27], v4 offset:15360
    v_max3_u32 v12, v12, v130, v131
    v_mfma_f32_32x32x16_bf16 v[224:239], v[20:23], v[128:131], v[96:111]
    ds_read_b64_tr_b16 v[28:29], v5 offset:14336
    v_max3_u32 v12, v12, v132, v133
    v_mfma_f32_32x32x16_bf16 v[240:255], v[20:23], v[132:135], v[112:127]
    ds_read_b64_tr_b16 v[30:31], v5 offset:15360
    v_max3_u32 v12, v12, v134, v135
    s_waitcnt vmcnt(12) lgkmcnt(0)
    v_mfma_f32_32x32x16_bf16 v[192:207], v[24:27], v[136:139], v[192:207]
    ds_read_b64_tr_b16 v[16:17], v4 offset:16384
    v_max3_u32 v12, v12, v136, v137
    v_mfma_f32_32x32x16_bf16 v[208:223], v[24:27], v[140:143], v[208:223]
    ds_read_b64_tr_b16 v[18:19], v4 offset:17408
    v_max3_u32 v12, v12, v138, v139
    v_mfma_f32_32x32x16_bf16 v[224:239], v[28:31], v[136:139], v[224:239]
    ds_read_b64_tr_b16 v[20:21], v5 offset:16384
    v_max3_u32 v12, v12, v140, v141
    v_mfma_f32_32x32x16_bf16 v[240:255], v[28:31], v[140:143], v[240:255]
    ds_read_b64_tr_b16 v[22:23], v5 offset:17408
    v_max3_u32 v12, v12, v142, v143
    s_waitcnt vmcnt(10) lgkmcnt(0)
    v_mfma_f32_32x32x16_bf16 v[192:207], v[16:19], v[144:147], v[192:207]
    ds_read_b64_tr_b16 v[24:25], v4 offset:18432
    v_max3_u32 v12, v12, v144, v145
    v_mfma_f32_32x32x16_bf16 v[208:223], v[16:19], v[148:151], v[208:223]
    ds_read_b64_tr_b16 v[26:27], v4 offset:19456
    v_max3_u32 v12, v12, v146, v147
    v_mfma_f32_32x32x16_bf16 v[224:239], v[20:23], v[144:147], v[224:239]
    ds_read_b64_tr_b16 v[28:29], v5 offset:18432
    v_max3_u32 v12, v12, v148, v149
    v_mfma_f32_32x32x16_bf16 v[240:255], v[20:23], v[148:151], v[240:255]
    ds_read_b64_tr_b16 v[30:31], v5 offset:19456
    v_max3_u32 v12, v12, v150, v151
    s_waitcnt vmcnt(8) lgkmcnt(0)
    v_mfma_f32_32x32x16_bf16 v[192:207], v[24:27], v[152:155], v[192:207]
    ds_read_b64_tr_b16 v[16:17], v4 offset:0
    v_max3_u32 v12, v12, v152, v153
    v_mfma_f32_32x32x16_bf16 v[208:223], v[24:27], v[156:159], v[208:223]
    ds_read_b64_tr_b16 v[18:19], v4 offset:1024
    v_max3_u32 v12, v12, v154, v155
    v_mfma_f32_32x32x16_bf16 v[224:239], v[28:31], v[152:155], v[224:239]
    ds_read_b64_tr_b16 v[20:21], v5 offset:0
    v_max3_u32 v12, v12, v156, v157
    v_mfma_f32_32x32x16_bf16 v[240:255], v[28:31], v[156:159], v[240:255]
    ds_read_b64_tr_b16 v[22:23], v5 offset:1024
    v_max3_u32 v12, v12, v158, v159
    s_waitcnt vmcnt(6) lgkmcnt(0)
    v_mfma_f32_32x32x16_bf16 v[192:207], v[16:19], v[160:163], v[192:207]
    ds_read_b64_tr_b16 v[24:25], v4 offset:2048
    v_max3_u32 v12, v12, v160, v161
    v_mfma_f32_32x32x16_bf16 v[208:223], v[16:19], v[164:167], v[208:223]
    ds_read_b64_tr_b16 v[26:27], v4 offset:3072
    v_max3_u32 v12, v12, v162, v163
    v_mfma_f32_32x32x16_bf16 v[224:239], v[20:23], v[160:163], v[224:239]
    ds_read_b64_tr_b16 v[28:29], v5 offset:2048
    v_max3_u32 v12, v12, v164, v165
    v_mfma_f32_32x32x16_bf16 v[240:255], v[20:23], v[164:167], v[240:255]
    ds_read_b64_tr_b16 v[30:31], v5 offset:3072
    v_max3_u32 v12, v12, v166, v167
    s_waitcnt vmcnt(4) lgkmcnt(0)
    v_mfma_f32_32x32x16_bf16 v[192:207], v[24:27], v[168:171], v[192:207]
    ds_read_b64_tr_b16 v[16:17], v4 offset:4096
    v_max3_u32 v12, v12, v168, v169
    v_mfma_f32_32x32x16_bf16 v[208:223], v[24:27], v[172:175], v[208:223]
    ds_read_b64_tr_b16 v[18:19], v4 offset:5120
    v_max3_u32 v12, v12, v170, v171
    v_mfma_f32_32x32x16_bf16 v[224:239], v[28:31], v[168:171], v[224:239]
    ds_read_b64_tr_b16 v[20:21], v5 offset:4096
    v_max3_u32 v12, v12, v172, v173
    v_mfma_f32_32x32x16_bf16 v[240:255], v[28:31], v[172:175], v[240:255]
    ds_read_b64_tr_b16 v[22:23], v5 offset:5120
    v_max3_u32 v12, v12, v174, v175
    s_waitcnt vmcnt(2) lgkmcnt(0)
    v_mfma_f32_32x32x16_bf16 v[192:207], v[16:19], v[176:179], v[192:207]
    ds_read_b64_tr_b16 v[24:25], v4 offset:6144
    v_max3_u32 v12, v12, v176, v177
    v_mfma_f32_32x32x16_bf16 v[208:223], v[16:19], v[180:183], v[208:223]
    ds_read_b64_tr_b16 v[26:27], v4 offset:7168
    v_max3_u32 v12, v12, v178, v179
    v_mfma_f32_32x32x16_bf16 v[224:239], v[20:23], v[176:179], v[224:239]
    ds_read_b64_tr_b16 v[28:29], v5 offset:6144
    v_max3_u32 v12, v12, v180, v181
    v_mfma_f32_32x32x16_bf16 v[240:255], v[20:23], v[180:183], v[240:255]
    ds_read_b64_tr_b16 v[30:31], v5 offset:7168
    v_max3_u32 v12, v12, v182, v183
    s_waitcnt vmcnt(0) lgkmcnt(0)
    v_mfma_f32_32x32x16_bf16 v[192:207], v[24:27], v[184:187], v[192:207]
    v_max3_u32 v12, v12, v184, v185
    v_max3_u32 v12, v12, v186, v187
    v_mfma_f32_32x32x16_bf16 v[208:223], v[24:27], v[188:191], v[208:223]
    v_max3_u32 v12, v12, v188, v189
    v_max3_u32 v12, v12, v190, v191
    v_mfma_f32_32x32x16_bf16 v[224:239], v[28:31], v[184:187], v[224:239]
    v_mfma_f32_32x32x16_bf16 v[240:255], v[28:31], v[188:191], v[240:255]
    v_cmp_eq_u32 vcc, -1, v12
    s_cbranch_vccz L_ofin_41
    s_cmp_le_i32 s76, 0
    s_cbranch_scc1 L_ofin_41
    ds_read_b64_tr_b16 v[16:17], v4 offset:12288
    ds_read_b64_tr_b16 v[18:19], v4 offset:13312
    ds_read_b64_tr_b16 v[20:21], v5 offset:12288
    ds_read_b64_tr_b16 v[22:23], v5 offset:13312
    s_branch L_oagain_39
L_ofin_41:
    s_cmp_lg_u32 s64, 0
    s_cbranch_scc1 L_red_42
    s_nop 7
    ds_write_b128 v8, v[208:211] offset:4096
    ds_write_b128 v8, v[212:215] offset:5120
    ds_write_b128 v8, v[216:219] offset:6144
    ds_write_b128 v8, v[220:223] offset:7168
    ds_write_b128 v8, v[224:227] offset:8192
    ds_write_b128 v8, v[228:231] offset:9216
    ds_write_b128 v8, v[232:235] offset:10240
    ds_write_b128 v8, v[236:239] offset:11264
    ds_write_b128 v8, v[240:243] offset:12288
    ds_write_b128 v8, v[244:247] offset:13312
    ds_write_b128 v8, v[248:251] offset:14336
    ds_write_b128 v8, v[252:255] offset:15360
    s_waitcnt lgkmcnt(0)
    s_barrier
    ds_read_b128 v[128:131], v9 offset:20480
    ds_read_b128 v[132:135], v9 offset:21504
    ds_read_b128 v[136:139], v9 offset:22528
    ds_read_b128 v[140:143], v9 offset:23552
    ds_read_b128 v[144:147], v9 offset:40960
    ds_read_b128 v[148:151], v9 offset:41984
    ds_read_b128 v[152:155], v9 offset:43008
    ds_read_b128 v[156:159], v9 offset:44032
    ds_read_b128 v[160:163], v9 offset:61440
    ds_read_b128 v[164:167], v9 offset:62464
    ds_read_b128 v[168:171], v9 offset:63488
    ds_read_b128 v[172:175], v9 offset:64512
    s_waitcnt lgkmcnt(8)
    v_pk_add_f32 v[192:193], v[192:193], v[128:129]
    v_pk_add_f32 v[194:195], v[194:195], v[130:131]
    v_pk_add_f32 v[196:197], v[196:197], v[132:133]
    v_pk_add_f32 v[198:199], v[198:199], v[134:135]
    v_pk_add_f32 v[200:201], v[200:201], v[136:137]
    v_pk_add_f32 v[202:203], v[202:203], v[138:139]
    v_pk_add_f32 v[204:205], v[204:205], v[140:141]
    v_pk_add_f32 v[206:207], v[206:207], v[142:143]
    s_waitcnt lgkmcnt(4)
    v_pk_add_f32 v[192:193], v[192:193], v[144:145]
    v_pk_add_f32 v[194:195], v[194:195], v[146:147]
    v_pk_add_f32 v[196:197], v[196:197], v[148:149]
    v_pk_add_f32 v[198:199], v[198:199], v[150:151]
    v_pk_add_f32 v[200:201], v[200:201], v[152:153]
    v_pk_add_f32 v[202:203], v[202:203], v[154:155]
    v_pk_add_f32 v[204:205], v[204:205], v[156:157]
    v_pk_add_f32 v[206:207], v[206:207], v[158:159]
    s_waitcnt lgkmcnt(0)
    v_pk_add_f32 v[192:193], v[192:193], v[160:161]
    v_pk_add_f32 v[194:195], v[194:195], v[162:163]
    v_pk_add_f32 v[196:197], v[196:197], v[164:165]
    v_pk_add_f32 v[198:199], v[198:199], v[166:167]
    v_pk_add_f32 v[200:201], v[200:201], v[168:169]
    v_pk_add_f32 v[202:203], v[202:203], v[170:171]
    v_pk_add_f32 v[204:205], v[204:205], v[172:173]
    v_pk_add_f32 v[206:207], v[206:207], v[174:175]
    v_cvt_pk_bf16_f32 v32, v192, v193
    v_cvt_pk_bf16_f32 v33, v194, v195
    v_cvt_pk_bf16_f32 v34, v196, v197
    v_cvt_pk_bf16_f32 v35, v198, v199
    v_cvt_pk_bf16_f32 v36, v200, v201
    v_cvt_pk_bf16_f32 v37, v202, v203
    v_cvt_pk_bf16_f32 v38, v204, v205
    v_cvt_pk_bf16_f32 v39, v206, v207
    s_branch L_out
L_red_42:
    s_cmp_lg_u32 s64, 1
    s_cbranch_scc1 L_red_43
    s_nop 7
    ds_write_b128 v8, v[192:195] offset:0
    ds_write_b128 v8, v[196:199] offset:1024
    ds_write_b128 v8, v[200:203] offset:2048
    ds_write_b128 v8, v[204:207] offset:3072
    ds_write_b128 v8, v[224:227] offset:8192
    ds_write_b128 v8, v[228:231] offset:9216
    ds_write_b128 v8, v[232:235] offset:10240
    ds_write_b128 v8, v[236:239] offset:11264
    ds_write_b128 v8, v[240:243] offset:12288
    ds_write_b128 v8, v[244:247] offset:13312
    ds_write_b128 v8, v[248:251] offset:14336
    ds_write_b128 v8, v[252:255] offset:15360
    s_waitcnt lgkmcnt(0)
    s_barrier
    ds_read_b128 v[128:131], v9 offset:0
    ds_read_b128 v[132:135], v9 offset:1024
    ds_read_b128 v[136:139], v9 offset:2048
    ds_read_b128 v[140:143], v9 offset:3072
    ds_read_b128 v[144:147], v9 offset:40960
    ds_read_b128 v[148:151], v9 offset:41984
    ds_read_b128 v[152:155], v9 offset:43008
    ds_read_b128 v[156:159], v9 offset:44032
    ds_read_b128 v[160:163], v9 offset:61440
    ds_read_b128 v[164:167], v9 offset:62464
    ds_read_b128 v[168:171], v9 offset:63488
    ds_read_b128 v[172:175], v9 offset:64512
    s_waitcnt lgkmcnt(8)
    v_pk_add_f32 v[208:209], v[208:209], v[128:129]
    v_pk_add_f32 v[210:211], v[210:211], v[130:131]
    v_pk_add_f32 v[212:213], v[212:213], v[132:133]
    v_pk_add_f32 v[214:215], v[214:215], v[134:135]
    v_pk_add_f32 v[216:217], v[216:217], v[136:137]
    v_pk_add_f32 v[218:219], v[218:219], v[138:139]
    v_pk_add_f32 v[220:221], v[220:221], v[140:141]
    v_pk_add_f32 v[222:223], v[222:223], v[142:143]
    s_waitcnt lgkmcnt(4)
    v_pk_add_f32 v[208:209], v[208:209], v[144:145]
    v_pk_add_f32 v[210:211], v[210:211], v[146:147]
    v_pk_add_f32 v[212:213], v[212:213], v[148:149]
    v_pk_add_f32 v[214:215], v[214:215], v[150:151]
    v_pk_add_f32 v[216:217], v[216:217], v[152:153]
    v_pk_add_f32 v[218:219], v[218:219], v[154:155]
    v_pk_add_f32 v[220:221], v[220:221], v[156:157]
    v_pk_add_f32 v[222:223], v[222:223], v[158:159]
    s_waitcnt lgkmcnt(0)
    v_pk_add_f32 v[208:209], v[208:209], v[160:161]
    v_pk_add_f32 v[210:211], v[210:211], v[162:163]
    v_pk_add_f32 v[212:213], v[212:213], v[164:165]
    v_pk_add_f32 v[214:215], v[214:215], v[166:167]
    v_pk_add_f32 v[216:217], v[216:217], v[168:169]
    v_pk_add_f32 v[218:219], v[218:219], v[170:171]
    v_pk_add_f32 v[220:221], v[220:221], v[172:173]
    v_pk_add_f32 v[222:223], v[222:223], v[174:175]
    v_cvt_pk_bf16_f32 v32, v208, v209
    v_cvt_pk_bf16_f32 v33, v210, v211
    v_cvt_pk_bf16_f32 v34, v212, v213
    v_cvt_pk_bf16_f32 v35, v214, v215
    v_cvt_pk_bf16_f32 v36, v216, v217
    v_cvt_pk_bf16_f32 v37, v218, v219
    v_cvt_pk_bf16_f32 v38, v220, v221
    v_cvt_pk_bf16_f32 v39, v222, v223
    s_branch L_out
L_red_43:
    s_cmp_lg_u32 s64, 2
    s_cbranch_scc1 L_red_44
    s_nop 7
    ds_write_b128 v8, v[192:195] offset:0
    ds_write_b128 v8, v[196:199] offset:1024
    ds_write_b128 v8, v[200:203] offset:2048
    ds_write_b128 v8, v[204:207] offset:3072
    ds_write_b128 v8, v[208:211] offset:4096
    ds_write_b128 v8, v[212:215] offset:5120
    ds_write_b128 v8, v[216:219] offset:6144
    ds_write_b128 v8, v[220:223] offset:7168
    ds_write_b128 v8, v[240:243] offset:12288
    ds_write_b128 v8, v[244:247] offset:13312
    ds_write_b128 v8, v[248:251] offset:14336
    ds_write_b128 v8, v[252:255] offset:15360
    s_waitcnt lgkmcnt(0)
    s_barrier
    ds_read_b128 v[128:131], v9 offset:0
    ds_read_b128 v[132:135], v9 offset:1024
    ds_read_b128 v[136:139], v9 offset:2048
    ds_read_b128 v[140:143], v9 offset:3072
    ds_read_b128 v[144:147], v9 offset:20480
    ds_read_b128 v[148:151], v9 offset:21504
    ds_read_b128 v[152:155], v9 offset:22528
    ds_read_b128 v[156:159], v9 offset:23552
    ds_read_b128 v[160:163], v9 offset:61440
    ds_read_b128 v[164:167], v9 offset:62464
    ds_read_b128 v[168:171], v9 offset:63488
    ds_read_b128 v[172:175], v9 offset:64512
    s_waitcnt lgkmcnt(8)
    v_pk_add_f32 v[224:225], v[224:225], v[128:129]
    v_pk_add_f32 v[226:227], v[226:227], v[130:131]
    v_pk_add_f32 v[228:229], v[228:229], v[132:133]
    v_pk_add_f32 v[230:231], v[230:231], v[134:135]
    v_pk_add_f32 v[232:233], v[232:233], v[136:137]
    v_pk_add_f32 v[234:235], v[234:235], v[138:139]
    v_pk_add_f32 v[236:237], v[236:237], v[140:141]
    v_pk_add_f32 v[238:239], v[238:239], v[142:143]
    s_waitcnt lgkmcnt(4)
    v_pk_add_f32 v[224:225], v[224:225], v[144:145]
    v_pk_add_f32 v[226:227], v[226:227], v[146:147]
    v_pk_add_f32 v[228:229], v[228:229], v[148:149]
    v_pk_add_f32 v[230:231], v[230:231], v[150:151]
    v_pk_add_f32 v[232:233], v[232:233], v[152:153]
    v_pk_add_f32 v[234:235], v[234:235], v[154:155]
    v_pk_add_f32 v[236:237], v[236:237], v[156:157]
    v_pk_add_f32 v[238:239], v[238:239], v[158:159]
    s_waitcnt lgkmcnt(0)
    v_pk_add_f32 v[224:225], v[224:225], v[160:161]
    v_pk_add_f32 v[226:227], v[226:227], v[162:163]
    v_pk_add_f32 v[228:229], v[228:229], v[164:165]
    v_pk_add_f32 v[230:231], v[230:231], v[166:167]
    v_pk_add_f32 v[232:233], v[232:233], v[168:169]
    v_pk_add_f32 v[234:235], v[234:235], v[170:171]
    v_pk_add_f32 v[236:237], v[236:237], v[172:173]
    v_pk_add_f32 v[238:239], v[238:239], v[174:175]
    v_cvt_pk_bf16_f32 v32, v224, v225
    v_cvt_pk_bf16_f32 v33, v226, v227
    v_cvt_pk_bf16_f32 v34, v228, v229
    v_cvt_pk_bf16_f32 v35, v230, v231
    v_cvt_pk_bf16_f32 v36, v232, v233
    v_cvt_pk_bf16_f32 v37, v234, v235
    v_cvt_pk_bf16_f32 v38, v236, v237
    v_cvt_pk_bf16_f32 v39, v238, v239
    s_branch L_out
L_red_44:
    s_nop 7
    ds_write_b128 v8, v[192:195] offset:0
    ds_write_b128 v8, v[196:199] offset:1024
    ds_write_b128 v8, v[200:203] offset:2048
    ds_write_b128 v8, v[204:207] offset:3072
    ds_write_b128 v8, v[208:211] offset:4096
    ds_write_b128 v8, v[212:215] offset:5120
    ds_write_b128 v8, v[216:219] offset:6144
    ds_write_b128 v8, v[220:223] offset:7168
    ds_write_b128 v8, v[224:227] offset:8192
    ds_write_b128 v8, v[228:231] offset:9216
    ds_write_b128 v8, v[232:235] offset:10240
    ds_write_b128 v8, v[236:239] offset:11264
    s_waitcnt lgkmcnt(0)
    s_barrier
    ds_read_b128 v[128:131], v9 offset:0
    ds_read_b128 v[132:135], v9 offset:1024
    ds_read_b128 v[136:139], v9 offset:2048
    ds_read_b128 v[140:143], v9 offset:3072
    ds_read_b128 v[144:147], v9 offset:20480
    ds_read_b128 v[148:151], v9 offset:21504
    ds_read_b128 v[152:155], v9 offset:22528
    ds_read_b128 v[156:159], v9 offset:23552
    ds_read_b128 v[160:163], v9 offset:40960
    ds_read_b128 v[164:167], v9 offset:41984
    ds_read_b128 v[168:171], v9 offset:43008
    ds_read_b128 v[172:175], v9 offset:44032
    s_waitcnt lgkmcnt(8)
    v_pk_add_f32 v[240:241], v[240:241], v[128:129]
    v_pk_add_f32 v[242:243], v[242:243], v[130:131]
    v_pk_add_f32 v[244:245], v[244:245], v[132:133]
    v_pk_add_f32 v[246:247], v[246:247], v[134:135]
    v_pk_add_f32 v[248:249], v[248:249], v[136:137]
    v_pk_add_f32 v[250:251], v[250:251], v[138:139]
    v_pk_add_f32 v[252:253], v[252:253], v[140:141]
    v_pk_add_f32 v[254:255], v[254:255], v[142:143]
    s_waitcnt lgkmcnt(4)
    v_pk_add_f32 v[240:241], v[240:241], v[144:145]
    v_pk_add_f32 v[242:243], v[242:243], v[146:147]
    v_pk_add_f32 v[244:245], v[244:245], v[148:149]
    v_pk_add_f32 v[246:247], v[246:247], v[150:151]
    v_pk_add_f32 v[248:249], v[248:249], v[152:153]
    v_pk_add_f32 v[250:251], v[250:251], v[154:155]
    v_pk_add_f32 v[252:253], v[252:253], v[156:157]
    v_pk_add_f32 v[254:255], v[254:255], v[158:159]
    s_waitcnt lgkmcnt(0)
    v_pk_add_f32 v[240:241], v[240:241], v[160:161]
    v_pk_add_f32 v[242:243], v[242:243], v[162:163]
    v_pk_add_f32 v[244:245], v[244:245], v[164:165]
    v_pk_add_f32 v[246:247], v[246:247], v[166:167]
    v_pk_add_f32 v[248:249], v[248:249], v[168:169]
    v_pk_add_f32 v[250:251], v[250:251], v[170:171]
    v_pk_add_f32 v[252:253], v[252:253], v[172:173]
    v_pk_add_f32 v[254:255], v[254:255], v[174:175]
    v_cvt_pk_bf16_f32 v32, v240, v241
    v_cvt_pk_bf16_f32 v33, v242, v243
    v_cvt_pk_bf16_f32 v34, v244, v245
    v_cvt_pk_bf16_f32 v35, v246, v247
    v_cvt_pk_bf16_f32 v36, v248, v249
    v_cvt_pk_bf16_f32 v37, v250, v251
    v_cvt_pk_bf16_f32 v38, v252, v253
    v_cvt_pk_bf16_f32 v39, v254, v255
L_out:
    s_nop 1
    v_permlane32_swap_b32 v32, v34
    v_permlane32_swap_b32 v33, v35
    v_permlane32_swap_b32 v36, v38
    v_permlane32_swap_b32 v37, v39
    buffer_store_dwordx4 v[32:35], v10, s[60:63], s90 offen
    buffer_store_dwordx4 v[36:39], v10, s[60:63], s90 offen offset:32
L_exit:
    s_endpgm
.section .rodata,"a"
.p2align 6
.amdhsa_kernel gated_mix__grouped_kv_mqa__glu_gated_geglu__prompt_kernel
  .amdhsa_next_free_vgpr 256
  .amdhsa_next_free_sgpr 102
  .amdhsa_accum_offset 256
  .amdhsa_group_segment_fixed_size 0
  .amdhsa_kernarg_size 104
  .amdhsa_user_sgpr_count 2
  .amdhsa_user_sgpr_kernarg_segment_ptr 1
  .amdhsa_system_sgpr_workgroup_id_x 1
.end_amdhsa_kernel
```
